```python
import torch

def _softmax(x, axis=-1):
    return torch.softmax(x, dim=axis)
def _gelu(x):
    return torch.nn.functional.gelu(x, approximate="tanh")
def _silu(x):
    return torch.nn.functional.silu(x)
def _sigmoid(x):
    return torch.sigmoid(x)
def _layernorm(x, axis=-1, eps=1e-5):
    m = x.mean(dim=axis, keepdim=True)
    v = x.var(dim=axis, keepdim=True, unbiased=False)
    return (x - m) / torch.sqrt(v + eps)
def _scatter_add(tgt, idx, src, axis=0):
    return tgt.clone().index_add_(axis, idx, src)
def _segment_sum(src, seg, n):
    out = torch.zeros((n,) + src.shape[1:], dtype=src.dtype)
    return out.index_add_(0, seg, src)
def _pad(x, pw):
    flat = tuple(v for pair in reversed(pw) for v in pair)
    return torch.nn.functional.pad(x, flat)

kernel_name = 'gated_mix__linear_kernel_hedgehog__glu_gated_geglu__prompt'

def setup_inputs():

    _w = (lambda a: (lambda t: t.to(torch.bfloat16) if t.is_floating_point() else t)(torch.as_tensor(a)))
    def _A_setup():
        B, S, D, H = 1, 2048, 448, 16
        Dh = D // H
        return {
            "x": _w((lambda *s: torch.randn(*s, dtype=torch.bfloat16) * 0.05)(B, S, D)),
            "wqkv": _w((lambda *s: torch.randn(*s, dtype=torch.bfloat16) * 0.8)(D, 3 * D)),
            "w_phi": _w((lambda *s: torch.randn(*s, dtype=torch.bfloat16) * 0.8)(H, Dh, Dh) * (Dh ** -0.5)),
            "wo": _w((lambda *s: torch.randn(*s, dtype=torch.bfloat16) * 0.05)(D, D)),
        }
    _A_in = _A_setup()

    def _B_setup():
        B, S, Dm, Df = 1, 2048, 448, 1792
        return {
            "x": _w((lambda *s: torch.randn(*s, dtype=torch.bfloat16) * 0.05)(B, S, Dm)),
            "w_gate": _w((lambda *s: torch.randn(*s, dtype=torch.bfloat16) * 1.6)(Dm, Df) * (Dm ** -0.5)),
            "w_up": _w((lambda *s: torch.randn(*s, dtype=torch.bfloat16) * 1.6)(Dm, Df) * (Dm ** -0.5)),
            "w_down": _w((lambda *s: torch.randn(*s, dtype=torch.bfloat16) * 1.6)(Df, Dm) * (Df ** -0.5)),
        }
    _B_in = _B_setup()

    return {
        "A_x": _A_in["x"],
        "A_wqkv": _A_in["wqkv"],
        "A_w_phi": _A_in["w_phi"],
        "A_wo": _A_in["wo"],
        "B_x": _B_in["x"],
        "B_w_gate": _B_in["w_gate"],
        "B_w_up": _B_in["w_up"],
        "B_w_down": _B_in["w_down"],
        "gate_w": _w((lambda *s: torch.randn(*s, dtype=torch.bfloat16) * 0.05)(448) * 16.0),
    }

def reference(A_x, A_wqkv, A_w_phi, A_wo, B_x, B_w_gate, B_w_up, B_w_down, gate_w):
    def _A_ref(x, wqkv, w_phi, wo):
        B, S, D = x.shape
        H = 16; Dh = D // H
        qkv = (lambda x, *d: x.permute(*d))((x @ wqkv).reshape(B, S, 3, H, Dh), 2, 0, 3, 1, 4)
        q, k, v = qkv[0], qkv[1], qkv[2]
        pq = torch.einsum("bhsd,hdf->bhsf", q, w_phi)
        pk = torch.einsum("bhsd,hdf->bhsf", k, w_phi)
        phi_q = torch.concatenate([_softmax(pq, axis=-1), _softmax(-pq, axis=-1)], axis=-1)
        phi_k = torch.concatenate([_softmax(pk, axis=-1), _softmax(-pk, axis=-1)], axis=-1)
        kv = torch.einsum("bhsf,bhsd->bhfd", phi_k, v)
        z  = torch.einsum("bhsf->bhf", phi_k)
        num = torch.einsum("bhqf,bhfd->bhqd", phi_q, kv)
        den = torch.einsum("bhqf,bhf->bhq", phi_q, z)[..., None] + 1e-6
        o = num / den
        return (lambda x, *d: x.permute(*d))(o, 0, 2, 1, 3).reshape(B, S, D) @ wo

    def _B_ref(x, w_gate, w_up, w_down):
        g = torch.einsum("bsd,df->bsf", x, w_gate)
        u = torch.einsum("bsd,df->bsf", x, w_up)
        h = _gelu(g) * u
        return torch.einsum("bsf,fd->bsd", h, w_down)

    x = A_x
    g = _sigmoid((x * gate_w).sum(-1, keepdims=True))
    a = _A_ref(x, A_wqkv, A_w_phi, A_wo)
    b = _B_ref(x, B_w_gate, B_w_up, B_w_down)
    return g * a + (1 - g) * b
```

```asm
; @launch grid=(256,1,1) block=(256,1,1) lds=163840
.amdgcn_target "amdgcn-amd-amdhsa--gfx950"
.text
.globl gated_mix__linear_kernel_hedgehog__glu_gated_geglu__prompt_kernel
.p2align 8
.type gated_mix__linear_kernel_hedgehog__glu_gated_geglu__prompt_kernel,@function
gated_mix__linear_kernel_hedgehog__glu_gated_geglu__prompt_kernel:
    s_cmp_ge_u32 s2, 256
    s_cbranch_scc1 Lend
    s_load_dwordx16 s[4:19], s[0:1], 0
    s_load_dwordx8 s[20:27], s[0:1], 64
    s_getpc_b64 s[96:97]
    s_bfe_u32 s3, s2, 0x20003
    s_mul_i32 s3, s3, 128
    v_add_u32 v13, s3, v0
    v_cmp_gt_u32 vcc, 128, v0
    s_nop 1
    v_cndmask_b32 v12, v13, v0, vcc
    v_lshlrev_b32 v12, 7, v12
    v_cmp_gt_u32 vcc, Lcode_end - gated_mix__linear_kernel_hedgehog__glu_gated_geglu__prompt_kernel - 64, v12
    s_nop 0
    s_and_saveexec_b64 s[100:101], vcc
    v_cmp_gt_u32 vcc, 256, v0
    s_nop 0
    s_and_b64 exec, exec, vcc
    s_cbranch_execz Lnocpf
    global_load_dword v20, v12, s[96:97]
Lnocpf:
    s_mov_b64 exec, -1
    s_memrealtime s[98:99]
    v_lshrrev_b32 v12, 6, v0
    v_and_b32 v0, 63, v0
    v_readfirstlane_b32 s72, v12
    v_lshlrev_b32 v1, 4, v0
    v_mov_b32 v11, 0
    s_mov_b32 s64, 0
    s_lshl_b32 s73, s72, 11
    s_and_b32 s74, s72, 1
    s_lshr_b32 s75, s72, 1
    v_lshrrev_b32 v2, 3, v0
    s_lshl_b32 s87, s72, 4
    v_add_u32 v2, s87, v2
    v_and_b32 v12, 7, v0
    v_bfe_u32 v13, v2, 1, 1
    v_lshlrev_b32 v13, 2, v13
    v_xor_b32 v3, v12, v13
    v_lshlrev_b32 v3, 4, v3
    v_bfe_u32 v13, v2, 1, 3
    v_xor_b32 v12, v12, v13
    v_lshlrev_b32 v12, 4, v12
    v_mul_u32_u24 v6, 896, v2
    v_xor_b32 v13, 64, v12
    v_add_u32 v7, v6, v13
    v_add_u32 v6, v6, v12
    v_add_u32 v7, 6144, v7
    s_and_b32 s87, s2, 7
    s_lshr_b32 s88, s2, 3
    s_lshl_b32 s85, s87, 2
    s_and_b32 s89, s88, 3
    s_add_u32 s85, s85, s89
    s_lshr_b32 s86, s88, 2
    s_and_b32 s76, s87, 1
    s_lshl_b32 s76, s76, 3
    s_lshr_b32 s87, s87, 1
    s_mul_i32 s90, s87, 28
    s_add_u32 s90, s90, s88
    s_lshr_b32 s93, s90, 3
    s_lshl_b32 s93, s93, 2
    s_mov_b32 s96, 0x38c27610
    s_mov_b32 s97, 0xbd5a94
    s_lshr_b64 s[96:97], s[96:97], s93
    s_and_b32 s93, s96, 15
    s_and_b32 s90, s90, 7
    s_and_b32 s92, s87, 1
    s_add_u32 s92, s92, 14
    s_lshr_b32 s87, s87, 1
    s_lshl_b32 s87, s87, 2
    s_add_u32 s87, s87, s89
    s_cmp_ge_u32 s88, 28
    s_cselect_b32 s93, s92, s93
    s_cselect_b32 s90, s87, s90
    s_add_u32 s76, s76, s90
    s_mul_i32 s87, s93, 3
    s_add_u32 s87, s87, s76
    s_mul_i32 s88, s87, 37
    s_lshr_b32 s88, s88, 8
    s_mul_i32 s88, s88, 7
    s_sub_u32 s80, s87, s88
    s_lshl_b32 s84, s80, 7
    s_mov_b32 s31, 0x20000
    s_mov_b32 s35, 0x20000
    s_mov_b32 s39, 0x20000
    s_mov_b32 s43, 0x20000
    s_mov_b32 s47, 0x20000
    s_sub_u32 s78, s93, 5
    s_and_b32 s78, s78, 7
    s_mul_i32 s48, s78, 112
    s_add_u32 s48, s48, 896
    s_add_u32 s49, s48, 896
    s_sub_u32 s89, s93, 14
    s_mul_i32 s87, s89, 448
    s_add_u32 s88, s87, 112
    s_cmp_ge_u32 s93, 14
    s_cselect_b32 s48, s87, s48
    s_cselect_b32 s49, s88, s49
    s_lshl_b32 s87, s93, 7
    s_movk_i32 s50, 2688
    s_movk_i32 s88, 96
    s_cmp_lt_u32 s93, 6
    s_cselect_b32 s48, s87, s48
    s_cselect_b32 s49, s87, s49
    s_cselect_b32 s50, 3584, s50
    s_cselect_b32 s88, -1, s88
    v_min_u32 v4, s88, v3
    v_mad_u32_u24 v4, v2, s50, v4
    s_lshl_b32 s87, s50, 3
    s_sub_u32 s87, s87, 1024
    v_add_u32 v5, s87, v4
    s_lshl_b32 s82, s50, 6
    s_mul_i32 s81, s80, s82
    s_mul_i32 s83, s82, 7
    s_sub_u32 s34, s83, s48
    s_sub_u32 s38, s83, s49
    s_mul_i32 s87, s76, 114688
    s_sub_u32 s42, 1835008, s87
    s_add_u32 s88, s87, 57344
    s_sub_u32 s46, 1835008, s88
    s_cmp_lt_u32 s93, 6
    s_waitcnt lgkmcnt(0)
    s_cselect_b64 s[32:33], s[14:15], s[6:7]
    s_cselect_b64 s[36:37], s[16:17], s[6:7]
    s_add_u32 s40, s4, s87
    s_addc_u32 s41, s5, 0
    s_add_u32 s44, s4, s88
    s_addc_u32 s45, s5, 0
    s_add_u32 m0, s73, 32768
    s_nop 0
    buffer_load_dwordx4 v6, s[40:43], s84 offen lds
    buffer_load_dwordx4 v7, s[40:43], s84 offen offset:1024 lds
    s_add_u32 m0, s73, 40960
    s_nop 0
    buffer_load_dwordx4 v6, s[44:47], s84 offen lds
    buffer_load_dwordx4 v7, s[44:47], s84 offen offset:1024 lds
    s_add_u32 s84, s84, 128
    s_cmp_eq_u32 s84, 896
    s_cselect_b32 s84, 0, s84
    s_add_u32 s32, s32, s48
    s_addc_u32 s33, s33, 0
    s_add_u32 s36, s36, s49
    s_addc_u32 s37, s37, 0
    s_add_u32 m0, s73, 49152
    s_nop 0
    buffer_load_dwordx4 v4, s[32:35], s81 offen lds
    buffer_load_dwordx4 v5, s[32:35], s81 offen offset:1024 lds
    s_add_u32 m0, s73, 57344
    s_nop 0
    buffer_load_dwordx4 v4, s[36:39], s81 offen lds
    buffer_load_dwordx4 v5, s[36:39], s81 offen offset:1024 lds
    s_add_u32 s81, s81, s82
    s_cmp_eq_u32 s81, s83
    s_cselect_b32 s81, 0, s81
    s_add_u32 m0, s73, 65536
    s_nop 0
    buffer_load_dwordx4 v6, s[40:43], s84 offen lds
    buffer_load_dwordx4 v7, s[40:43], s84 offen offset:1024 lds
    s_add_u32 m0, s73, 73728
    s_nop 0
    buffer_load_dwordx4 v6, s[44:47], s84 offen lds
    buffer_load_dwordx4 v7, s[44:47], s84 offen offset:1024 lds
    s_add_u32 s84, s84, 128
    s_cmp_eq_u32 s84, 896
    s_cselect_b32 s84, 0, s84
    s_mul_i32 s92, s78, 3136
    s_movk_i32 s50, 3136
    s_mov_b32 s51, 0x20000
    s_mov_b32 s77, 0x16
    s_mov_b32 s87, 0x0e0000
    s_cmp_lt_u32 s93, 12
    s_cselect_b32 s77, 6, s77
    s_cselect_b32 s87, 0x800, s87
    s_cmp_lt_u32 s93, 6
    s_cselect_b32 s77, 0x15, s77
    s_cselect_b32 s78, s93, s78
    s_cselect_b32 s87, 0x140600, s87
    s_cselect_b32 s50, 0, s50
    s_mul_i32 s88, s93, 0x10100
    s_add_u32 s78, s78, s88
    s_add_u32 s78, s78, s87
    s_mul_i32 s87, s89, 12544
    s_cmp_ge_u32 s93, 14
    s_cselect_b32 s77, 3, s77
    s_cselect_b32 s92, s87, s92
    s_cselect_b32 s50, 12544, s50
    s_cselect_b32 s93, s89, s93
    s_mov_b64 s[28:29], s[26:27]
    s_mov_b32 s30, 16777216
    s_cmp_eq_u32 s72, 0
    s_cselect_b32 s63, 1, 0
    s_add_u32 s48, s8, s92
    s_addc_u32 s49, s9, 0
    s_or_b32 s87, s2, s72
    s_cmp_lg_u32 s87, 0
    s_cbranch_scc1 Lnotag
    s_or_b32 s87, s98, 1
    v_mov_b32 v12, s87
    v_mov_b32 v13, 0
    s_mov_b64 exec, 1
    global_store_dword v13, v12, s[24:25] sc1
    s_mov_b64 exec, -1
Lnotag:
    s_mov_b32 s91, 0x3fb8aa3b
    s_mov_b32 s96, 0
    s_mov_b32 s97, -1
    s_lshl_b32 s87, s75, 6
    v_and_b32 v12, 3, v0
    v_lshlrev_b32 v12, 3, v12
    v_bfe_u32 v13, v0, 4, 1
    v_lshl_add_u32 v12, v13, 5, v12
    v_add_u32 v12, s87, v12
    v_bfe_u32 v13, v0, 3, 1
    v_lshlrev_b32 v13, 6, v13
    v_xor_b32 v12, v12, v13
    v_bfe_u32 v13, v0, 2, 2
    v_lshl_add_u32 v12, v13, 7, v12
    v_bfe_u32 v13, v0, 5, 1
    v_lshl_add_u32 v8, v13, 10, v12
    v_add_u32 v9, 0x10000, v8
    v_add_u32 v10, 0x20000, v8
    v_mov_b32 v35, v8
    s_cmp_eq_u32 s77, 0x15
    s_cselect_b32 s87, 64, 56
    s_mul_i32 s87, s87, s75
    v_and_b32 v12, 3, v0
    v_lshlrev_b32 v12, 3, v12
    v_bfe_u32 v13, v0, 4, 1
    v_lshl_add_u32 v12, v13, 5, v12
    v_add_u32 v12, s87, v12
    v_bfe_u32 v13, v0, 3, 1
    v_lshlrev_b32 v13, 6, v13
    v_xor_b32 v12, v12, v13
    v_bfe_u32 v13, v0, 2, 2
    v_lshl_add_u32 v12, v13, 7, v12
    v_bfe_u32 v13, v0, 5, 1
    v_lshl_add_u32 v8, v13, 10, v12
    v_add_u32 v9, 0x10000, v8
    v_add_u32 v10, 0x20000, v8
    v_and_b32 v12, 31, v0
    v_lshlrev_b32 v17, 2, v12
    s_lshl_b32 s87, s74, 6
    v_add_u32 v12, s87, v12
    v_bfe_u32 v13, v12, 1, 3
    v_lshrrev_b32 v14, 5, v0
    v_xor_b32 v13, v13, v14
    v_lshlrev_b32 v15, 4, v13
    v_lshl_add_u32 v40, v12, 7, v15
    v_xor_b32 v41, 32, v40
    v_xor_b32 v42, 64, v40
    v_xor_b32 v43, 0x60, v40
    v_lshlrev_b32 v15, 3, v13
    v_lshl_add_u32 v12, v12, 6, v15
    s_mul_i32 s87, s75, 24576
    s_add_u32 s87, s87, 114688
    v_add_u32 v48, s87, v12
    v_xor_b32 v49, 16, v48
    v_xor_b32 v50, 32, v48
    v_xor_b32 v51, 48, v48
    v_mov_b32 v36, -1
    v_mov_b32 v37, -1
    v_mov_b32 v38, -1
    v_mov_b32 v39, -1
    v_mov_b32 v18, 0
    v_mov_b32 v21, 0xbdd2d3e8
    v_lshlrev_b32 v19, 7, v0
    s_lshl_b32 s88, s76, 1
    s_add_u32 s88, s88, s74
    s_lshl_b32 s89, s75, 11
    s_mul_i32 s58, s88, 229376
    s_add_u32 s58, s58, s89
    s_add_u32 s58, s58, 1048576
    s_lshl_b32 s90, s88, 16
    s_lshl_b32 s87, s93, 14
    s_add_u32 s90, s90, s87
    s_add_u32 s90, s90, s89
    s_add_u32 s90, s90, 8388608
    s_lshl_b32 s59, s76, 10
    s_lshl_b32 s87, s93, 2
    s_add_u32 s59, s59, s87
    s_add_u32 s59, s59, 4096
    s_lshl_b32 s87, s74, 2
    s_lshl_b32 s87, s87, 7
    s_add_u32 s87, s87, s59
    s_add_u32 s87, s87, 56
    s_lshl_b32 s89, s93, 5
    s_add_u32 s89, s89, s88
    s_lshl_b32 s89, s89, 1
    s_add_u32 s89, s89, s75
    s_lshl_b32 s89, s89, 8
    s_add_u32 s89, s89, 65536
    s_cmp_eq_u32 s77, 3
    s_cselect_b32 s58, s90, s58
    s_cselect_b32 s59, s87, s59
    s_cselect_b32 s78, s89, s78
    s_mul_i32 s87, s75, 1568
    s_add_u32 s87, s87, 147456
    v_bfe_u32 v12, v0, 2, 2
    v_lshrrev_b32 v13, 5, v0
    v_lshl_add_u32 v14, v13, 2, v12
    v_mul_u32_u24 v14, 56, v14
    v_and_b32 v15, 3, v0
    v_lshl_add_u32 v14, v15, 3, v14
    v_bfe_u32 v16, v0, 4, 1
    v_lshl_add_u32 v14, v16, 5, v14
    v_lshl_add_u32 v15, v16, 2, v15
    v_add_u32 v16, s87, v14
    v_lshl_add_u32 v14, v13, 3, v12
    v_lshlrev_b32 v14, 6, v14
    v_lshrrev_b32 v12, 1, v12
    v_lshl_add_u32 v12, v13, 2, v12
    v_xor_b32 v12, v12, v15
    v_lshl_add_u32 v14, v12, 3, v14
    s_mul_i32 s87, s75, 24576
    s_add_u32 s87, s87, 114688
    v_add_u32 v52, s87, v14
    v_xor_b32 v53, 16, v52
    v_add_u32 v53, 0x100, v53
    s_lshl_b32 s87, s74, 13
    s_add_u32 s87, s87, 8192
    v_add_u32 v54, s87, v52
    v_add_u32 v55, s87, v53
    v_and_b32 v12, 3, v0
    v_lshlrev_b32 v12, 3, v12
    v_bfe_u32 v13, v0, 4, 1
    v_lshl_add_u32 v12, v13, 5, v12
    v_bfe_u32 v13, v0, 3, 1
    v_lshl_add_u32 v12, v13, 6, v12
    v_bfe_u32 v13, v0, 2, 2
    v_lshl_add_u32 v12, v13, 7, v12
    v_bfe_u32 v13, v0, 5, 1
    v_lshl_add_u32 v12, v13, 9, v12
    v_add_u32 v24, s73, v12
    v_xor_b32 v27, 64, v24
    v_add_u32 v25, 0x10000, v24
    v_add_u32 v28, 0x10000, v27
    v_add_u32 v26, 0x20000, v24
    v_add_u32 v29, 0x20000, v27
    s_mul_i32 s61, s85, 229376
    s_lshl_b32 s87, s72, 10
    s_add_u32 s61, s61, s87
    s_add_u32 s61, s61, 1048576
    s_lshl_b32 s62, s85, 16
    s_add_u32 s62, s62, s73
    s_add_u32 s62, s62, 8388608
    s_lshl_b32 s60, s85, 2
    s_add_u32 s60, s60, s72
    s_lshl_b32 s60, s60, 7
    s_add_u32 s60, s60, 4096
    s_lshl_b32 s87, s85, 1
    s_add_u32 s87, s87, 1
    s_lshl_b32 s87, s87, 8
    s_add_u32 s87, s87, 65536
    v_add_u32 v23, s87, v17
    s_mul_i32 s87, s72, 12288
    v_add_u32 v33, s87, v1
    v_mul_u32_u24 v12, 224, v17
    v_lshrrev_b32 v13, 5, v0
    v_lshl_add_u32 v12, v13, 4, v12
    s_mul_i32 s87, s85, 57344
    s_lshl_b32 s88, s86, 7
    s_add_u32 s87, s87, s88
    s_lshl_b32 s88, s72, 5
    s_add_u32 s87, s87, s88
    v_add_u32 v34, s87, v12
    s_add_u32 s87, s86, s85
    s_and_b32 s88, s87, 3
    s_lshl_b32 s88, s88, 2
    s_mul_i32 s89, s87, 86
    s_lshr_b32 s89, s89, 8
    s_mul_i32 s89, s89, 3
    s_sub_u32 s89, s87, s89
    s_lshl_b32 s89, s89, 2
    s_lshr_b32 s52, 0x10210, s89
    s_lshr_b32 s53, 0x5436543, s88
    s_mul_i32 s89, s87, 43
    s_lshr_b32 s89, s89, 8
    s_mul_i32 s89, s89, 6
    s_sub_u32 s89, s87, s89
    s_lshl_b32 s89, s89, 2
    s_mov_b32 s54, 0x87cba987
    s_mov_b32 s55, 0xba9
    s_lshr_b64 s[54:55], s[54:55], s89
    s_lshr_b32 s55, 0x2103210, s88
    s_add_u32 m0, s73, 81920
    s_nop 0
    buffer_load_dwordx4 v4, s[32:35], s81 offen lds
    buffer_load_dwordx4 v5, s[32:35], s81 offen offset:1024 lds
    s_add_u32 m0, s73, 90112
    s_nop 0
    buffer_load_dwordx4 v4, s[36:39], s81 offen lds
    buffer_load_dwordx4 v5, s[36:39], s81 offen offset:1024 lds
    s_add_u32 s81, s81, s82
    s_cmp_eq_u32 s81, s83
    s_cselect_b32 s81, 0, s81
    s_waitcnt vmcnt(8)
    s_barrier
    v_add_u32 v44, 32768, v40
    ds_read_b128 a[0:3], v44
    ds_read_b64_tr_b16 v[64:65], v8 offset:49152
    ds_read_b64_tr_b16 v[66:67], v8 offset:49664
    ds_read_b128 a[112:115], v44 offset:4096
    ds_read_b64_tr_b16 v[68:69], v8 offset:57344
    ds_read_b64_tr_b16 v[70:71], v8 offset:57856
    v_add_u32 v45, 32768, v41
    ds_read_b128 a[4:7], v45
    ds_read_b64_tr_b16 v[72:73], v8 offset:51200
    ds_read_b64_tr_b16 v[74:75], v8 offset:51712
    ds_read_b128 a[116:119], v45 offset:4096
    ds_read_b64_tr_b16 v[76:77], v8 offset:59392
    ds_read_b64_tr_b16 v[78:79], v8 offset:59904
    s_waitcnt lgkmcnt(6)
    v_mfma_f32_32x32x16_bf16 v[128:143], v[64:67], a[0:3], 0
    v_add_u32 v44, 32768, v42
    ds_read_b128 a[8:11], v44
    ds_read_b64_tr_b16 v[80:81], v8 offset:53248
    s_add_u32 m0, s73, 114688
    s_nop 0
    buffer_load_dwordx4 v6, s[40:43], s84 offen lds
    v_mfma_f32_32x32x16_bf16 v[144:159], v[68:71], a[0:3], 0
    ds_read_b64_tr_b16 v[82:83], v8 offset:53760
    buffer_load_dwordx4 v7, s[40:43], s84 offen offset:1024 lds
    v_mfma_f32_32x32x16_bf16 v[160:175], v[64:67], a[112:115], 0
    ds_read_b128 a[120:123], v44 offset:4096
    ds_read_b64_tr_b16 v[84:85], v8 offset:61440
    s_add_u32 m0, s73, 122880
    s_nop 0
    buffer_load_dwordx4 v6, s[44:47], s84 offen lds
    v_mfma_f32_32x32x16_bf16 v[176:191], v[68:71], a[112:115], 0
    ds_read_b64_tr_b16 v[86:87], v8 offset:61952
    buffer_load_dwordx4 v7, s[44:47], s84 offen offset:1024 lds
    s_add_u32 s84, s84, 128
    s_cmp_eq_u32 s84, 896
    s_cselect_b32 s84, 0, s84
    s_waitcnt lgkmcnt(6)
    v_mfma_f32_32x32x16_bf16 v[128:143], v[72:75], a[4:7], v[128:143]
    v_add_u32 v45, 32768, v43
    ds_read_b128 a[12:15], v45
    ds_read_b64_tr_b16 v[88:89], v8 offset:55296
    s_add_u32 m0, s73, 131072
    s_nop 0
    buffer_load_dwordx4 v4, s[32:35], s81 offen lds
    v_mfma_f32_32x32x16_bf16 v[144:159], v[76:79], a[4:7], v[144:159]
    ds_read_b64_tr_b16 v[90:91], v8 offset:55808
    buffer_load_dwordx4 v5, s[32:35], s81 offen offset:1024 lds
    v_mfma_f32_32x32x16_bf16 v[160:175], v[72:75], a[116:119], v[160:175]
    ds_read_b128 a[124:127], v45 offset:4096
    ds_read_b64_tr_b16 v[92:93], v8 offset:63488
    s_add_u32 m0, s73, 139264
    s_nop 0
    buffer_load_dwordx4 v4, s[36:39], s81 offen lds
    v_mfma_f32_32x32x16_bf16 v[176:191], v[76:79], a[116:119], v[176:191]
    ds_read_b64_tr_b16 v[94:95], v8 offset:64000
    buffer_load_dwordx4 v5, s[36:39], s81 offen offset:1024 lds
    s_add_u32 s81, s81, s82
    s_cmp_eq_u32 s81, s83
    s_cselect_b32 s81, 0, s81
    s_waitcnt lgkmcnt(6)
    v_mfma_f32_32x32x16_bf16 v[128:143], v[80:83], a[8:11], v[128:143]
    s_waitcnt lgkmcnt(0)
    s_waitcnt vmcnt(8)
    s_barrier
    v_add_u32 v44, 65536, v40
    ds_read_b128 a[16:19], v44
    ds_read_b64_tr_b16 v[64:65], v9 offset:16384
    v_mfma_f32_32x32x16_bf16 v[144:159], v[84:87], a[8:11], v[144:159]
    ds_read_b64_tr_b16 v[66:67], v9 offset:16896
    s_add_u32 m0, s73, 0
    s_nop 0
    buffer_load_dwordx4 v6, s[40:43], s84 offen lds
    v_mfma_f32_32x32x16_bf16 v[160:175], v[80:83], a[120:123], v[160:175]
    ds_read_b128 a[128:131], v44 offset:4096
    ds_read_b64_tr_b16 v[68:69], v9 offset:24576
    buffer_load_dwordx4 v7, s[40:43], s84 offen offset:1024 lds
    v_mfma_f32_32x32x16_bf16 v[176:191], v[84:87], a[120:123], v[176:191]
    ds_read_b64_tr_b16 v[70:71], v9 offset:25088
    s_add_u32 m0, s73, 8192
    s_nop 0
    buffer_load_dwordx4 v6, s[44:47], s84 offen lds
    v_mfma_f32_32x32x16_bf16 v[128:143], v[88:91], a[12:15], v[128:143]
    v_add_u32 v45, 65536, v41
    ds_read_b128 a[20:23], v45
    ds_read_b64_tr_b16 v[72:73], v9 offset:18432
    buffer_load_dwordx4 v7, s[44:47], s84 offen offset:1024 lds
    s_add_u32 s84, s84, 128
    s_cmp_eq_u32 s84, 896
    s_cselect_b32 s84, 0, s84
    v_mfma_f32_32x32x16_bf16 v[144:159], v[92:95], a[12:15], v[144:159]
    ds_read_b64_tr_b16 v[74:75], v9 offset:18944
    v_mfma_f32_32x32x16_bf16 v[160:175], v[88:91], a[124:127], v[160:175]
    ds_read_b128 a[132:135], v45 offset:4096
    ds_read_b64_tr_b16 v[76:77], v9 offset:26624
    s_add_u32 m0, s73, 16384
    s_nop 0
    buffer_load_dwordx4 v4, s[32:35], s81 offen lds
    v_mfma_f32_32x32x16_bf16 v[176:191], v[92:95], a[124:127], v[176:191]
    ds_read_b64_tr_b16 v[78:79], v9 offset:27136
    buffer_load_dwordx4 v5, s[32:35], s81 offen offset:1024 lds
    s_waitcnt lgkmcnt(6)
    v_mfma_f32_32x32x16_bf16 v[128:143], v[64:67], a[16:19], v[128:143]
    v_add_u32 v44, 65536, v42
    ds_read_b128 a[24:27], v44
    ds_read_b64_tr_b16 v[80:81], v9 offset:20480
    s_add_u32 m0, s73, 24576
    s_nop 0
    buffer_load_dwordx4 v4, s[36:39], s81 offen lds
    v_mfma_f32_32x32x16_bf16 v[144:159], v[68:71], a[16:19], v[144:159]
    ds_read_b64_tr_b16 v[82:83], v9 offset:20992
    buffer_load_dwordx4 v5, s[36:39], s81 offen offset:1024 lds
    s_add_u32 s81, s81, s82
    s_cmp_eq_u32 s81, s83
    s_cselect_b32 s81, 0, s81
    v_mfma_f32_32x32x16_bf16 v[160:175], v[64:67], a[128:131], v[160:175]
    ds_read_b128 a[136:139], v44 offset:4096
    ds_read_b64_tr_b16 v[84:85], v9 offset:28672
    v_mfma_f32_32x32x16_bf16 v[176:191], v[68:71], a[128:131], v[176:191]
    ds_read_b64_tr_b16 v[86:87], v9 offset:29184
    s_add_u32 m0, s73, 32768
    s_nop 0
    buffer_load_dwordx4 v6, s[40:43], s84 offen lds
    s_waitcnt lgkmcnt(6)
    v_mfma_f32_32x32x16_bf16 v[128:143], v[72:75], a[20:23], v[128:143]
    v_add_u32 v45, 65536, v43
    ds_read_b128 a[28:31], v45
    ds_read_b64_tr_b16 v[88:89], v9 offset:22528
    buffer_load_dwordx4 v7, s[40:43], s84 offen offset:1024 lds
    v_mfma_f32_32x32x16_bf16 v[144:159], v[76:79], a[20:23], v[144:159]
    ds_read_b64_tr_b16 v[90:91], v9 offset:23040
    s_add_u32 m0, s73, 40960
    s_nop 0
    buffer_load_dwordx4 v6, s[44:47], s84 offen lds
    v_mfma_f32_32x32x16_bf16 v[160:175], v[72:75], a[132:135], v[160:175]
    ds_read_b128 a[140:143], v45 offset:4096
    ds_read_b64_tr_b16 v[92:93], v9 offset:30720
    buffer_load_dwordx4 v7, s[44:47], s84 offen offset:1024 lds
    s_add_u32 s84, s84, 128
    s_cmp_eq_u32 s84, 896
    s_cselect_b32 s84, 0, s84
    v_mfma_f32_32x32x16_bf16 v[176:191], v[76:79], a[132:135], v[176:191]
    ds_read_b64_tr_b16 v[94:95], v9 offset:31232
    s_waitcnt lgkmcnt(6)
    v_mfma_f32_32x32x16_bf16 v[128:143], v[80:83], a[24:27], v[128:143]
    s_waitcnt lgkmcnt(0)
    s_waitcnt vmcnt(12)
    s_barrier
    v_add_u32 v44, 114688, v40
    ds_read_b128 a[32:35], v44
    ds_read_b64_tr_b16 v[64:65], v10 offset:0
    v_mfma_f32_32x32x16_bf16 v[144:159], v[84:87], a[24:27], v[144:159]
    ds_read_b64_tr_b16 v[66:67], v10 offset:512
    s_add_u32 m0, s73, 49152
    s_nop 0
    buffer_load_dwordx4 v4, s[32:35], s81 offen lds
    v_mfma_f32_32x32x16_bf16 v[160:175], v[80:83], a[136:139], v[160:175]
    ds_read_b128 a[144:147], v44 offset:4096
    ds_read_b64_tr_b16 v[68:69], v10 offset:8192
    buffer_load_dwordx4 v5, s[32:35], s81 offen offset:1024 lds
    v_mfma_f32_32x32x16_bf16 v[176:191], v[84:87], a[136:139], v[176:191]
    ds_read_b64_tr_b16 v[70:71], v10 offset:8704
    s_add_u32 m0, s73, 57344
    s_nop 0
    buffer_load_dwordx4 v4, s[36:39], s81 offen lds
    v_mfma_f32_32x32x16_bf16 v[128:143], v[88:91], a[28:31], v[128:143]
    v_add_u32 v45, 114688, v41
    ds_read_b128 a[36:39], v45
    ds_read_b64_tr_b16 v[72:73], v10 offset:2048
    buffer_load_dwordx4 v5, s[36:39], s81 offen offset:1024 lds
    s_add_u32 s81, s81, s82
    s_cmp_eq_u32 s81, s83
    s_cselect_b32 s81, 0, s81
    v_mfma_f32_32x32x16_bf16 v[144:159], v[92:95], a[28:31], v[144:159]
    ds_read_b64_tr_b16 v[74:75], v10 offset:2560
    v_mfma_f32_32x32x16_bf16 v[160:175], v[88:91], a[140:143], v[160:175]
    ds_read_b128 a[148:151], v45 offset:4096
    ds_read_b64_tr_b16 v[76:77], v10 offset:10240
    s_add_u32 m0, s73, 65536
    s_nop 0
    buffer_load_dwordx4 v6, s[40:43], s84 offen lds
    v_mfma_f32_32x32x16_bf16 v[176:191], v[92:95], a[140:143], v[176:191]
    ds_read_b64_tr_b16 v[78:79], v10 offset:10752
    buffer_load_dwordx4 v7, s[40:43], s84 offen offset:1024 lds
    s_waitcnt lgkmcnt(6)
    v_mfma_f32_32x32x16_bf16 v[128:143], v[64:67], a[32:35], v[128:143]
    v_add_u32 v44, 114688, v42
    ds_read_b128 a[40:43], v44
    ds_read_b64_tr_b16 v[80:81], v10 offset:4096
    s_add_u32 m0, s73, 73728
    s_nop 0
    buffer_load_dwordx4 v6, s[44:47], s84 offen lds
    v_mfma_f32_32x32x16_bf16 v[144:159], v[68:71], a[32:35], v[144:159]
    ds_read_b64_tr_b16 v[82:83], v10 offset:4608
    buffer_load_dwordx4 v7, s[44:47], s84 offen offset:1024 lds
    s_add_u32 s84, s84, 128
    s_cmp_eq_u32 s84, 896
    s_cselect_b32 s84, 0, s84
    v_mfma_f32_32x32x16_bf16 v[160:175], v[64:67], a[144:147], v[160:175]
    ds_read_b128 a[152:155], v44 offset:4096
    ds_read_b64_tr_b16 v[84:85], v10 offset:12288
    v_mfma_f32_32x32x16_bf16 v[176:191], v[68:71], a[144:147], v[176:191]
    ds_read_b64_tr_b16 v[86:87], v10 offset:12800
    s_add_u32 m0, s73, 81920
    s_nop 0
    buffer_load_dwordx4 v4, s[32:35], s81 offen lds
    s_waitcnt lgkmcnt(6)
    v_mfma_f32_32x32x16_bf16 v[128:143], v[72:75], a[36:39], v[128:143]
    v_add_u32 v45, 114688, v43
    ds_read_b128 a[44:47], v45
    ds_read_b64_tr_b16 v[88:89], v10 offset:6144
    buffer_load_dwordx4 v5, s[32:35], s81 offen offset:1024 lds
    v_mfma_f32_32x32x16_bf16 v[144:159], v[76:79], a[36:39], v[144:159]
    ds_read_b64_tr_b16 v[90:91], v10 offset:6656
    s_add_u32 m0, s73, 90112
    s_nop 0
    buffer_load_dwordx4 v4, s[36:39], s81 offen lds
    v_mfma_f32_32x32x16_bf16 v[160:175], v[72:75], a[148:151], v[160:175]
    ds_read_b128 a[156:159], v45 offset:4096
    ds_read_b64_tr_b16 v[92:93], v10 offset:14336
    buffer_load_dwordx4 v5, s[36:39], s81 offen offset:1024 lds
    s_add_u32 s81, s81, s82
    s_cmp_eq_u32 s81, s83
    s_cselect_b32 s81, 0, s81
    v_mfma_f32_32x32x16_bf16 v[176:191], v[76:79], a[148:151], v[176:191]
    ds_read_b64_tr_b16 v[94:95], v10 offset:14848
    s_waitcnt lgkmcnt(6)
    v_mfma_f32_32x32x16_bf16 v[128:143], v[80:83], a[40:43], v[128:143]
    s_waitcnt lgkmcnt(0)
    s_waitcnt vmcnt(16)
    s_barrier
    v_add_u32 v44, 0, v40
    ds_read_b128 a[48:51], v44
    ds_read_b64_tr_b16 v[64:65], v8 offset:16384
    v_mfma_f32_32x32x16_bf16 v[144:159], v[84:87], a[40:43], v[144:159]
    ds_read_b64_tr_b16 v[66:67], v8 offset:16896
    v_mov_b32 v13, 0
    global_load_dword v22, v13, s[24:25] sc1
    v_mfma_f32_32x32x16_bf16 v[160:175], v[80:83], a[152:155], v[160:175]
    ds_read_b128 a[160:163], v44 offset:4096
    ds_read_b64_tr_b16 v[68:69], v8 offset:24576
    s_lshl_b32 s87, s72, 12
    s_add_u32 m0, s87, 147456
    s_nop 0
    buffer_load_dwordx4 v1, s[48:51], s87 offen offset:0 lds
    buffer_load_dwordx4 v1, s[48:51], s87 offen offset:1024 lds
    buffer_load_dwordx4 v1, s[48:51], s87 offen offset:2048 lds
    buffer_load_dwordx4 v1, s[48:51], s87 offen offset:3072 lds
    s_cmp_lg_u32 s72, 3
    s_cbranch_scc1 Lnogw
    s_mov_b64 s[48:49], s[20:21]
    s_movk_i32 s50, 896
    s_mov_b32 m0, 161792
    s_nop 0
    buffer_load_dwordx4 v1, s[48:51], 0 offen lds
Lnogw:
    v_mfma_f32_32x32x16_bf16 v[176:191], v[84:87], a[152:155], v[176:191]
    ds_read_b64_tr_b16 v[70:71], v8 offset:25088
    s_add_u32 m0, s73, 114688
    s_nop 0
    buffer_load_dwordx4 v6, s[40:43], s84 offen lds
    v_mfma_f32_32x32x16_bf16 v[128:143], v[88:91], a[44:47], v[128:143]
    v_add_u32 v45, 0, v41
    ds_read_b128 a[52:55], v45
    ds_read_b64_tr_b16 v[72:73], v8 offset:18432
    v_mfma_f32_32x32x16_bf16 v[144:159], v[92:95], a[44:47], v[144:159]
    ds_read_b64_tr_b16 v[74:75], v8 offset:18944
    buffer_load_dwordx4 v7, s[40:43], s84 offen offset:1024 lds
    v_mfma_f32_32x32x16_bf16 v[160:175], v[88:91], a[156:159], v[160:175]
    ds_read_b128 a[164:167], v45 offset:4096
    ds_read_b64_tr_b16 v[76:77], v8 offset:26624
    s_add_u32 m0, s73, 122880
    s_nop 0
    buffer_load_dwordx4 v6, s[44:47], s84 offen lds
    v_mfma_f32_32x32x16_bf16 v[176:191], v[92:95], a[156:159], v[176:191]
    ds_read_b64_tr_b16 v[78:79], v8 offset:27136
    buffer_load_dwordx4 v7, s[44:47], s84 offen offset:1024 lds
    s_add_u32 s84, s84, 128
    s_cmp_eq_u32 s84, 896
    s_cselect_b32 s84, 0, s84
    s_waitcnt lgkmcnt(6)
    v_mfma_f32_32x32x16_bf16 v[128:143], v[64:67], a[48:51], v[128:143]
    v_add_u32 v44, 0, v42
    ds_read_b128 a[56:59], v44
    ds_read_b64_tr_b16 v[80:81], v8 offset:20480
    v_mfma_f32_32x32x16_bf16 v[144:159], v[68:71], a[48:51], v[144:159]
    ds_read_b64_tr_b16 v[82:83], v8 offset:20992
    s_add_u32 m0, s73, 131072
    s_nop 0
    buffer_load_dwordx4 v4, s[32:35], s81 offen lds
    v_mfma_f32_32x32x16_bf16 v[160:175], v[64:67], a[160:163], v[160:175]
    ds_read_b128 a[168:171], v44 offset:4096
    ds_read_b64_tr_b16 v[84:85], v8 offset:28672
    buffer_load_dwordx4 v5, s[32:35], s81 offen offset:1024 lds
    v_mfma_f32_32x32x16_bf16 v[176:191], v[68:71], a[160:163], v[176:191]
    ds_read_b64_tr_b16 v[86:87], v8 offset:29184
    s_add_u32 m0, s73, 139264
    s_nop 0
    buffer_load_dwordx4 v4, s[36:39], s81 offen lds
    s_waitcnt lgkmcnt(6)
    v_mfma_f32_32x32x16_bf16 v[128:143], v[72:75], a[52:55], v[128:143]
    v_add_u32 v45, 0, v43
    ds_read_b128 a[60:63], v45
    ds_read_b64_tr_b16 v[88:89], v8 offset:22528
    v_mfma_f32_32x32x16_bf16 v[144:159], v[76:79], a[52:55], v[144:159]
    ds_read_b64_tr_b16 v[90:91], v8 offset:23040
    buffer_load_dwordx4 v5, s[36:39], s81 offen offset:1024 lds
    s_add_u32 s81, s81, s82
    s_cmp_eq_u32 s81, s83
    s_cselect_b32 s81, 0, s81
    v_mfma_f32_32x32x16_bf16 v[160:175], v[72:75], a[164:167], v[160:175]
    ds_read_b128 a[172:175], v45 offset:4096
    ds_read_b64_tr_b16 v[92:93], v8 offset:30720
    s_and_b32 s87, s77, 3
    s_cmp_lg_u32 s87, 2
    s_cbranch_scc1 Lnoet
    s_cmp_lg_u32 s72, 3
    s_cbranch_scc1 Lnoet
    s_and_b32 s87, s78, 7
    s_lshl_b32 s88, s76, 3
    s_add_u32 s87, s87, s88
    s_bitcmp0_b32 s87, 0
    s_cselect_b64 s[48:49], s[14:15], s[16:17]
    s_mov_b32 s50, 1605632
    s_lshr_b32 s87, s87, 1
    s_mul_i32 s87, s87, 28672
    v_lshrrev_b32 v12, 3, v0
    v_mul_u32_u24 v12, 3584, v12
    v_and_b32 v13, 7, v0
    v_lshl_add_u32 v12, v13, 7, v12
    buffer_load_dword v20, v12, s[48:51], s87 offen offset:2560
Lnoet:
    v_mfma_f32_32x32x16_bf16 v[176:191], v[76:79], a[164:167], v[176:191]
    ds_read_b64_tr_b16 v[94:95], v8 offset:31232
    s_waitcnt lgkmcnt(6)
    v_mfma_f32_32x32x16_bf16 v[128:143], v[80:83], a[56:59], v[128:143]
    s_waitcnt lgkmcnt(0)
    s_waitcnt vmcnt(21)
    s_barrier
    v_add_u32 v44, 32768, v40
    ds_read_b128 a[64:67], v44
    ds_read_b64_tr_b16 v[64:65], v8 offset:49152
    v_mfma_f32_32x32x16_bf16 v[144:159], v[84:87], a[56:59], v[144:159]
    ds_read_b64_tr_b16 v[66:67], v8 offset:49664
    s_cmp_eq_u32 s77, 3
    s_cbranch_scc1 Lswq
    s_bfe_u32 s87, s78, 0x80008
    s_lshl_b32 s87, s87, 7
    s_add_u32 s32, s14, s87
    s_addc_u32 s33, s15, 0
    s_add_u32 s36, s16, s87
    s_addc_u32 s37, s17, 0
    s_sub_u32 s34, 1605632, s87
    s_mov_b32 s38, s34
    s_movk_i32 s87, 3584
    v_mad_u32_u24 v4, v2, s87, v3
    v_add_u32 v5, 27648, v4
    s_mov_b32 s82, 229376
    s_mul_i32 s81, s80, s82
    s_mov_b32 s83, 1605632
    s_branch Lswd
Lswq:
    s_add_u32 s32, s32, 224
    s_addc_u32 s33, s33, 0
    s_add_u32 s36, s36, 224
    s_addc_u32 s37, s37, 0
    s_sub_u32 s34, s34, 224
    s_sub_u32 s38, s38, 224
Lswd:
    v_mfma_f32_32x32x16_bf16 v[160:175], v[80:83], a[168:171], v[160:175]
    ds_read_b128 a[176:179], v44 offset:4096
    ds_read_b64_tr_b16 v[68:69], v8 offset:57344
    s_add_u32 m0, s73, 0
    s_nop 0
    buffer_load_dwordx4 v4, s[32:35], s81 offen lds
    v_mfma_f32_32x32x16_bf16 v[176:191], v[84:87], a[168:171], v[176:191]
    ds_read_b64_tr_b16 v[70:71], v8 offset:57856
    v_mfma_f32_32x32x16_bf16 v[128:143], v[88:91], a[60:63], v[128:143]
    v_add_u32 v45, 32768, v41
    ds_read_b128 a[68:71], v45
    ds_read_b64_tr_b16 v[72:73], v8 offset:51200
    buffer_load_dwordx4 v5, s[32:35], s81 offen offset:1024 lds
    v_mfma_f32_32x32x16_bf16 v[144:159], v[92:95], a[60:63], v[144:159]
    ds_read_b64_tr_b16 v[74:75], v8 offset:51712
    v_mfma_f32_32x32x16_bf16 v[160:175], v[88:91], a[172:175], v[160:175]
    ds_read_b128 a[180:183], v45 offset:4096
    ds_read_b64_tr_b16 v[76:77], v8 offset:59392
    s_add_u32 m0, s73, 8192
    s_nop 0
    buffer_load_dwordx4 v4, s[36:39], s81 offen lds
    v_mfma_f32_32x32x16_bf16 v[176:191], v[92:95], a[172:175], v[176:191]
    ds_read_b64_tr_b16 v[78:79], v8 offset:59904
    buffer_load_dwordx4 v5, s[36:39], s81 offen offset:1024 lds
    s_add_u32 s81, s81, s82
    s_cmp_eq_u32 s81, s83
    s_cselect_b32 s81, 0, s81
    s_waitcnt lgkmcnt(6)
    v_mfma_f32_32x32x16_bf16 v[128:143], v[64:67], a[64:67], v[128:143]
    v_add_u32 v44, 32768, v42
    ds_read_b128 a[72:75], v44
    ds_read_b64_tr_b16 v[80:81], v8 offset:53248
    v_mfma_f32_32x32x16_bf16 v[144:159], v[68:71], a[64:67], v[144:159]
    ds_read_b64_tr_b16 v[82:83], v8 offset:53760
    s_add_u32 m0, s73, 16384
    s_nop 0
    buffer_load_dwordx4 v4, s[32:35], s81 offen lds
    v_mfma_f32_32x32x16_bf16 v[160:175], v[64:67], a[176:179], v[160:175]
    ds_read_b128 a[184:187], v44 offset:4096
    ds_read_b64_tr_b16 v[84:85], v8 offset:61440
    v_mfma_f32_32x32x16_bf16 v[176:191], v[68:71], a[176:179], v[176:191]
    ds_read_b64_tr_b16 v[86:87], v8 offset:61952
    buffer_load_dwordx4 v5, s[32:35], s81 offen offset:1024 lds
    s_waitcnt lgkmcnt(6)
    v_mfma_f32_32x32x16_bf16 v[128:143], v[72:75], a[68:71], v[128:143]
    v_add_u32 v45, 32768, v43
    ds_read_b128 a[76:79], v45
    ds_read_b64_tr_b16 v[88:89], v8 offset:55296
    s_add_u32 m0, s73, 24576
    s_nop 0
    buffer_load_dwordx4 v4, s[36:39], s81 offen lds
    v_mfma_f32_32x32x16_bf16 v[144:159], v[76:79], a[68:71], v[144:159]
    ds_read_b64_tr_b16 v[90:91], v8 offset:55808
    v_mfma_f32_32x32x16_bf16 v[160:175], v[72:75], a[180:183], v[160:175]
    ds_read_b128 a[188:191], v45 offset:4096
    ds_read_b64_tr_b16 v[92:93], v8 offset:63488
    buffer_load_dwordx4 v5, s[36:39], s81 offen offset:1024 lds
    s_add_u32 s81, s81, s82
    s_cmp_eq_u32 s81, s83
    s_cselect_b32 s81, 0, s81
    v_mfma_f32_32x32x16_bf16 v[176:191], v[76:79], a[180:183], v[176:191]
    ds_read_b64_tr_b16 v[94:95], v8 offset:64000
    s_waitcnt lgkmcnt(6)
    v_mfma_f32_32x32x16_bf16 v[128:143], v[80:83], a[72:75], v[128:143]
    s_waitcnt lgkmcnt(0)
    s_waitcnt vmcnt(21)
    s_barrier
    v_add_u32 v44, 65536, v40
    ds_read_b128 a[80:83], v44
    ds_read_b64_tr_b16 v[64:65], v9 offset:16384
    v_mfma_f32_32x32x16_bf16 v[144:159], v[84:87], a[72:75], v[144:159]
    ds_read_b64_tr_b16 v[66:67], v9 offset:16896
    s_add_u32 m0, s73, 32768
    s_nop 0
    buffer_load_dwordx4 v4, s[32:35], s81 offen lds
    v_mfma_f32_32x32x16_bf16 v[160:175], v[80:83], a[184:187], v[160:175]
    ds_read_b128 a[192:195], v44 offset:4096
    ds_read_b64_tr_b16 v[68:69], v9 offset:24576
    buffer_load_dwordx4 v5, s[32:35], s81 offen offset:1024 lds
    v_mfma_f32_32x32x16_bf16 v[176:191], v[84:87], a[184:187], v[176:191]
    ds_read_b64_tr_b16 v[70:71], v9 offset:25088
    v_mfma_f32_32x32x16_bf16 v[128:143], v[88:91], a[76:79], v[128:143]
    v_add_u32 v45, 65536, v41
    ds_read_b128 a[84:87], v45
    ds_read_b64_tr_b16 v[72:73], v9 offset:18432
    s_add_u32 m0, s73, 40960
    s_nop 0
    buffer_load_dwordx4 v4, s[36:39], s81 offen lds
    v_mfma_f32_32x32x16_bf16 v[144:159], v[92:95], a[76:79], v[144:159]
    ds_read_b64_tr_b16 v[74:75], v9 offset:18944
    v_mfma_f32_32x32x16_bf16 v[160:175], v[88:91], a[188:191], v[160:175]
    ds_read_b128 a[196:199], v45 offset:4096
    ds_read_b64_tr_b16 v[76:77], v9 offset:26624
    buffer_load_dwordx4 v5, s[36:39], s81 offen offset:1024 lds
    s_add_u32 s81, s81, s82
    s_cmp_eq_u32 s81, s83
    s_cselect_b32 s81, 0, s81
    v_mfma_f32_32x32x16_bf16 v[176:191], v[92:95], a[188:191], v[176:191]
    ds_read_b64_tr_b16 v[78:79], v9 offset:27136
    s_waitcnt lgkmcnt(6)
    v_mfma_f32_32x32x16_bf16 v[128:143], v[64:67], a[80:83], v[128:143]
    v_add_u32 v44, 65536, v42
    ds_read_b128 a[88:91], v44
    ds_read_b64_tr_b16 v[80:81], v9 offset:20480
    s_add_u32 m0, s73, 49152
    s_nop 0
    buffer_load_dwordx4 v4, s[32:35], s81 offen lds
    v_mfma_f32_32x32x16_bf16 v[144:159], v[68:71], a[80:83], v[144:159]
    ds_read_b64_tr_b16 v[82:83], v9 offset:20992
    v_mfma_f32_32x32x16_bf16 v[160:175], v[64:67], a[192:195], v[160:175]
    ds_read_b128 a[200:203], v44 offset:4096
    ds_read_b64_tr_b16 v[84:85], v9 offset:28672
    buffer_load_dwordx4 v5, s[32:35], s81 offen offset:1024 lds
    v_mfma_f32_32x32x16_bf16 v[176:191], v[68:71], a[192:195], v[176:191]
    ds_read_b64_tr_b16 v[86:87], v9 offset:29184
    s_waitcnt lgkmcnt(6)
    v_mfma_f32_32x32x16_bf16 v[128:143], v[72:75], a[84:87], v[128:143]
    v_add_u32 v45, 65536, v43
    ds_read_b128 a[92:95], v45
    ds_read_b64_tr_b16 v[88:89], v9 offset:22528
    s_add_u32 m0, s73, 57344
    s_nop 0
    buffer_load_dwordx4 v4, s[36:39], s81 offen lds
    v_mfma_f32_32x32x16_bf16 v[144:159], v[76:79], a[84:87], v[144:159]
    ds_read_b64_tr_b16 v[90:91], v9 offset:23040
    v_mfma_f32_32x32x16_bf16 v[160:175], v[72:75], a[196:199], v[160:175]
    ds_read_b128 a[204:207], v45 offset:4096
    ds_read_b64_tr_b16 v[92:93], v9 offset:30720
    buffer_load_dwordx4 v5, s[36:39], s81 offen offset:1024 lds
    s_add_u32 s81, s81, s82
    s_cmp_eq_u32 s81, s83
    s_cselect_b32 s81, 0, s81
    v_mfma_f32_32x32x16_bf16 v[176:191], v[76:79], a[196:199], v[176:191]
    ds_read_b64_tr_b16 v[94:95], v9 offset:31232
    s_waitcnt lgkmcnt(6)
    v_mfma_f32_32x32x16_bf16 v[128:143], v[80:83], a[88:91], v[128:143]
    s_waitcnt lgkmcnt(0)
    s_waitcnt vmcnt(16)
    s_barrier
    v_add_u32 v44, 114688, v40
    ds_read_b128 a[96:99], v44
    ds_read_b64_tr_b16 v[64:65], v10 offset:0
    v_mfma_f32_32x32x16_bf16 v[144:159], v[84:87], a[88:91], v[144:159]
    ds_read_b64_tr_b16 v[66:67], v10 offset:512
    s_add_u32 m0, s73, 65536
    s_nop 0
    buffer_load_dwordx4 v4, s[32:35], s81 offen lds
    v_mfma_f32_32x32x16_bf16 v[160:175], v[80:83], a[200:203], v[160:175]
    ds_read_b128 a[208:211], v44 offset:4096
    ds_read_b64_tr_b16 v[68:69], v10 offset:8192
    buffer_load_dwordx4 v5, s[32:35], s81 offen offset:1024 lds
    v_mfma_f32_32x32x16_bf16 v[176:191], v[84:87], a[200:203], v[176:191]
    ds_read_b64_tr_b16 v[70:71], v10 offset:8704
    v_mfma_f32_32x32x16_bf16 v[128:143], v[88:91], a[92:95], v[128:143]
    v_add_u32 v45, 114688, v41
    ds_read_b128 a[100:103], v45
    ds_read_b64_tr_b16 v[72:73], v10 offset:2048
    s_add_u32 m0, s73, 73728
    s_nop 0
    buffer_load_dwordx4 v4, s[36:39], s81 offen lds
    v_mfma_f32_32x32x16_bf16 v[144:159], v[92:95], a[92:95], v[144:159]
    ds_read_b64_tr_b16 v[74:75], v10 offset:2560
    v_mfma_f32_32x32x16_bf16 v[160:175], v[88:91], a[204:207], v[160:175]
    ds_read_b128 a[212:215], v45 offset:4096
    ds_read_b64_tr_b16 v[76:77], v10 offset:10240
    buffer_load_dwordx4 v5, s[36:39], s81 offen offset:1024 lds
    s_add_u32 s81, s81, s82
    s_cmp_eq_u32 s81, s83
    s_cselect_b32 s81, 0, s81
    v_mfma_f32_32x32x16_bf16 v[176:191], v[92:95], a[204:207], v[176:191]
    ds_read_b64_tr_b16 v[78:79], v10 offset:10752
    s_waitcnt lgkmcnt(6)
    v_mfma_f32_32x32x16_bf16 v[128:143], v[64:67], a[96:99], v[128:143]
    v_add_u32 v44, 114688, v42
    ds_read_b128 a[104:107], v44
    ds_read_b64_tr_b16 v[80:81], v10 offset:4096
    s_add_u32 m0, s73, 81920
    s_nop 0
    buffer_load_dwordx4 v4, s[32:35], s81 offen lds
    v_mfma_f32_32x32x16_bf16 v[144:159], v[68:71], a[96:99], v[144:159]
    ds_read_b64_tr_b16 v[82:83], v10 offset:4608
    v_mfma_f32_32x32x16_bf16 v[160:175], v[64:67], a[208:211], v[160:175]
    ds_read_b128 a[216:219], v44 offset:4096
    ds_read_b64_tr_b16 v[84:85], v10 offset:12288
    buffer_load_dwordx4 v5, s[32:35], s81 offen offset:1024 lds
    v_mfma_f32_32x32x16_bf16 v[176:191], v[68:71], a[208:211], v[176:191]
    ds_read_b64_tr_b16 v[86:87], v10 offset:12800
    ds_read_b64_tr_b16 v[112:113], v16 offset:0
    ds_read_b64_tr_b16 v[114:115], v16 offset:448
    ds_read_b64_tr_b16 v[116:117], v16 offset:896
    ds_read_b64_tr_b16 v[118:119], v16 offset:1344
    s_waitcnt lgkmcnt(10)
    v_mfma_f32_32x32x16_bf16 v[128:143], v[72:75], a[100:103], v[128:143]
    v_add_u32 v45, 114688, v43
    ds_read_b128 a[108:111], v45
    ds_read_b64_tr_b16 v[88:89], v10 offset:6144
    s_add_u32 m0, s73, 90112
    s_nop 0
    buffer_load_dwordx4 v4, s[36:39], s81 offen lds
    v_mfma_f32_32x32x16_bf16 v[144:159], v[76:79], a[100:103], v[144:159]
    ds_read_b64_tr_b16 v[90:91], v10 offset:6656
    v_mfma_f32_32x32x16_bf16 v[160:175], v[72:75], a[212:215], v[160:175]
    ds_read_b128 a[220:223], v45 offset:4096
    ds_read_b64_tr_b16 v[92:93], v10 offset:14336
    buffer_load_dwordx4 v5, s[36:39], s81 offen offset:1024 lds
    s_add_u32 s81, s81, s82
    s_cmp_eq_u32 s81, s83
    s_cselect_b32 s81, 0, s81
    v_mfma_f32_32x32x16_bf16 v[176:191], v[76:79], a[212:215], v[176:191]
    ds_read_b64_tr_b16 v[94:95], v10 offset:14848
    ds_read_b64_tr_b16 v[120:121], v16 offset:3136
    ds_read_b64_tr_b16 v[122:123], v16 offset:3584
    ds_read_b64_tr_b16 v[124:125], v16 offset:4032
    ds_read_b64_tr_b16 v[126:127], v16 offset:4480
    s_waitcnt lgkmcnt(10)
    v_mfma_f32_32x32x16_bf16 v[128:143], v[80:83], a[104:107], v[128:143]
    s_waitcnt lgkmcnt(0)
    s_waitcnt vmcnt(20)
    s_barrier
    ds_read_b64_tr_b16 v[64:65], v8 offset:0
    v_mfma_f32_32x32x16_bf16 v[144:159], v[84:87], a[104:107], v[144:159]
    ds_read_b64_tr_b16 v[66:67], v8 offset:512
    v_mfma_f32_32x32x16_bf16 v[160:175], v[80:83], a[216:219], v[160:175]
    ds_read_b64_tr_b16 v[68:69], v8 offset:8192
    v_mfma_f32_32x32x16_bf16 v[176:191], v[84:87], a[216:219], v[176:191]
    ds_read_b64_tr_b16 v[70:71], v8 offset:8704
    v_mfma_f32_32x32x16_bf16 v[128:143], v[88:91], a[108:111], v[128:143]
    ds_read_b64_tr_b16 v[72:73], v8 offset:2048
    v_mfma_f32_32x32x16_bf16 v[144:159], v[92:95], a[108:111], v[144:159]
    ds_read_b64_tr_b16 v[74:75], v8 offset:2560
    v_mfma_f32_32x32x16_bf16 v[160:175], v[88:91], a[220:223], v[160:175]
    ds_read_b64_tr_b16 v[76:77], v8 offset:10240
    v_mfma_f32_32x32x16_bf16 v[176:191], v[92:95], a[220:223], v[176:191]
    ds_read_b64_tr_b16 v[78:79], v8 offset:10752
    v_readfirstlane_b32 s79, v22
    s_mov_b32 s92, 0x8000
Ltagchk:
    s_cmp_lg_u32 s79, 0
    s_cbranch_scc1 Ltagok
    v_mov_b32 v13, 0
    global_load_dword v22, v13, s[24:25] sc1
    s_waitcnt vmcnt(0)
    v_readfirstlane_b32 s79, v22
    s_sub_u32 s92, s92, 1
    s_cmp_lg_u32 s92, 0
    s_cbranch_scc1 Ltagchk
Ltagok:
    s_cmp_lg_u32 s77, 0x15
    s_cbranch_scc1 Lother
    s_bfe_u32 s87, s78, 0x80000
    s_lshl_b32 s87, s87, 12
    s_add_u32 s57, s87, s58
    s_waitcnt lgkmcnt(4)
    v_mfma_f32_32x32x16_bf16 v[192:207], v[64:67], a[0:3], 0
    ds_read_b64_tr_b16 v[80:81], v8 offset:4096
    s_add_u32 m0, s73, 98304
    s_nop 0
    buffer_load_dwordx4 v4, s[32:35], s81 offen lds
    v_mfma_f32_32x32x16_bf16 v[208:223], v[68:71], a[0:3], 0
    ds_read_b64_tr_b16 v[82:83], v8 offset:4608
    buffer_load_dwordx4 v5, s[32:35], s81 offen offset:1024 lds
    v_mfma_f32_32x32x16_bf16 v[224:239], v[64:67], a[112:115], 0
    ds_read_b64_tr_b16 v[84:85], v8 offset:12288
    s_bfe_u32 s87, s78, 0x80008
    s_lshl_b32 s87, s87, 12
    s_add_u32 s48, s87, s58
    buffer_store_dwordx4 v[36:39], v1, s[28:31], s48 offen offset:0 sc1
    v_mfma_f32_32x32x16_bf16 v[240:255], v[68:71], a[112:115], 0
    ds_read_b64_tr_b16 v[86:87], v8 offset:12800
    s_add_u32 m0, s73, 106496
    s_nop 0
    buffer_load_dwordx4 v4, s[36:39], s81 offen lds
    s_waitcnt lgkmcnt(4)
    v_mfma_f32_32x32x16_bf16 v[192:207], v[72:75], a[4:7], v[192:207]
    ds_read_b64_tr_b16 v[88:89], v8 offset:6144
    buffer_load_dwordx4 v5, s[36:39], s81 offen offset:1024 lds
    s_add_u32 s81, s81, s82
    s_cmp_eq_u32 s81, s83
    s_cselect_b32 s81, 0, s81
    v_mul_f32 v96, v128, v128
    v_mul_f32 v144, v128, v144
    v_fmaak_f32 v96, v21, v96, 0xc0135761
    v_mfma_f32_32x32x16_bf16 v[208:223], v[76:79], a[4:7], v[208:223]
    ds_read_b64_tr_b16 v[90:91], v8 offset:6656
    v_mul_f32 v97, v129, v129
    v_mul_f32 v145, v129, v145
    v_mul_f32 v128, v96, v128
    v_mfma_f32_32x32x16_bf16 v[224:239], v[72:75], a[116:119], v[224:239]
    ds_read_b64_tr_b16 v[92:93], v8 offset:14336
    s_bfe_u32 s87, s78, 0x80010
    s_lshl_b32 s87, s87, 7
    s_add_u32 s32, s14, s87
    s_addc_u32 s33, s15, 0
    s_add_u32 s36, s16, s87
    s_addc_u32 s37, s17, 0
    s_sub_u32 s34, 1605632, s87
    s_mov_b32 s38, s34
    v_fmaak_f32 v97, v21, v97, 0xc0135761
    v_mul_f32 v98, v130, v130
    v_mul_f32 v146, v130, v146
    v_mfma_f32_32x32x16_bf16 v[240:255], v[76:79], a[116:119], v[240:255]
    ds_read_b64_tr_b16 v[94:95], v8 offset:14848
    v_exp_f32 v128, v128
    v_mul_f32 v129, v97, v129
    v_fmaak_f32 v98, v21, v98, 0xc0135761
    s_waitcnt lgkmcnt(4)
    v_mfma_f32_32x32x16_bf16 v[192:207], v[80:83], a[8:11], v[192:207]
    s_waitcnt lgkmcnt(0)
    s_waitcnt vmcnt(21)
    s_barrier
    ds_read_b64_tr_b16 v[64:65], v8 offset:16384
    v_mul_f32 v99, v131, v131
    v_mul_f32 v147, v131, v147
    v_mfma_f32_32x32x16_bf16 v[208:223], v[84:87], a[8:11], v[208:223]
    ds_read_b64_tr_b16 v[66:67], v8 offset:16896
    s_add_u32 m0, s73, 0
    s_nop 0
    buffer_load_dwordx4 v4, s[32:35], s81 offen lds
    buffer_store_dwordx4 v[36:39], v1, s[28:31], s48 offen offset:1024 sc1
    v_add_f32 v128, 1.0, v128
    v_exp_f32 v129, v129
    v_mul_f32 v130, v98, v130
    v_mfma_f32_32x32x16_bf16 v[224:239], v[80:83], a[120:123], v[224:239]
    ds_read_b64_tr_b16 v[68:69], v8 offset:24576
    v_fmaak_f32 v99, v21, v99, 0xc0135761
    v_mul_f32 v100, v132, v132
    v_mul_f32 v148, v132, v148
    v_mfma_f32_32x32x16_bf16 v[240:255], v[84:87], a[120:123], v[240:255]
    ds_read_b64_tr_b16 v[70:71], v8 offset:25088
    v_rcp_f32 v128, v128
    v_add_f32 v129, 1.0, v129
    v_exp_f32 v130, v130
    v_mfma_f32_32x32x16_bf16 v[192:207], v[88:91], a[12:15], v[192:207]
    ds_read_b64_tr_b16 v[72:73], v8 offset:18432
    buffer_load_dwordx4 v5, s[32:35], s81 offen offset:1024 lds
    v_mul_f32 v131, v99, v131
    v_fmaak_f32 v100, v21, v100, 0xc0135761
    v_mfma_f32_32x32x16_bf16 v[208:223], v[92:95], a[12:15], v[208:223]
    ds_read_b64_tr_b16 v[74:75], v8 offset:18944
    v_mul_f32 v101, v133, v133
    v_mul_f32 v149, v133, v149
    v_mul_f32 v144, v144, v128
    v_mfma_f32_32x32x16_bf16 v[224:239], v[88:91], a[124:127], v[224:239]
    ds_read_b64_tr_b16 v[76:77], v8 offset:26624
    v_rcp_f32 v129, v129
    v_add_f32 v130, 1.0, v130
    v_exp_f32 v131, v131
    v_mfma_f32_32x32x16_bf16 v[240:255], v[92:95], a[124:127], v[240:255]
    ds_read_b64_tr_b16 v[78:79], v8 offset:27136
    v_mul_f32 v132, v100, v132
    v_fmaak_f32 v101, v21, v101, 0xc0135761
    v_mul_f32 v102, v134, v134
    s_waitcnt lgkmcnt(4)
    v_mfma_f32_32x32x16_bf16 v[192:207], v[64:67], a[16:19], v[192:207]
    ds_read_b64_tr_b16 v[80:81], v8 offset:20480
    s_add_u32 m0, s73, 8192
    s_nop 0
    buffer_load_dwordx4 v4, s[36:39], s81 offen lds
    s_add_u32 s48, s48, 114688
    buffer_store_dwordx4 v[36:39], v1, s[28:31], s48 offen offset:0 sc1
    v_mul_f32 v150, v134, v150
    v_mul_f32 v145, v145, v129
    v_mfma_f32_32x32x16_bf16 v[208:223], v[68:71], a[16:19], v[208:223]
    ds_read_b64_tr_b16 v[82:83], v8 offset:20992
    v_rcp_f32 v130, v130
    v_add_f32 v131, 1.0, v131
    v_exp_f32 v132, v132
    v_mfma_f32_32x32x16_bf16 v[224:239], v[64:67], a[128:131], v[224:239]
    ds_read_b64_tr_b16 v[84:85], v8 offset:28672
    v_mul_f32 v133, v101, v133
    v_fmaak_f32 v102, v21, v102, 0xc0135761
    v_mul_f32 v103, v135, v135
    v_mfma_f32_32x32x16_bf16 v[240:255], v[68:71], a[128:131], v[240:255]
    ds_read_b64_tr_b16 v[86:87], v8 offset:29184
    v_mul_f32 v151, v135, v151
    v_mul_f32 v146, v146, v130
    v_rcp_f32 v131, v131
    s_waitcnt lgkmcnt(4)
    v_mfma_f32_32x32x16_bf16 v[192:207], v[72:75], a[20:23], v[192:207]
    ds_read_b64_tr_b16 v[88:89], v8 offset:22528
    buffer_load_dwordx4 v5, s[36:39], s81 offen offset:1024 lds
    s_add_u32 s81, s81, s82
    s_cmp_eq_u32 s81, s83
    s_cselect_b32 s81, 0, s81
    v_add_f32 v132, 1.0, v132
    v_exp_f32 v133, v133
    v_mfma_f32_32x32x16_bf16 v[208:223], v[76:79], a[20:23], v[208:223]
    ds_read_b64_tr_b16 v[90:91], v8 offset:23040
    v_mul_f32 v134, v102, v134
    v_fmaak_f32 v103, v21, v103, 0xc0135761
    v_mul_f32 v96, v136, v136
    v_mfma_f32_32x32x16_bf16 v[224:239], v[72:75], a[132:135], v[224:239]
    ds_read_b64_tr_b16 v[92:93], v8 offset:30720
    v_mul_f32 v152, v136, v152
    v_mul_f32 v147, v147, v131
    v_rcp_f32 v132, v132
    v_mfma_f32_32x32x16_bf16 v[240:255], v[76:79], a[132:135], v[240:255]
    ds_read_b64_tr_b16 v[94:95], v8 offset:31232
    buffer_store_dwordx4 v[36:39], v1, s[28:31], s48 offen offset:1024 sc1
    v_add_f32 v133, 1.0, v133
    v_exp_f32 v134, v134
    v_mul_f32 v135, v103, v135
    s_waitcnt lgkmcnt(4)
    v_mfma_f32_32x32x16_bf16 v[192:207], v[80:83], a[24:27], v[192:207]
    s_waitcnt lgkmcnt(0)
    s_waitcnt vmcnt(24)
    s_barrier
    ds_read_b64_tr_b16 v[64:65], v8 offset:32768
    v_fmaak_f32 v96, v21, v96, 0xc0135761
    v_mul_f32 v97, v137, v137
    v_mfma_f32_32x32x16_bf16 v[208:223], v[84:87], a[24:27], v[208:223]
    ds_read_b64_tr_b16 v[66:67], v8 offset:33280
    s_add_u32 m0, s73, 16384
    s_nop 0
    buffer_load_dwordx4 v4, s[32:35], s81 offen lds
    v_mul_f32 v153, v137, v153
    v_mul_f32 v148, v148, v132
    v_rcp_f32 v133, v133
    v_mfma_f32_32x32x16_bf16 v[224:239], v[80:83], a[136:139], v[224:239]
    ds_read_b64_tr_b16 v[68:69], v8 offset:40960
    v_add_f32 v134, 1.0, v134
    v_exp_f32 v135, v135
    v_mul_f32 v136, v96, v136
    v_mfma_f32_32x32x16_bf16 v[240:255], v[84:87], a[136:139], v[240:255]
    ds_read_b64_tr_b16 v[70:71], v8 offset:41472
    v_fmaak_f32 v97, v21, v97, 0xc0135761
    v_mul_f32 v98, v138, v138
    v_mul_f32 v154, v138, v154
    v_mfma_f32_32x32x16_bf16 v[192:207], v[88:91], a[28:31], v[192:207]
    ds_read_b64_tr_b16 v[72:73], v8 offset:34816
    buffer_load_dwordx4 v5, s[32:35], s81 offen offset:1024 lds
    v_mul_f32 v149, v149, v133
    v_rcp_f32 v134, v134
    v_mfma_f32_32x32x16_bf16 v[208:223], v[92:95], a[28:31], v[208:223]
    ds_read_b64_tr_b16 v[74:75], v8 offset:35328
    v_add_f32 v135, 1.0, v135
    v_exp_f32 v136, v136
    v_mul_f32 v137, v97, v137
    v_mfma_f32_32x32x16_bf16 v[224:239], v[88:91], a[140:143], v[224:239]
    ds_read_b64_tr_b16 v[76:77], v8 offset:43008
    s_bfe_u32 s87, s78, 0x80010
    s_lshl_b32 s87, s87, 12
    s_add_u32 s48, s87, s58
    buffer_store_dwordx4 v[36:39], v1, s[28:31], s48 offen offset:0 sc1
    v_fmaak_f32 v98, v21, v98, 0xc0135761
    v_mul_f32 v99, v139, v139
    v_mul_f32 v155, v139, v155
    v_mfma_f32_32x32x16_bf16 v[240:255], v[92:95], a[140:143], v[240:255]
    ds_read_b64_tr_b16 v[78:79], v8 offset:43520
    v_mul_f32 v150, v150, v134
    v_rcp_f32 v135, v135
    v_add_f32 v136, 1.0, v136
    s_waitcnt lgkmcnt(4)
    v_mfma_f32_32x32x16_bf16 v[192:207], v[64:67], a[32:35], v[192:207]
    ds_read_b64_tr_b16 v[80:81], v8 offset:36864
    s_add_u32 m0, s73, 24576
    s_nop 0
    buffer_load_dwordx4 v4, s[36:39], s81 offen lds
    v_exp_f32 v137, v137
    v_mul_f32 v138, v98, v138
    v_fmaak_f32 v99, v21, v99, 0xc0135761
    v_mfma_f32_32x32x16_bf16 v[208:223], v[68:71], a[32:35], v[208:223]
    ds_read_b64_tr_b16 v[82:83], v8 offset:37376
    v_mul_f32 v100, v140, v140
    v_mul_f32 v156, v140, v156
    v_mfma_f32_32x32x16_bf16 v[224:239], v[64:67], a[144:147], v[224:239]
    ds_read_b64_tr_b16 v[84:85], v8 offset:45056
    v_mul_f32 v151, v151, v135
    v_rcp_f32 v136, v136
    v_add_f32 v137, 1.0, v137
    v_mfma_f32_32x32x16_bf16 v[240:255], v[68:71], a[144:147], v[240:255]
    ds_read_b64_tr_b16 v[86:87], v8 offset:45568
    v_exp_f32 v138, v138
    v_mul_f32 v139, v99, v139
    v_fmaak_f32 v100, v21, v100, 0xc0135761
    s_waitcnt lgkmcnt(4)
    v_mfma_f32_32x32x16_bf16 v[192:207], v[72:75], a[36:39], v[192:207]
    ds_read_b64_tr_b16 v[88:89], v8 offset:38912
    buffer_load_dwordx4 v5, s[36:39], s81 offen offset:1024 lds
    s_add_u32 s81, s81, s82
    s_cmp_eq_u32 s81, s83
    s_cselect_b32 s81, 0, s81
    v_mul_f32 v101, v141, v141
    v_mul_f32 v157, v141, v157
    v_cvt_pk_bf16_f32 v128, v144, v145
    v_mfma_f32_32x32x16_bf16 v[208:223], v[76:79], a[36:39], v[208:223]
    ds_read_b64_tr_b16 v[90:91], v8 offset:39424
    buffer_store_dwordx4 v[36:39], v1, s[28:31], s48 offen offset:1024 sc1
    v_cvt_pk_bf16_f32 v129, v146, v147
    v_cvt_pk_bf16_f32 v130, v148, v149
    v_mfma_f32_32x32x16_bf16 v[224:239], v[72:75], a[148:151], v[224:239]
    ds_read_b64_tr_b16 v[92:93], v8 offset:47104
    v_cvt_pk_bf16_f32 v131, v150, v151
    v_mul_f32 v152, v152, v136
    v_rcp_f32 v137, v137
    v_mfma_f32_32x32x16_bf16 v[240:255], v[76:79], a[148:151], v[240:255]
    ds_read_b64_tr_b16 v[94:95], v8 offset:47616
    v_add_f32 v138, 1.0, v138
    v_exp_f32 v139, v139
    v_mul_f32 v140, v100, v140
    s_waitcnt lgkmcnt(4)
    v_mfma_f32_32x32x16_bf16 v[192:207], v[80:83], a[40:43], v[192:207]
    s_waitcnt lgkmcnt(0)
    s_waitcnt vmcnt(26)
    s_barrier
    ds_read_b64_tr_b16 v[64:65], v8 offset:49152
    v_fmaak_f32 v101, v21, v101, 0xc0135761
    v_mul_f32 v102, v142, v142
    buffer_store_dwordx4 v[128:131], v1, s[28:31], s57 offen offset:0 sc1
    v_mfma_f32_32x32x16_bf16 v[208:223], v[84:87], a[40:43], v[208:223]
    ds_read_b64_tr_b16 v[66:67], v8 offset:49664
    s_add_u32 m0, s73, 32768
    s_nop 0
    buffer_load_dwordx4 v4, s[32:35], s81 offen lds
    v_mul_f32 v158, v142, v158
    v_mul_f32 v153, v153, v137
    v_mfma_f32_32x32x16_bf16 v[224:239], v[80:83], a[152:155], v[224:239]
    ds_read_b64_tr_b16 v[68:69], v8 offset:57344
    v_rcp_f32 v138, v138
    v_add_f32 v139, 1.0, v139
    v_exp_f32 v140, v140
    v_mfma_f32_32x32x16_bf16 v[240:255], v[84:87], a[152:155], v[240:255]
    ds_read_b64_tr_b16 v[70:71], v8 offset:57856
    v_mul_f32 v141, v101, v141
    v_fmaak_f32 v102, v21, v102, 0xc0135761
    v_mul_f32 v103, v143, v143
    v_mfma_f32_32x32x16_bf16 v[192:207], v[88:91], a[44:47], v[192:207]
    ds_read_b64_tr_b16 v[72:73], v8 offset:51200
    buffer_load_dwordx4 v5, s[32:35], s81 offen offset:1024 lds
    s_add_u32 s48, s48, 114688
    buffer_store_dwordx4 v[36:39], v1, s[28:31], s48 offen offset:0 sc1
    v_mul_f32 v159, v143, v159
    v_mul_f32 v96, v160, v160
    v_mul_f32 v154, v154, v138
    v_mfma_f32_32x32x16_bf16 v[208:223], v[92:95], a[44:47], v[208:223]
    ds_read_b64_tr_b16 v[74:75], v8 offset:51712
    v_rcp_f32 v139, v139
    v_add_f32 v140, 1.0, v140
    v_mfma_f32_32x32x16_bf16 v[224:239], v[88:91], a[156:159], v[224:239]
    ds_read_b64_tr_b16 v[76:77], v8 offset:59392
    v_exp_f32 v141, v141
    v_mul_f32 v142, v102, v142
    v_fmaak_f32 v103, v21, v103, 0xc0135761
    v_mfma_f32_32x32x16_bf16 v[240:255], v[92:95], a[156:159], v[240:255]
    ds_read_b64_tr_b16 v[78:79], v8 offset:59904
    v_mul_f32 v176, v160, v176
    v_fmaak_f32 v96, v21, v96, 0xc0135761
    v_mul_f32 v97, v161, v161
    s_waitcnt lgkmcnt(4)
    v_mfma_f32_32x32x16_bf16 v[192:207], v[64:67], a[48:51], v[192:207]
    ds_read_b64_tr_b16 v[80:81], v8 offset:53248
    s_add_u32 m0, s73, 40960
    s_nop 0
    buffer_load_dwordx4 v4, s[36:39], s81 offen lds
    v_mul_f32 v155, v155, v139
    v_rcp_f32 v140, v140
    v_add_f32 v141, 1.0, v141
    v_mfma_f32_32x32x16_bf16 v[208:223], v[68:71], a[48:51], v[208:223]
    ds_read_b64_tr_b16 v[82:83], v8 offset:53760
    v_exp_f32 v142, v142
    v_mul_f32 v143, v103, v143
    v_mfma_f32_32x32x16_bf16 v[224:239], v[64:67], a[160:163], v[224:239]
    ds_read_b64_tr_b16 v[84:85], v8 offset:61440
    v_mul_f32 v177, v161, v177
    v_mul_f32 v160, v96, v160
    v_fmaak_f32 v97, v21, v97, 0xc0135761
    v_mfma_f32_32x32x16_bf16 v[240:255], v[68:71], a[160:163], v[240:255]
    ds_read_b64_tr_b16 v[86:87], v8 offset:61952
    buffer_store_dwordx4 v[36:39], v1, s[28:31], s48 offen offset:1024 sc1
    v_mul_f32 v98, v162, v162
    v_mul_f32 v156, v156, v140
    v_rcp_f32 v141, v141
    s_waitcnt lgkmcnt(4)
    v_mfma_f32_32x32x16_bf16 v[192:207], v[72:75], a[52:55], v[192:207]
    ds_read_b64_tr_b16 v[88:89], v8 offset:55296
    buffer_load_dwordx4 v5, s[36:39], s81 offen offset:1024 lds
    s_add_u32 s81, s81, s82
    s_cmp_eq_u32 s81, s83
    s_cselect_b32 s81, 0, s81
    v_add_f32 v142, 1.0, v142
    v_exp_f32 v143, v143
    v_mul_f32 v178, v162, v178
    v_mfma_f32_32x32x16_bf16 v[208:223], v[76:79], a[52:55], v[208:223]
    ds_read_b64_tr_b16 v[90:91], v8 offset:55808
    v_exp_f32 v160, v160
    v_mul_f32 v161, v97, v161
    v_mfma_f32_32x32x16_bf16 v[224:239], v[72:75], a[164:167], v[224:239]
    ds_read_b64_tr_b16 v[92:93], v8 offset:63488
    v_fmaak_f32 v98, v21, v98, 0xc0135761
    v_mul_f32 v99, v163, v163
    v_mul_f32 v157, v157, v141
    v_mfma_f32_32x32x16_bf16 v[240:255], v[76:79], a[164:167], v[240:255]
    ds_read_b64_tr_b16 v[94:95], v8 offset:64000
    v_rcp_f32 v142, v142
    v_add_f32 v143, 1.0, v143
    v_mul_f32 v179, v163, v179
    s_waitcnt lgkmcnt(4)
    v_mfma_f32_32x32x16_bf16 v[192:207], v[80:83], a[56:59], v[192:207]
    s_waitcnt lgkmcnt(0)
    s_waitcnt vmcnt(29)
    s_barrier
    ds_read_b64_tr_b16 v[64:65], v9 offset:0
    v_add_f32 v160, 1.0, v160
    v_exp_f32 v161, v161
    v_mul_f32 v162, v98, v162
    v_mfma_f32_32x32x16_bf16 v[208:223], v[84:87], a[56:59], v[208:223]
    ds_read_b64_tr_b16 v[66:67], v9 offset:512
    s_add_u32 m0, s73, 49152
    s_nop 0
    buffer_load_dwordx4 v4, s[32:35], s81 offen lds
    v_fmaak_f32 v99, v21, v99, 0xc0135761
    v_mul_f32 v100, v164, v164
    v_mul_f32 v158, v158, v142
    v_mfma_f32_32x32x16_bf16 v[224:239], v[80:83], a[168:171], v[224:239]
    ds_read_b64_tr_b16 v[68:69], v9 offset:8192
    s_lshl_b32 s87, s93, 2
    s_add_u32 s87, s87, s72
    s_mul_i32 s87, s87, 3
    s_add_u32 s87, s87, 0
    s_min_u32 s87, s87, 127
    s_lshl_b32 s88, s76, 7
    s_add_u32 s87, s87, s88
    s_lshl_b32 s87, s87, 10
    s_add_u32 s87, s87, 8388608
    buffer_store_dwordx4 v[36:39], v1, s[28:31], s87 offen sc1
    v_rcp_f32 v143, v143
    v_mul_f32 v180, v164, v180
    v_mfma_f32_32x32x16_bf16 v[240:255], v[84:87], a[168:171], v[240:255]
    ds_read_b64_tr_b16 v[70:71], v9 offset:8704
    v_rcp_f32 v160, v160
    v_add_f32 v161, 1.0, v161
    v_exp_f32 v162, v162
    v_mfma_f32_32x32x16_bf16 v[192:207], v[88:91], a[60:63], v[192:207]
    ds_read_b64_tr_b16 v[72:73], v9 offset:2048
    buffer_load_dwordx4 v5, s[32:35], s81 offen offset:1024 lds
    v_mul_f32 v163, v99, v163
    v_fmaak_f32 v100, v21, v100, 0xc0135761
    v_mul_f32 v101, v165, v165
    v_mfma_f32_32x32x16_bf16 v[208:223], v[92:95], a[60:63], v[208:223]
    ds_read_b64_tr_b16 v[74:75], v9 offset:2560
    v_mul_f32 v159, v159, v143
    v_mul_f32 v181, v165, v181
    v_cvt_pk_bf16_f32 v136, v152, v153
    v_mfma_f32_32x32x16_bf16 v[224:239], v[88:91], a[172:175], v[224:239]
    ds_read_b64_tr_b16 v[76:77], v9 offset:10240
    v_cvt_pk_bf16_f32 v137, v154, v155
    v_cvt_pk_bf16_f32 v138, v156, v157
    v_mfma_f32_32x32x16_bf16 v[240:255], v[92:95], a[172:175], v[240:255]
    ds_read_b64_tr_b16 v[78:79], v9 offset:10752
    v_cvt_pk_bf16_f32 v139, v158, v159
    v_mul_f32 v176, v176, v160
    v_rcp_f32 v161, v161
    s_waitcnt lgkmcnt(4)
    v_mfma_f32_32x32x16_bf16 v[192:207], v[64:67], a[64:67], v[192:207]
    ds_read_b64_tr_b16 v[80:81], v9 offset:4096
    s_add_u32 m0, s73, 57344
    s_nop 0
    buffer_load_dwordx4 v4, s[36:39], s81 offen lds
    v_add_f32 v162, 1.0, v162
    v_exp_f32 v163, v163
    v_mul_f32 v164, v100, v164
    v_mfma_f32_32x32x16_bf16 v[208:223], v[68:71], a[64:67], v[208:223]
    ds_read_b64_tr_b16 v[82:83], v9 offset:4608
    s_lshl_b32 s87, s93, 2
    s_add_u32 s87, s87, s72
    s_mul_i32 s87, s87, 3
    s_add_u32 s87, s87, 1
    s_min_u32 s87, s87, 127
    s_lshl_b32 s88, s76, 7
    s_add_u32 s87, s87, s88
    s_lshl_b32 s87, s87, 10
    s_add_u32 s87, s87, 8388608
    buffer_store_dwordx4 v[36:39], v1, s[28:31], s87 offen sc1
    v_fmaak_f32 v101, v21, v101, 0xc0135761
    v_mul_f32 v102, v166, v166
    v_mul_f32 v182, v166, v182
    v_mfma_f32_32x32x16_bf16 v[224:239], v[64:67], a[176:179], v[224:239]
    ds_read_b64_tr_b16 v[84:85], v9 offset:12288
    buffer_store_dwordx4 v[136:139], v1, s[28:31], s57 offen offset:1024 sc1
    v_mul_f32 v177, v177, v161
    v_mfma_f32_32x32x16_bf16 v[240:255], v[68:71], a[176:179], v[240:255]
    ds_read_b64_tr_b16 v[86:87], v9 offset:12800
    v_rcp_f32 v162, v162
    v_add_f32 v163, 1.0, v163
    v_exp_f32 v164, v164
    s_waitcnt lgkmcnt(4)
    v_mfma_f32_32x32x16_bf16 v[192:207], v[72:75], a[68:71], v[192:207]
    ds_read_b64_tr_b16 v[88:89], v9 offset:6144
    buffer_load_dwordx4 v5, s[36:39], s81 offen offset:1024 lds
    s_add_u32 s81, s81, s82
    s_cmp_eq_u32 s81, s83
    s_cselect_b32 s81, 0, s81
    v_mul_f32 v165, v101, v165
    v_fmaak_f32 v102, v21, v102, 0xc0135761
    v_mul_f32 v103, v167, v167
    v_mfma_f32_32x32x16_bf16 v[208:223], v[76:79], a[68:71], v[208:223]
    ds_read_b64_tr_b16 v[90:91], v9 offset:6656
    v_mul_f32 v183, v167, v183
    v_mul_f32 v178, v178, v162
    v_rcp_f32 v163, v163
    v_mfma_f32_32x32x16_bf16 v[224:239], v[72:75], a[180:183], v[224:239]
    ds_read_b64_tr_b16 v[92:93], v9 offset:14336
    v_add_f32 v164, 1.0, v164
    v_exp_f32 v165, v165
    v_mfma_f32_32x32x16_bf16 v[240:255], v[76:79], a[180:183], v[240:255]
    ds_read_b64_tr_b16 v[94:95], v9 offset:14848
    v_mul_f32 v166, v102, v166
    v_fmaak_f32 v103, v21, v103, 0xc0135761
    v_mul_f32 v96, v168, v168
    s_waitcnt lgkmcnt(4)
    v_mfma_f32_32x32x16_bf16 v[192:207], v[80:83], a[72:75], v[192:207]
    s_waitcnt lgkmcnt(0)
    s_waitcnt vmcnt(32)
    s_barrier
    ds_read_b64_tr_b16 v[64:65], v9 offset:16384
    s_lshl_b32 s87, s93, 2
    s_add_u32 s87, s87, s72
    s_mul_i32 s87, s87, 3
    s_add_u32 s87, s87, 2
    s_min_u32 s87, s87, 127
    s_lshl_b32 s88, s76, 7
    s_add_u32 s87, s87, s88
    s_lshl_b32 s87, s87, 10
    s_add_u32 s87, s87, 8388608
    buffer_store_dwordx4 v[36:39], v1, s[28:31], s87 offen sc1
    v_mul_f32 v184, v168, v184
    v_mul_f32 v179, v179, v163
    v_rcp_f32 v164, v164
    v_mfma_f32_32x32x16_bf16 v[208:223], v[84:87], a[72:75], v[208:223]
    ds_read_b64_tr_b16 v[66:67], v9 offset:16896
    s_add_u32 m0, s73, 65536
    s_nop 0
    buffer_load_dwordx4 v4, s[32:35], s81 offen lds
    v_add_f32 v165, 1.0, v165
    v_exp_f32 v166, v166
    v_mul_f32 v167, v103, v167
    v_mfma_f32_32x32x16_bf16 v[224:239], v[80:83], a[184:187], v[224:239]
    ds_read_b64_tr_b16 v[68:69], v9 offset:24576
    v_fmaak_f32 v96, v21, v96, 0xc0135761
    v_mul_f32 v97, v169, v169
    v_mfma_f32_32x32x16_bf16 v[240:255], v[84:87], a[184:187], v[240:255]
    ds_read_b64_tr_b16 v[70:71], v9 offset:25088
    v_mul_f32 v185, v169, v185
    v_mul_f32 v180, v180, v164
    v_rcp_f32 v165, v165
    v_mfma_f32_32x32x16_bf16 v[192:207], v[88:91], a[76:79], v[192:207]
    ds_read_b64_tr_b16 v[72:73], v9 offset:18432
    buffer_load_dwordx4 v5, s[32:35], s81 offen offset:1024 lds
    v_add_f32 v166, 1.0, v166
    v_exp_f32 v167, v167
    v_mul_f32 v168, v96, v168
    v_mfma_f32_32x32x16_bf16 v[208:223], v[92:95], a[76:79], v[208:223]
    ds_read_b64_tr_b16 v[74:75], v9 offset:18944
    v_fmaak_f32 v97, v21, v97, 0xc0135761
    v_mul_f32 v98, v170, v170
    v_mul_f32 v186, v170, v186
    v_mfma_f32_32x32x16_bf16 v[224:239], v[88:91], a[188:191], v[224:239]
    ds_read_b64_tr_b16 v[76:77], v9 offset:26624
    v_mul_f32 v181, v181, v165
    v_rcp_f32 v166, v166
    v_mfma_f32_32x32x16_bf16 v[240:255], v[92:95], a[188:191], v[240:255]
    ds_read_b64_tr_b16 v[78:79], v9 offset:27136
    v_add_f32 v167, 1.0, v167
    v_exp_f32 v168, v168
    v_mul_f32 v169, v97, v169
    s_waitcnt lgkmcnt(4)
    v_mfma_f32_32x32x16_bf16 v[192:207], v[64:67], a[80:83], v[192:207]
    ds_read_b64_tr_b16 v[80:81], v9 offset:20480
    s_add_u32 m0, s73, 73728
    s_nop 0
    buffer_load_dwordx4 v4, s[36:39], s81 offen lds
    v_fmaak_f32 v98, v21, v98, 0xc0135761
    v_mul_f32 v99, v171, v171
    v_mul_f32 v187, v171, v187
    v_mfma_f32_32x32x16_bf16 v[208:223], v[68:71], a[80:83], v[208:223]
    ds_read_b64_tr_b16 v[82:83], v9 offset:20992
    v_mul_f32 v182, v182, v166
    v_rcp_f32 v167, v167
    v_add_f32 v168, 1.0, v168
    v_mfma_f32_32x32x16_bf16 v[224:239], v[64:67], a[192:195], v[224:239]
    ds_read_b64_tr_b16 v[84:85], v9 offset:28672
    v_exp_f32 v169, v169
    v_mul_f32 v170, v98, v170
    v_fmaak_f32 v99, v21, v99, 0xc0135761
    v_mfma_f32_32x32x16_bf16 v[240:255], v[68:71], a[192:195], v[240:255]
    ds_read_b64_tr_b16 v[86:87], v9 offset:29184
    v_mul_f32 v100, v172, v172
    v_mul_f32 v188, v172, v188
    s_waitcnt lgkmcnt(4)
    v_mfma_f32_32x32x16_bf16 v[192:207], v[72:75], a[84:87], v[192:207]
    ds_read_b64_tr_b16 v[88:89], v9 offset:22528
    buffer_load_dwordx4 v5, s[36:39], s81 offen offset:1024 lds
    s_add_u32 s81, s81, s82
    s_cmp_eq_u32 s81, s83
    s_cselect_b32 s81, 0, s81
    v_mul_f32 v183, v183, v167
    v_rcp_f32 v168, v168
    v_add_f32 v169, 1.0, v169
    v_mfma_f32_32x32x16_bf16 v[208:223], v[76:79], a[84:87], v[208:223]
    ds_read_b64_tr_b16 v[90:91], v9 offset:23040
    v_exp_f32 v170, v170
    v_mul_f32 v171, v99, v171
    v_fmaak_f32 v100, v21, v100, 0xc0135761
    v_mfma_f32_32x32x16_bf16 v[224:239], v[72:75], a[196:199], v[224:239]
    ds_read_b64_tr_b16 v[92:93], v9 offset:30720
    v_mul_f32 v101, v173, v173
    v_mul_f32 v189, v173, v189
    v_cvt_pk_bf16_f32 v160, v176, v177
    v_mfma_f32_32x32x16_bf16 v[240:255], v[76:79], a[196:199], v[240:255]
    ds_read_b64_tr_b16 v[94:95], v9 offset:31232
    v_cvt_pk_bf16_f32 v161, v178, v179
    v_cvt_pk_bf16_f32 v162, v180, v181
    s_waitcnt lgkmcnt(4)
    v_mfma_f32_32x32x16_bf16 v[192:207], v[80:83], a[88:91], v[192:207]
    s_waitcnt lgkmcnt(0)
    s_waitcnt vmcnt(32)
    s_barrier
    ds_read_b64_tr_b16 v[64:65], v9 offset:32768
    v_cvt_pk_bf16_f32 v163, v182, v183
    v_mul_f32 v184, v184, v168
    v_rcp_f32 v169, v169
    v_mfma_f32_32x32x16_bf16 v[208:223], v[84:87], a[88:91], v[208:223]
    ds_read_b64_tr_b16 v[66:67], v9 offset:33280
    s_add_u32 m0, s73, 81920
    s_nop 0
    buffer_load_dwordx4 v4, s[32:35], s81 offen lds
    v_add_f32 v170, 1.0, v170
    v_exp_f32 v171, v171
    v_mul_f32 v172, v100, v172
    v_mfma_f32_32x32x16_bf16 v[224:239], v[80:83], a[200:203], v[224:239]
    ds_read_b64_tr_b16 v[68:69], v9 offset:40960
    v_fmaak_f32 v101, v21, v101, 0xc0135761
    v_mul_f32 v102, v174, v174
    s_add_u32 s57, s57, 114688
    buffer_store_dwordx4 v[160:163], v1, s[28:31], s57 offen offset:0 sc1
    v_mfma_f32_32x32x16_bf16 v[240:255], v[84:87], a[200:203], v[240:255]
    ds_read_b64_tr_b16 v[70:71], v9 offset:41472
    v_mul_f32 v190, v174, v190
    v_mul_f32 v185, v185, v169
    v_mfma_f32_32x32x16_bf16 v[192:207], v[88:91], a[92:95], v[192:207]
    ds_read_b64_tr_b16 v[72:73], v9 offset:34816
    buffer_load_dwordx4 v5, s[32:35], s81 offen offset:1024 lds
    v_rcp_f32 v170, v170
    v_add_f32 v171, 1.0, v171
    v_exp_f32 v172, v172
    v_mfma_f32_32x32x16_bf16 v[208:223], v[92:95], a[92:95], v[208:223]
    ds_read_b64_tr_b16 v[74:75], v9 offset:35328
    v_mul_f32 v173, v101, v173
    v_fmaak_f32 v102, v21, v102, 0xc0135761
    v_mul_f32 v103, v175, v175
    v_mfma_f32_32x32x16_bf16 v[224:239], v[88:91], a[204:207], v[224:239]
    ds_read_b64_tr_b16 v[76:77], v9 offset:43008
    v_mul_f32 v191, v175, v191
    v_mul_f32 v186, v186, v170
    v_rcp_f32 v171, v171
    v_mfma_f32_32x32x16_bf16 v[240:255], v[92:95], a[204:207], v[240:255]
    ds_read_b64_tr_b16 v[78:79], v9 offset:43520
    v_add_f32 v172, 1.0, v172
    v_exp_f32 v173, v173
    s_waitcnt lgkmcnt(4)
    v_mfma_f32_32x32x16_bf16 v[192:207], v[64:67], a[96:99], v[192:207]
    ds_read_b64_tr_b16 v[80:81], v9 offset:36864
    s_add_u32 m0, s73, 90112
    s_nop 0
    buffer_load_dwordx4 v4, s[36:39], s81 offen lds
    v_mul_f32 v174, v102, v174
    v_fmaak_f32 v103, v21, v103, 0xc0135761
    v_mul_f32 v187, v187, v171
    v_mfma_f32_32x32x16_bf16 v[208:223], v[68:71], a[96:99], v[208:223]
    ds_read_b64_tr_b16 v[82:83], v9 offset:37376
    v_rcp_f32 v172, v172
    v_add_f32 v173, 1.0, v173
    v_exp_f32 v174, v174
    v_mfma_f32_32x32x16_bf16 v[224:239], v[64:67], a[208:211], v[224:239]
    ds_read_b64_tr_b16 v[84:85], v9 offset:45056
    v_mul_f32 v175, v103, v175
    v_mul_f32 v188, v188, v172
    v_rcp_f32 v173, v173
    v_mfma_f32_32x32x16_bf16 v[240:255], v[68:71], a[208:211], v[240:255]
    ds_read_b64_tr_b16 v[86:87], v9 offset:45568
    v_add_f32 v174, 1.0, v174
    v_exp_f32 v175, v175
    s_waitcnt lgkmcnt(4)
    v_mfma_f32_32x32x16_bf16 v[192:207], v[72:75], a[100:103], v[192:207]
    ds_read_b64_tr_b16 v[88:89], v9 offset:38912
    buffer_load_dwordx4 v5, s[36:39], s81 offen offset:1024 lds
    s_add_u32 s81, s81, s82
    s_cmp_eq_u32 s81, s83
    s_cselect_b32 s81, 0, s81
    v_mul_f32 v189, v189, v173
    v_rcp_f32 v174, v174
    v_add_f32 v175, 1.0, v175
    v_mfma_f32_32x32x16_bf16 v[208:223], v[76:79], a[100:103], v[208:223]
    ds_read_b64_tr_b16 v[90:91], v9 offset:39424
    v_mul_f32 v190, v190, v174
    v_rcp_f32 v175, v175
    s_nop 0
    v_mul_f32 v191, v191, v175
    v_mfma_f32_32x32x16_bf16 v[224:239], v[72:75], a[212:215], v[224:239]
    ds_read_b64_tr_b16 v[92:93], v9 offset:47104
    v_cvt_pk_bf16_f32 v168, v184, v185
    v_cvt_pk_bf16_f32 v169, v186, v187
    v_cvt_pk_bf16_f32 v170, v188, v189
    v_mfma_f32_32x32x16_bf16 v[240:255], v[76:79], a[212:215], v[240:255]
    ds_read_b64_tr_b16 v[94:95], v9 offset:47616
    v_cvt_pk_bf16_f32 v171, v190, v191
    buffer_store_dwordx4 v[168:171], v1, s[28:31], s57 offen offset:1024 sc1
    s_waitcnt lgkmcnt(4)
    v_mfma_f32_32x32x16_bf16 v[192:207], v[80:83], a[104:107], v[192:207]
    s_waitcnt lgkmcnt(0)
    s_waitcnt vmcnt(32)
    s_barrier
    ds_read_b64_tr_b16 v[64:65], v8 offset:0
    v_mfma_f32_32x32x16_bf16 v[208:223], v[84:87], a[104:107], v[208:223]
    ds_read_b64_tr_b16 v[66:67], v8 offset:512
    v_mfma_f32_32x32x16_bf16 v[224:239], v[80:83], a[216:219], v[224:239]
    ds_read_b64_tr_b16 v[68:69], v8 offset:8192
    v_mfma_f32_32x32x16_bf16 v[240:255], v[84:87], a[216:219], v[240:255]
    ds_read_b64_tr_b16 v[70:71], v8 offset:8704
    v_mfma_f32_32x32x16_bf16 v[192:207], v[88:91], a[108:111], v[192:207]
    ds_read_b64_tr_b16 v[72:73], v8 offset:2048
    v_mfma_f32_32x32x16_bf16 v[208:223], v[92:95], a[108:111], v[208:223]
    ds_read_b64_tr_b16 v[74:75], v8 offset:2560
    v_mfma_f32_32x32x16_bf16 v[224:239], v[88:91], a[220:223], v[224:239]
    ds_read_b64_tr_b16 v[76:77], v8 offset:10240
    v_mfma_f32_32x32x16_bf16 v[240:255], v[92:95], a[220:223], v[240:255]
    ds_read_b64_tr_b16 v[78:79], v8 offset:10752
    s_lshr_b32 s78, s78, 8
Lmc:
    s_bfe_u32 s87, s78, 0x80000
    s_lshl_b32 s87, s87, 12
    s_add_u32 s57, s87, s58
    s_waitcnt lgkmcnt(4)
    v_mfma_f32_32x32x16_bf16 v[128:143], v[64:67], a[0:3], 0
    ds_read_b64_tr_b16 v[80:81], v8 offset:4096
    s_add_u32 m0, s73, 98304
    s_nop 0
    buffer_load_dwordx4 v4, s[32:35], s81 offen lds
    v_mfma_f32_32x32x16_bf16 v[144:159], v[68:71], a[0:3], 0
    ds_read_b64_tr_b16 v[82:83], v8 offset:4608
    buffer_load_dwordx4 v5, s[32:35], s81 offen offset:1024 lds
    v_mfma_f32_32x32x16_bf16 v[160:175], v[64:67], a[112:115], 0
    ds_read_b64_tr_b16 v[84:85], v8 offset:12288
    s_add_u32 m0, s73, 106496
    s_nop 0
    buffer_load_dwordx4 v4, s[36:39], s81 offen lds
    v_mfma_f32_32x32x16_bf16 v[176:191], v[68:71], a[112:115], 0
    ds_read_b64_tr_b16 v[86:87], v8 offset:12800
    buffer_load_dwordx4 v5, s[36:39], s81 offen offset:1024 lds
    s_add_u32 s81, s81, s82
    s_cmp_eq_u32 s81, s83
    s_cselect_b32 s81, 0, s81
    s_waitcnt lgkmcnt(4)
    v_mfma_f32_32x32x16_bf16 v[128:143], v[72:75], a[4:7], v[128:143]
    ds_read_b64_tr_b16 v[88:89], v8 offset:6144
    s_lshl_b32 s87, s86, 7
    s_add_u32 s32, s18, s87
    s_addc_u32 s33, s19, 0
    s_sub_u32 s34, 1605632, s87
    v_mul_f32 v96, v192, v192
    v_mul_f32 v208, v192, v208
    v_fmaak_f32 v96, v21, v96, 0xc0135761
    v_mul_f32 v97, v193, v193
    v_mul_f32 v209, v193, v209
    v_mfma_f32_32x32x16_bf16 v[144:159], v[76:79], a[4:7], v[144:159]
    ds_read_b64_tr_b16 v[90:91], v8 offset:6656
    s_add_u32 s36, s32, 57344
    s_addc_u32 s37, s33, 0
    s_sub_u32 s38, s34, 57344
    s_mov_b32 s82, 114688
    v_mul_f32 v192, v96, v192
    v_fmaak_f32 v97, v21, v97, 0xc0135761
    v_mul_f32 v98, v194, v194
    v_mul_f32 v210, v194, v210
    v_mfma_f32_32x32x16_bf16 v[160:175], v[72:75], a[116:119], v[160:175]
    ds_read_b64_tr_b16 v[92:93], v8 offset:14336
    s_movk_i32 s87, 896
    v_mad_u32_u24 v4, v2, s87, v3
    v_add_u32 v5, 6144, v4
    v_exp_f32 v192, v192
    v_mul_f32 v193, v97, v193
    v_fmaak_f32 v98, v21, v98, 0xc0135761
    v_mul_f32 v99, v195, v195
    v_mfma_f32_32x32x16_bf16 v[176:191], v[76:79], a[116:119], v[176:191]
    ds_read_b64_tr_b16 v[94:95], v8 offset:14848
    v_mul_f32 v211, v195, v211
    v_add_f32 v192, 1.0, v192
    v_exp_f32 v193, v193
    v_mul_f32 v194, v98, v194
    s_waitcnt lgkmcnt(4)
    v_mfma_f32_32x32x16_bf16 v[128:143], v[80:83], a[8:11], v[128:143]
    s_waitcnt lgkmcnt(0)
    s_waitcnt vmcnt(20)
    s_barrier
    ds_read_b64_tr_b16 v[64:65], v8 offset:16384
    v_fmaak_f32 v99, v21, v99, 0xc0135761
    v_mul_f32 v100, v196, v196
    v_mul_f32 v212, v196, v212
    v_rcp_f32 v192, v192
    v_mfma_f32_32x32x16_bf16 v[144:159], v[84:87], a[8:11], v[144:159]
    ds_read_b64_tr_b16 v[66:67], v8 offset:16896
    s_bfe_u32 s81, s52, 0x40000
    s_mul_i32 s81, s81, s82
    s_add_u32 m0, s73, 0
    s_nop 0
    buffer_load_dwordx4 v4, s[32:35], s81 offen lds
    v_add_f32 v193, 1.0, v193
    v_exp_f32 v194, v194
    v_mul_f32 v195, v99, v195
    v_fmaak_f32 v100, v21, v100, 0xc0135761
    v_mfma_f32_32x32x16_bf16 v[160:175], v[80:83], a[120:123], v[160:175]
    ds_read_b64_tr_b16 v[68:69], v8 offset:24576
    v_mul_f32 v101, v197, v197
    v_mul_f32 v213, v197, v213
    v_mul_f32 v208, v208, v192
    v_rcp_f32 v193, v193
    v_mfma_f32_32x32x16_bf16 v[176:191], v[84:87], a[120:123], v[176:191]
    ds_read_b64_tr_b16 v[70:71], v8 offset:25088
    v_add_f32 v194, 1.0, v194
    v_exp_f32 v195, v195
    v_mul_f32 v196, v100, v196
    v_fmaak_f32 v101, v21, v101, 0xc0135761
    v_mfma_f32_32x32x16_bf16 v[128:143], v[88:91], a[12:15], v[128:143]
    ds_read_b64_tr_b16 v[72:73], v8 offset:18432
    buffer_load_dwordx4 v5, s[32:35], s81 offen offset:1024 lds
    v_mul_f32 v102, v198, v198
    v_mul_f32 v214, v198, v214
    v_mul_f32 v209, v209, v193
    v_rcp_f32 v194, v194
    v_mfma_f32_32x32x16_bf16 v[144:159], v[92:95], a[12:15], v[144:159]
    ds_read_b64_tr_b16 v[74:75], v8 offset:18944
    v_add_f32 v195, 1.0, v195
    v_exp_f32 v196, v196
    v_mul_f32 v197, v101, v197
    v_fmaak_f32 v102, v21, v102, 0xc0135761
    v_mfma_f32_32x32x16_bf16 v[160:175], v[88:91], a[124:127], v[160:175]
    ds_read_b64_tr_b16 v[76:77], v8 offset:26624
    v_mul_f32 v103, v199, v199
    v_mul_f32 v215, v199, v215
    v_mul_f32 v210, v210, v194
    v_rcp_f32 v195, v195
    v_mfma_f32_32x32x16_bf16 v[176:191], v[92:95], a[124:127], v[176:191]
    ds_read_b64_tr_b16 v[78:79], v8 offset:27136
    v_add_f32 v196, 1.0, v196
    v_exp_f32 v197, v197
    v_mul_f32 v198, v102, v198
    v_fmaak_f32 v103, v21, v103, 0xc0135761
    s_waitcnt lgkmcnt(4)
    v_mfma_f32_32x32x16_bf16 v[128:143], v[64:67], a[16:19], v[128:143]
    ds_read_b64_tr_b16 v[80:81], v8 offset:20480
    s_add_u32 m0, s73, 8192
    s_nop 0
    buffer_load_dwordx4 v4, s[36:39], s81 offen lds
    v_mul_f32 v96, v200, v200
    v_mul_f32 v216, v200, v216
    v_mul_f32 v211, v211, v195
    v_rcp_f32 v196, v196
    v_mfma_f32_32x32x16_bf16 v[144:159], v[68:71], a[16:19], v[144:159]
    ds_read_b64_tr_b16 v[82:83], v8 offset:20992
    v_add_f32 v197, 1.0, v197
    v_exp_f32 v198, v198
    v_mul_f32 v199, v103, v199
    v_fmaak_f32 v96, v21, v96, 0xc0135761
    v_mfma_f32_32x32x16_bf16 v[160:175], v[64:67], a[128:131], v[160:175]
    ds_read_b64_tr_b16 v[84:85], v8 offset:28672
    v_mul_f32 v97, v201, v201
    v_mul_f32 v217, v201, v217
    v_mul_f32 v212, v212, v196
    v_rcp_f32 v197, v197
    v_mfma_f32_32x32x16_bf16 v[176:191], v[68:71], a[128:131], v[176:191]
    ds_read_b64_tr_b16 v[86:87], v8 offset:29184
    v_add_f32 v198, 1.0, v198
    v_exp_f32 v199, v199
    v_mul_f32 v200, v96, v200
    v_fmaak_f32 v97, v21, v97, 0xc0135761
    s_waitcnt lgkmcnt(4)
    v_mfma_f32_32x32x16_bf16 v[128:143], v[72:75], a[20:23], v[128:143]
    ds_read_b64_tr_b16 v[88:89], v8 offset:22528
    buffer_load_dwordx4 v5, s[36:39], s81 offen offset:1024 lds
    v_mul_f32 v98, v202, v202
    v_mul_f32 v218, v202, v218
    v_mul_f32 v213, v213, v197
    v_rcp_f32 v198, v198
    v_mfma_f32_32x32x16_bf16 v[144:159], v[76:79], a[20:23], v[144:159]
    ds_read_b64_tr_b16 v[90:91], v8 offset:23040
    v_add_f32 v199, 1.0, v199
    v_exp_f32 v200, v200
    v_mul_f32 v201, v97, v201
    v_fmaak_f32 v98, v21, v98, 0xc0135761
    v_mul_f32 v99, v203, v203
    v_mfma_f32_32x32x16_bf16 v[160:175], v[72:75], a[132:135], v[160:175]
    ds_read_b64_tr_b16 v[92:93], v8 offset:30720
    v_mul_f32 v219, v203, v219
    v_mul_f32 v214, v214, v198
    v_rcp_f32 v199, v199
    v_add_f32 v200, 1.0, v200
    v_mfma_f32_32x32x16_bf16 v[176:191], v[76:79], a[132:135], v[176:191]
    ds_read_b64_tr_b16 v[94:95], v8 offset:31232
    v_exp_f32 v201, v201
    v_mul_f32 v202, v98, v202
    v_fmaak_f32 v99, v21, v99, 0xc0135761
    v_mul_f32 v100, v204, v204
    s_waitcnt lgkmcnt(4)
    v_mfma_f32_32x32x16_bf16 v[128:143], v[80:83], a[24:27], v[128:143]
    s_waitcnt lgkmcnt(0)
    s_waitcnt vmcnt(8)
    s_barrier
    s_cmp_lg_u32 s63, 1
    s_cbranch_scc1 Lwf_2
    v_mov_b32 v15, s79
    s_mov_b64 exec, 0xff
    buffer_store_dword v15, v19, s[28:31], s59 offen sc1
    s_mov_b64 exec, -1
Lwf_2:
    ds_read_b64_tr_b16 v[64:65], v8 offset:32768
    v_mul_f32 v220, v204, v220
    v_mul_f32 v215, v215, v199
    v_rcp_f32 v200, v200
    v_add_f32 v201, 1.0, v201
    v_mfma_f32_32x32x16_bf16 v[144:159], v[84:87], a[24:27], v[144:159]
    ds_read_b64_tr_b16 v[66:67], v8 offset:33280
    s_bfe_u32 s81, s52, 0x40004
    s_mul_i32 s81, s81, s82
    s_add_u32 m0, s73, 16384
    s_nop 0
    buffer_load_dwordx4 v4, s[32:35], s81 offen lds
    v_exp_f32 v202, v202
    v_mul_f32 v203, v99, v203
    v_fmaak_f32 v100, v21, v100, 0xc0135761
    v_mul_f32 v101, v205, v205
    v_mfma_f32_32x32x16_bf16 v[160:175], v[80:83], a[136:139], v[160:175]
    ds_read_b64_tr_b16 v[68:69], v8 offset:40960
    v_mul_f32 v221, v205, v221
    v_cvt_pk_bf16_f32 v192, v208, v209
    v_cvt_pk_bf16_f32 v193, v210, v211
    v_cvt_pk_bf16_f32 v194, v212, v213
    v_mfma_f32_32x32x16_bf16 v[176:191], v[84:87], a[136:139], v[176:191]
    ds_read_b64_tr_b16 v[70:71], v8 offset:41472
    v_cvt_pk_bf16_f32 v195, v214, v215
    v_mul_f32 v216, v216, v200
    v_rcp_f32 v201, v201
    v_add_f32 v202, 1.0, v202
    v_mfma_f32_32x32x16_bf16 v[128:143], v[88:91], a[28:31], v[128:143]
    ds_read_b64_tr_b16 v[72:73], v8 offset:34816
    buffer_load_dwordx4 v5, s[32:35], s81 offen offset:1024 lds
    v_exp_f32 v203, v203
    v_mul_f32 v204, v100, v204
    v_fmaak_f32 v101, v21, v101, 0xc0135761
    v_mul_f32 v102, v206, v206
    v_mfma_f32_32x32x16_bf16 v[144:159], v[92:95], a[28:31], v[144:159]
    ds_read_b64_tr_b16 v[74:75], v8 offset:35328
    buffer_store_dwordx4 v[192:195], v1, s[28:31], s57 offen offset:0 sc1
    v_mul_f32 v222, v206, v222
    v_mul_f32 v217, v217, v201
    v_rcp_f32 v202, v202
    v_mfma_f32_32x32x16_bf16 v[160:175], v[88:91], a[140:143], v[160:175]
    ds_read_b64_tr_b16 v[76:77], v8 offset:43008
    v_add_f32 v203, 1.0, v203
    v_exp_f32 v204, v204
    v_mul_f32 v205, v101, v205
    v_fmaak_f32 v102, v21, v102, 0xc0135761
    v_mfma_f32_32x32x16_bf16 v[176:191], v[92:95], a[140:143], v[176:191]
    ds_read_b64_tr_b16 v[78:79], v8 offset:43520
    v_mul_f32 v103, v207, v207
    v_mul_f32 v223, v207, v223
    v_mul_f32 v96, v224, v224
    v_mul_f32 v218, v218, v202
    s_waitcnt lgkmcnt(4)
    v_mfma_f32_32x32x16_bf16 v[128:143], v[64:67], a[32:35], v[128:143]
    ds_read_b64_tr_b16 v[80:81], v8 offset:36864
    s_add_u32 m0, s73, 24576
    s_nop 0
    buffer_load_dwordx4 v4, s[36:39], s81 offen lds
    v_rcp_f32 v203, v203
    v_add_f32 v204, 1.0, v204
    v_exp_f32 v205, v205
    v_mul_f32 v206, v102, v206
    v_mfma_f32_32x32x16_bf16 v[144:159], v[68:71], a[32:35], v[144:159]
    ds_read_b64_tr_b16 v[82:83], v8 offset:37376
    v_fmaak_f32 v103, v21, v103, 0xc0135761
    v_mul_f32 v240, v224, v240
    v_fmaak_f32 v96, v21, v96, 0xc0135761
    v_mul_f32 v97, v225, v225
    v_mfma_f32_32x32x16_bf16 v[160:175], v[64:67], a[144:147], v[160:175]
    ds_read_b64_tr_b16 v[84:85], v8 offset:45056
    v_mul_f32 v219, v219, v203
    v_rcp_f32 v204, v204
    v_add_f32 v205, 1.0, v205
    v_exp_f32 v206, v206
    v_mfma_f32_32x32x16_bf16 v[176:191], v[68:71], a[144:147], v[176:191]
    ds_read_b64_tr_b16 v[86:87], v8 offset:45568
    v_mul_f32 v207, v103, v207
    v_mul_f32 v241, v225, v241
    v_mul_f32 v224, v96, v224
    v_fmaak_f32 v97, v21, v97, 0xc0135761
    s_waitcnt lgkmcnt(4)
    v_mfma_f32_32x32x16_bf16 v[128:143], v[72:75], a[36:39], v[128:143]
    ds_read_b64_tr_b16 v[88:89], v8 offset:38912
    buffer_load_dwordx4 v5, s[36:39], s81 offen offset:1024 lds
    v_mul_f32 v98, v226, v226
    v_mul_f32 v220, v220, v204
    v_rcp_f32 v205, v205
    v_add_f32 v206, 1.0, v206
    v_mfma_f32_32x32x16_bf16 v[144:159], v[76:79], a[36:39], v[144:159]
    ds_read_b64_tr_b16 v[90:91], v8 offset:39424
    v_exp_f32 v207, v207
    v_mul_f32 v242, v226, v242
    v_exp_f32 v224, v224
    v_mul_f32 v225, v97, v225
    v_mfma_f32_32x32x16_bf16 v[160:175], v[72:75], a[148:151], v[160:175]
    ds_read_b64_tr_b16 v[92:93], v8 offset:47104
    v_fmaak_f32 v98, v21, v98, 0xc0135761
    v_mul_f32 v99, v227, v227
    v_mul_f32 v221, v221, v205
    v_rcp_f32 v206, v206
    v_add_f32 v207, 1.0, v207
    v_mfma_f32_32x32x16_bf16 v[176:191], v[76:79], a[148:151], v[176:191]
    ds_read_b64_tr_b16 v[94:95], v8 offset:47616
    v_mul_f32 v243, v227, v243
    v_add_f32 v224, 1.0, v224
    v_exp_f32 v225, v225
    v_mul_f32 v226, v98, v226
    s_waitcnt lgkmcnt(4)
    v_mfma_f32_32x32x16_bf16 v[128:143], v[80:83], a[40:43], v[128:143]
    s_waitcnt lgkmcnt(0)
    s_barrier
    ds_read_b64_tr_b16 v[64:65], v8 offset:49152
    v_fmaak_f32 v99, v21, v99, 0xc0135761
    v_mul_f32 v100, v228, v228
    v_mul_f32 v222, v222, v206
    v_rcp_f32 v207, v207
    v_mfma_f32_32x32x16_bf16 v[144:159], v[84:87], a[40:43], v[144:159]
    ds_read_b64_tr_b16 v[66:67], v8 offset:49664
    s_bfe_u32 s81, s52, 0x40008
    s_mul_i32 s81, s81, s82
    s_add_u32 m0, s73, 32768
    s_nop 0
    buffer_load_dwordx4 v4, s[32:35], s81 offen lds
    v_mul_f32 v244, v228, v244
    v_rcp_f32 v224, v224
    v_add_f32 v225, 1.0, v225
    v_exp_f32 v226, v226
    v_mfma_f32_32x32x16_bf16 v[160:175], v[80:83], a[152:155], v[160:175]
    ds_read_b64_tr_b16 v[68:69], v8 offset:57344
    v_mul_f32 v227, v99, v227
    v_fmaak_f32 v100, v21, v100, 0xc0135761
    v_mul_f32 v101, v229, v229
    v_mul_f32 v223, v223, v207
    v_mfma_f32_32x32x16_bf16 v[176:191], v[84:87], a[152:155], v[176:191]
    ds_read_b64_tr_b16 v[70:71], v8 offset:57856
    v_mul_f32 v245, v229, v245
    v_cvt_pk_bf16_f32 v200, v216, v217
    v_cvt_pk_bf16_f32 v201, v218, v219
    v_cvt_pk_bf16_f32 v202, v220, v221
    v_mfma_f32_32x32x16_bf16 v[128:143], v[88:91], a[44:47], v[128:143]
    ds_read_b64_tr_b16 v[72:73], v8 offset:51200
    buffer_load_dwordx4 v5, s[32:35], s81 offen offset:1024 lds
    v_cvt_pk_bf16_f32 v203, v222, v223
    v_mul_f32 v240, v240, v224
    v_rcp_f32 v225, v225
    v_add_f32 v226, 1.0, v226
    v_mfma_f32_32x32x16_bf16 v[144:159], v[92:95], a[44:47], v[144:159]
    ds_read_b64_tr_b16 v[74:75], v8 offset:51712
    v_exp_f32 v227, v227
    v_mul_f32 v228, v100, v228
    v_fmaak_f32 v101, v21, v101, 0xc0135761
    v_mul_f32 v102, v230, v230
    v_mfma_f32_32x32x16_bf16 v[160:175], v[88:91], a[156:159], v[160:175]
    ds_read_b64_tr_b16 v[76:77], v8 offset:59392
    v_mul_f32 v246, v230, v246
    buffer_store_dwordx4 v[200:203], v1, s[28:31], s57 offen offset:1024 sc1
    v_mul_f32 v241, v241, v225
    v_rcp_f32 v226, v226
    v_mfma_f32_32x32x16_bf16 v[176:191], v[92:95], a[156:159], v[176:191]
    ds_read_b64_tr_b16 v[78:79], v8 offset:59904
    v_add_f32 v227, 1.0, v227
    v_exp_f32 v228, v228
    v_mul_f32 v229, v101, v229
    v_fmaak_f32 v102, v21, v102, 0xc0135761
    s_waitcnt lgkmcnt(4)
    v_mfma_f32_32x32x16_bf16 v[128:143], v[64:67], a[48:51], v[128:143]
    ds_read_b64_tr_b16 v[80:81], v8 offset:53248
    s_add_u32 m0, s73, 40960
    s_nop 0
    buffer_load_dwordx4 v4, s[36:39], s81 offen lds
    v_mul_f32 v103, v231, v231
    v_mul_f32 v247, v231, v247
    v_mul_f32 v242, v242, v226
    v_rcp_f32 v227, v227
    v_mfma_f32_32x32x16_bf16 v[144:159], v[68:71], a[48:51], v[144:159]
    ds_read_b64_tr_b16 v[82:83], v8 offset:53760
    v_add_f32 v228, 1.0, v228
    v_exp_f32 v229, v229
    v_mul_f32 v230, v102, v230
    v_fmaak_f32 v103, v21, v103, 0xc0135761
    v_mfma_f32_32x32x16_bf16 v[160:175], v[64:67], a[160:163], v[160:175]
    ds_read_b64_tr_b16 v[84:85], v8 offset:61440
    v_mul_f32 v96, v232, v232
    v_mul_f32 v248, v232, v248
    v_mul_f32 v243, v243, v227
    v_rcp_f32 v228, v228
    v_mfma_f32_32x32x16_bf16 v[176:191], v[68:71], a[160:163], v[176:191]
    ds_read_b64_tr_b16 v[86:87], v8 offset:61952
    v_add_f32 v229, 1.0, v229
    v_exp_f32 v230, v230
    v_mul_f32 v231, v103, v231
    v_fmaak_f32 v96, v21, v96, 0xc0135761
    s_waitcnt lgkmcnt(4)
    v_mfma_f32_32x32x16_bf16 v[128:143], v[72:75], a[52:55], v[128:143]
    ds_read_b64_tr_b16 v[88:89], v8 offset:55296
    buffer_load_dwordx4 v5, s[36:39], s81 offen offset:1024 lds
    v_mul_f32 v97, v233, v233
    v_mul_f32 v249, v233, v249
    v_mul_f32 v244, v244, v228
    v_rcp_f32 v229, v229
    v_mfma_f32_32x32x16_bf16 v[144:159], v[76:79], a[52:55], v[144:159]
    ds_read_b64_tr_b16 v[90:91], v8 offset:55808
    v_add_f32 v230, 1.0, v230
    v_exp_f32 v231, v231
    v_mul_f32 v232, v96, v232
    v_fmaak_f32 v97, v21, v97, 0xc0135761
    v_mfma_f32_32x32x16_bf16 v[160:175], v[72:75], a[164:167], v[160:175]
    ds_read_b64_tr_b16 v[92:93], v8 offset:63488
    v_mul_f32 v98, v234, v234
    v_mul_f32 v250, v234, v250
    v_mul_f32 v245, v245, v229
    v_rcp_f32 v230, v230
    v_mfma_f32_32x32x16_bf16 v[176:191], v[76:79], a[164:167], v[176:191]
    ds_read_b64_tr_b16 v[94:95], v8 offset:64000
    v_add_f32 v231, 1.0, v231
    v_exp_f32 v232, v232
    v_mul_f32 v233, v97, v233
    v_fmaak_f32 v98, v21, v98, 0xc0135761
    v_mul_f32 v99, v235, v235
    s_waitcnt lgkmcnt(4)
    v_mfma_f32_32x32x16_bf16 v[128:143], v[80:83], a[56:59], v[128:143]
    s_waitcnt lgkmcnt(0)
    s_barrier
    ds_read_b64_tr_b16 v[64:65], v9 offset:0
    v_mul_f32 v251, v235, v251
    v_mul_f32 v246, v246, v230
    v_rcp_f32 v231, v231
    v_add_f32 v232, 1.0, v232
    v_mfma_f32_32x32x16_bf16 v[144:159], v[84:87], a[56:59], v[144:159]
    ds_read_b64_tr_b16 v[66:67], v9 offset:512
    s_bfe_u32 s81, s53, 0x40000
    s_mul_i32 s81, s81, s82
    s_add_u32 m0, s73, 49152
    s_nop 0
    buffer_load_dwordx4 v4, s[32:35], s81 offen lds
    v_exp_f32 v233, v233
    v_mul_f32 v234, v98, v234
    v_fmaak_f32 v99, v21, v99, 0xc0135761
    v_mul_f32 v100, v236, v236
    v_mfma_f32_32x32x16_bf16 v[160:175], v[80:83], a[168:171], v[160:175]
    ds_read_b64_tr_b16 v[68:69], v9 offset:8192
    v_mul_f32 v252, v236, v252
    v_mul_f32 v247, v247, v231
    v_rcp_f32 v232, v232
    v_add_f32 v233, 1.0, v233
    v_mfma_f32_32x32x16_bf16 v[176:191], v[84:87], a[168:171], v[176:191]
    ds_read_b64_tr_b16 v[70:71], v9 offset:8704
    v_exp_f32 v234, v234
    v_mul_f32 v235, v99, v235
    v_fmaak_f32 v100, v21, v100, 0xc0135761
    v_mul_f32 v101, v237, v237
    v_mfma_f32_32x32x16_bf16 v[128:143], v[88:91], a[60:63], v[128:143]
    ds_read_b64_tr_b16 v[72:73], v9 offset:2048
    buffer_load_dwordx4 v5, s[32:35], s81 offen offset:1024 lds
    v_mul_f32 v253, v237, v253
    v_cvt_pk_bf16_f32 v224, v240, v241
    v_cvt_pk_bf16_f32 v225, v242, v243
    v_cvt_pk_bf16_f32 v226, v244, v245
    v_mfma_f32_32x32x16_bf16 v[144:159], v[92:95], a[60:63], v[144:159]
    ds_read_b64_tr_b16 v[74:75], v9 offset:2560
    v_cvt_pk_bf16_f32 v227, v246, v247
    v_mul_f32 v248, v248, v232
    v_rcp_f32 v233, v233
    v_add_f32 v234, 1.0, v234
    v_mfma_f32_32x32x16_bf16 v[160:175], v[88:91], a[172:175], v[160:175]
    ds_read_b64_tr_b16 v[76:77], v9 offset:10240
    v_exp_f32 v235, v235
    v_mul_f32 v236, v100, v236
    v_fmaak_f32 v101, v21, v101, 0xc0135761
    v_mul_f32 v102, v238, v238
    v_mfma_f32_32x32x16_bf16 v[176:191], v[92:95], a[172:175], v[176:191]
    ds_read_b64_tr_b16 v[78:79], v9 offset:10752
    s_add_u32 s57, s57, 114688
    buffer_store_dwordx4 v[224:227], v1, s[28:31], s57 offen offset:0 sc1
    v_mul_f32 v254, v238, v254
    v_mul_f32 v249, v249, v233
    v_rcp_f32 v234, v234
    s_waitcnt lgkmcnt(4)
    v_mfma_f32_32x32x16_bf16 v[128:143], v[64:67], a[64:67], v[128:143]
    ds_read_b64_tr_b16 v[80:81], v9 offset:4096
    s_add_u32 m0, s73, 57344
    s_nop 0
    buffer_load_dwordx4 v4, s[36:39], s81 offen lds
    v_add_f32 v235, 1.0, v235
    v_exp_f32 v236, v236
    v_mul_f32 v237, v101, v237
    v_fmaak_f32 v102, v21, v102, 0xc0135761
    v_mfma_f32_32x32x16_bf16 v[144:159], v[68:71], a[64:67], v[144:159]
    ds_read_b64_tr_b16 v[82:83], v9 offset:4608
    v_mul_f32 v103, v239, v239
    v_mul_f32 v255, v239, v255
    v_mul_f32 v250, v250, v234
    v_rcp_f32 v235, v235
    v_mfma_f32_32x32x16_bf16 v[160:175], v[64:67], a[176:179], v[160:175]
    ds_read_b64_tr_b16 v[84:85], v9 offset:12288
    v_add_f32 v236, 1.0, v236
    v_exp_f32 v237, v237
    v_mul_f32 v238, v102, v238
    v_fmaak_f32 v103, v21, v103, 0xc0135761
    v_mfma_f32_32x32x16_bf16 v[176:191], v[68:71], a[176:179], v[176:191]
    ds_read_b64_tr_b16 v[86:87], v9 offset:12800
    v_mul_f32 v251, v251, v235
    v_rcp_f32 v236, v236
    v_add_f32 v237, 1.0, v237
    v_exp_f32 v238, v238
    s_waitcnt lgkmcnt(4)
    v_mfma_f32_32x32x16_bf16 v[128:143], v[72:75], a[68:71], v[128:143]
    ds_read_b64_tr_b16 v[88:89], v9 offset:6144
    buffer_load_dwordx4 v5, s[36:39], s81 offen offset:1024 lds
    v_mul_f32 v239, v103, v239
    v_mul_f32 v252, v252, v236
    v_rcp_f32 v237, v237
    v_add_f32 v238, 1.0, v238
    v_mfma_f32_32x32x16_bf16 v[144:159], v[76:79], a[68:71], v[144:159]
    ds_read_b64_tr_b16 v[90:91], v9 offset:6656
    v_exp_f32 v239, v239
    v_mul_f32 v253, v253, v237
    v_rcp_f32 v238, v238
    v_add_f32 v239, 1.0, v239
    v_mfma_f32_32x32x16_bf16 v[160:175], v[72:75], a[180:183], v[160:175]
    ds_read_b64_tr_b16 v[92:93], v9 offset:14336
    v_mul_f32 v254, v254, v238
    v_rcp_f32 v239, v239
    s_nop 0
    v_mul_f32 v255, v255, v239
    v_cvt_pk_bf16_f32 v232, v248, v249
    v_mfma_f32_32x32x16_bf16 v[176:191], v[76:79], a[180:183], v[176:191]
    ds_read_b64_tr_b16 v[94:95], v9 offset:14848
    v_cvt_pk_bf16_f32 v233, v250, v251
    v_cvt_pk_bf16_f32 v234, v252, v253
    v_cvt_pk_bf16_f32 v235, v254, v255
    buffer_store_dwordx4 v[232:235], v1, s[28:31], s57 offen offset:1024 sc1
    s_waitcnt lgkmcnt(4)
    v_mfma_f32_32x32x16_bf16 v[128:143], v[80:83], a[72:75], v[128:143]
    s_waitcnt lgkmcnt(0)
    s_barrier
    ds_read_b64_tr_b16 v[64:65], v9 offset:16384
    v_mfma_f32_32x32x16_bf16 v[144:159], v[84:87], a[72:75], v[144:159]
    ds_read_b64_tr_b16 v[66:67], v9 offset:16896
    s_bfe_u32 s81, s53, 0x40004
    s_mul_i32 s81, s81, s82
    s_add_u32 m0, s73, 65536
    s_nop 0
    buffer_load_dwordx4 v4, s[32:35], s81 offen lds
    v_mfma_f32_32x32x16_bf16 v[160:175], v[80:83], a[184:187], v[160:175]
    ds_read_b64_tr_b16 v[68:69], v9 offset:24576
    buffer_load_dwordx4 v5, s[32:35], s81 offen offset:1024 lds
    v_mfma_f32_32x32x16_bf16 v[176:191], v[84:87], a[184:187], v[176:191]
    ds_read_b64_tr_b16 v[70:71], v9 offset:25088
    v_mfma_f32_32x32x16_bf16 v[128:143], v[88:91], a[76:79], v[128:143]
    ds_read_b64_tr_b16 v[72:73], v9 offset:18432
    s_add_u32 m0, s73, 73728
    s_nop 0
    buffer_load_dwordx4 v4, s[36:39], s81 offen lds
    v_mfma_f32_32x32x16_bf16 v[144:159], v[92:95], a[76:79], v[144:159]
    ds_read_b64_tr_b16 v[74:75], v9 offset:18944
    v_mfma_f32_32x32x16_bf16 v[160:175], v[88:91], a[188:191], v[160:175]
    ds_read_b64_tr_b16 v[76:77], v9 offset:26624
    buffer_load_dwordx4 v5, s[36:39], s81 offen offset:1024 lds
    v_mfma_f32_32x32x16_bf16 v[176:191], v[92:95], a[188:191], v[176:191]
    ds_read_b64_tr_b16 v[78:79], v9 offset:27136
    s_waitcnt lgkmcnt(4)
    v_mfma_f32_32x32x16_bf16 v[128:143], v[64:67], a[80:83], v[128:143]
    ds_read_b64_tr_b16 v[80:81], v9 offset:20480
    s_bfe_u32 s81, s53, 0x40008
    s_mul_i32 s81, s81, s82
    s_add_u32 m0, s73, 114688
    s_nop 0
    buffer_load_dwordx4 v4, s[32:35], s81 offen lds
    v_mfma_f32_32x32x16_bf16 v[144:159], v[68:71], a[80:83], v[144:159]
    ds_read_b64_tr_b16 v[82:83], v9 offset:20992
    v_mfma_f32_32x32x16_bf16 v[160:175], v[64:67], a[192:195], v[160:175]
    ds_read_b64_tr_b16 v[84:85], v9 offset:28672
    buffer_load_dwordx4 v5, s[32:35], s81 offen offset:1024 lds
    v_mfma_f32_32x32x16_bf16 v[176:191], v[68:71], a[192:195], v[176:191]
    ds_read_b64_tr_b16 v[86:87], v9 offset:29184
    s_waitcnt lgkmcnt(4)
    v_mfma_f32_32x32x16_bf16 v[128:143], v[72:75], a[84:87], v[128:143]
    ds_read_b64_tr_b16 v[88:89], v9 offset:22528
    s_add_u32 m0, s73, 122880
    s_nop 0
    buffer_load_dwordx4 v4, s[36:39], s81 offen lds
    buffer_load_dword v18, v17, s[28:31], s60 offen sc1
    v_mfma_f32_32x32x16_bf16 v[144:159], v[76:79], a[84:87], v[144:159]
    ds_read_b64_tr_b16 v[90:91], v9 offset:23040
    v_mfma_f32_32x32x16_bf16 v[160:175], v[72:75], a[196:199], v[160:175]
    ds_read_b64_tr_b16 v[92:93], v9 offset:30720
    buffer_load_dwordx4 v5, s[36:39], s81 offen offset:1024 lds
    v_mfma_f32_32x32x16_bf16 v[176:191], v[76:79], a[196:199], v[176:191]
    ds_read_b64_tr_b16 v[94:95], v9 offset:31232
    s_waitcnt lgkmcnt(4)
    v_mfma_f32_32x32x16_bf16 v[128:143], v[80:83], a[88:91], v[128:143]
    s_waitcnt lgkmcnt(0)
    s_waitcnt vmcnt(28)
    s_barrier
    ds_read_b64_tr_b16 v[64:65], v9 offset:32768
    v_mfma_f32_32x32x16_bf16 v[144:159], v[84:87], a[88:91], v[144:159]
    ds_read_b64_tr_b16 v[66:67], v9 offset:33280
    s_bfe_u32 s81, s53, 0x4000c
    s_mul_i32 s81, s81, s82
    s_add_u32 m0, s73, 81920
    s_nop 0
    buffer_load_dwordx4 v4, s[32:35], s81 offen lds
    v_mfma_f32_32x32x16_bf16 v[160:175], v[80:83], a[200:203], v[160:175]
    ds_read_b64_tr_b16 v[68:69], v9 offset:40960
    buffer_load_dwordx4 v5, s[32:35], s81 offen offset:1024 lds
    v_mfma_f32_32x32x16_bf16 v[176:191], v[84:87], a[200:203], v[176:191]
    ds_read_b64_tr_b16 v[70:71], v9 offset:41472
    v_mfma_f32_32x32x16_bf16 v[128:143], v[88:91], a[92:95], v[128:143]
    ds_read_b64_tr_b16 v[72:73], v9 offset:34816
    s_add_u32 m0, s73, 90112
    s_nop 0
    buffer_load_dwordx4 v4, s[36:39], s81 offen lds
    v_mfma_f32_32x32x16_bf16 v[144:159], v[92:95], a[92:95], v[144:159]
    ds_read_b64_tr_b16 v[74:75], v9 offset:35328
    v_mfma_f32_32x32x16_bf16 v[160:175], v[88:91], a[204:207], v[160:175]
    ds_read_b64_tr_b16 v[76:77], v9 offset:43008
    buffer_load_dwordx4 v5, s[36:39], s81 offen offset:1024 lds
    v_mfma_f32_32x32x16_bf16 v[176:191], v[92:95], a[204:207], v[176:191]
    ds_read_b64_tr_b16 v[78:79], v9 offset:43520
    s_waitcnt lgkmcnt(4)
    v_mfma_f32_32x32x16_bf16 v[128:143], v[64:67], a[96:99], v[128:143]
    ds_read_b64_tr_b16 v[80:81], v9 offset:36864
    s_bfe_u32 s81, s54, 0x40000
    s_mul_i32 s81, s81, s82
    s_add_u32 m0, s73, 131072
    s_nop 0
    buffer_load_dwordx4 v4, s[32:35], s81 offen lds
    v_mfma_f32_32x32x16_bf16 v[144:159], v[68:71], a[96:99], v[144:159]
    ds_read_b64_tr_b16 v[82:83], v9 offset:37376
    v_mfma_f32_32x32x16_bf16 v[160:175], v[64:67], a[208:211], v[160:175]
    ds_read_b64_tr_b16 v[84:85], v9 offset:45056
    buffer_load_dwordx4 v5, s[32:35], s81 offen offset:1024 lds
    v_mfma_f32_32x32x16_bf16 v[176:191], v[68:71], a[208:211], v[176:191]
    ds_read_b64_tr_b16 v[86:87], v9 offset:45568
    s_waitcnt lgkmcnt(4)
    v_mfma_f32_32x32x16_bf16 v[128:143], v[72:75], a[100:103], v[128:143]
    ds_read_b64_tr_b16 v[88:89], v9 offset:38912
    s_add_u32 m0, s73, 139264
    s_nop 0
    buffer_load_dwordx4 v4, s[36:39], s81 offen lds
    v_mfma_f32_32x32x16_bf16 v[144:159], v[76:79], a[100:103], v[144:159]
    ds_read_b64_tr_b16 v[90:91], v9 offset:39424
    v_mfma_f32_32x32x16_bf16 v[160:175], v[72:75], a[212:215], v[160:175]
    ds_read_b64_tr_b16 v[92:93], v9 offset:47104
    buffer_load_dwordx4 v5, s[36:39], s81 offen offset:1024 lds
    v_mfma_f32_32x32x16_bf16 v[176:191], v[76:79], a[212:215], v[176:191]
    ds_read_b64_tr_b16 v[94:95], v9 offset:47616
    s_waitcnt lgkmcnt(4)
    v_mfma_f32_32x32x16_bf16 v[128:143], v[80:83], a[104:107], v[128:143]
    v_mfma_f32_32x32x16_bf16 v[144:159], v[84:87], a[104:107], v[144:159]
    v_mfma_f32_32x32x16_bf16 v[160:175], v[80:83], a[216:219], v[160:175]
    v_mfma_f32_32x32x16_bf16 v[176:191], v[84:87], a[216:219], v[176:191]
    s_waitcnt lgkmcnt(0)
    v_mfma_f32_32x32x16_bf16 v[128:143], v[88:91], a[108:111], v[128:143]
    v_mfma_f32_32x32x16_bf16 v[144:159], v[92:95], a[108:111], v[144:159]
    v_mfma_f32_32x32x16_bf16 v[160:175], v[88:91], a[220:223], v[160:175]
    v_mfma_f32_32x32x16_bf16 v[176:191], v[92:95], a[220:223], v[176:191]
    s_lshr_b32 s78, s78, 8
Lp2:
    s_barrier
    s_bfe_u32 s87, s78, 0x80000
    s_lshl_b32 s87, s87, 12
    s_add_u32 s57, s87, s58
    s_mov_b64 s[44:45], s[22:23]
    s_mov_b32 s46, 1835008
    s_mov_b32 s92, 0x8000
Lck_6:
    v_cmp_eq_u32 vcc, s79, v18
    s_sub_u32 s92, s92, 1
    s_cbranch_scc1 Lcd_7
    s_andn2_b32 s87, 0x3f, vcc_lo
    s_cbranch_scc0 Lcd_7
    buffer_load_dword v18, v17, s[28:31], s60 offen sc1
    s_sleep 4
    s_branch Lck_6
Lcd_7:
    s_mov_b32 s92, 0x8000
    s_mov_b32 s48, 0xc0135761
    s_mov_b32 s49, 0xc0135761
    v_mov_b32 v112, v21
    s_bfe_u32 s88, s52, 0x40000
    s_lshl_b32 s88, s88, 13
    s_add_u32 s65, s88, s61
    buffer_load_dwordx4 a[0:3], v1, s[28:31], s65 offen sc1
    v_pk_mul_f32 v[96:97], v[128:129], v[128:129]
    v_pk_mul_f32 v[144:145], v[128:129], v[144:145]
    v_pk_fma_f32 v[96:97], v[96:97], v[112:113], s[48:49] op_sel_hi:[1,0,1]
    v_pk_mul_f32 v[98:99], v[130:131], v[130:131]
    v_pk_mul_f32 v[146:147], v[130:131], v[146:147]
    v_pk_mul_f32 v[128:129], v[96:97], v[128:129]
    v_pk_fma_f32 v[98:99], v[98:99], v[112:113], s[48:49] op_sel_hi:[1,0,1]
    v_pk_mul_f32 v[100:101], v[132:133], v[132:133]
    v_pk_mul_f32 v[148:149], v[132:133], v[148:149]
    v_exp_f32 v128, v128
    v_pk_mul_f32 v[130:131], v[98:99], v[130:131]
    s_add_u32 s65, s65, 114688
    buffer_load_dwordx4 a[4:7], v1, s[28:31], s65 offen sc1
    v_exp_f32 v129, v129
    v_pk_fma_f32 v[100:101], v[100:101], v[112:113], s[48:49] op_sel_hi:[1,0,1]
    v_pk_mul_f32 v[102:103], v[134:135], v[134:135]
    v_pk_mul_f32 v[150:151], v[134:135], v[150:151]
    v_exp_f32 v130, v130
    v_pk_add_f32 v[128:129], v[128:129], 1.0 op_sel_hi:[1,0]
    v_pk_mul_f32 v[132:133], v[100:101], v[132:133]
    v_exp_f32 v131, v131
    v_pk_fma_f32 v[102:103], v[102:103], v[112:113], s[48:49] op_sel_hi:[1,0,1]
    v_pk_mul_f32 v[96:97], v[136:137], v[136:137]
    v_pk_mul_f32 v[152:153], v[136:137], v[152:153]
    s_bfe_u32 s88, s52, 0x40000
    s_lshl_b32 s88, s88, 13
    s_add_u32 s65, s88, s61
    s_add_u32 s65, s65, 4096
    buffer_load_dwordx4 a[8:11], v1, s[28:31], s65 offen sc1
    v_rcp_f32 v128, v128
    v_exp_f32 v132, v132
    v_pk_add_f32 v[130:131], v[130:131], 1.0 op_sel_hi:[1,0]
    v_pk_mul_f32 v[134:135], v[102:103], v[134:135]
    v_rcp_f32 v129, v129
    v_exp_f32 v133, v133
    v_pk_fma_f32 v[96:97], v[96:97], v[112:113], s[48:49] op_sel_hi:[1,0,1]
    v_pk_mul_f32 v[98:99], v[138:139], v[138:139]
    v_pk_mul_f32 v[154:155], v[138:139], v[154:155]
    v_rcp_f32 v130, v130
    v_exp_f32 v134, v134
    s_add_u32 s65, s65, 114688
    buffer_load_dwordx4 a[12:15], v1, s[28:31], s65 offen sc1
    v_pk_mul_f32 v[144:145], v[144:145], v[128:129]
    v_pk_add_f32 v[132:133], v[132:133], 1.0 op_sel_hi:[1,0]
    v_pk_mul_f32 v[136:137], v[96:97], v[136:137]
    v_rcp_f32 v131, v131
    v_exp_f32 v135, v135
    v_pk_fma_f32 v[98:99], v[98:99], v[112:113], s[48:49] op_sel_hi:[1,0,1]
    v_pk_mul_f32 v[100:101], v[140:141], v[140:141]
    v_pk_mul_f32 v[156:157], v[140:141], v[156:157]
    v_rcp_f32 v132, v132
    v_exp_f32 v136, v136
    v_pk_mul_f32 v[146:147], v[146:147], v[130:131]
    v_pk_add_f32 v[134:135], v[134:135], 1.0 op_sel_hi:[1,0]
    s_bfe_u32 s88, s52, 0x40004
    s_lshl_b32 s88, s88, 13
    s_add_u32 s65, s88, s61
    buffer_load_dwordx4 a[16:19], v1, s[28:31], s65 offen sc1
    v_pk_mul_f32 v[138:139], v[98:99], v[138:139]
    v_rcp_f32 v133, v133
    v_exp_f32 v137, v137
    v_pk_fma_f32 v[100:101], v[100:101], v[112:113], s[48:49] op_sel_hi:[1,0,1]
    v_pk_mul_f32 v[102:103], v[142:143], v[142:143]
    v_pk_mul_f32 v[158:159], v[142:143], v[158:159]
    v_rcp_f32 v134, v134
    v_exp_f32 v138, v138
    v_pk_mul_f32 v[148:149], v[148:149], v[132:133]
    v_pk_add_f32 v[136:137], v[136:137], 1.0 op_sel_hi:[1,0]
    v_pk_mul_f32 v[140:141], v[100:101], v[140:141]
    s_add_u32 s65, s65, 114688
    buffer_load_dwordx4 a[20:23], v1, s[28:31], s65 offen sc1
    v_rcp_f32 v135, v135
    v_exp_f32 v139, v139
    v_pk_fma_f32 v[102:103], v[102:103], v[112:113], s[48:49] op_sel_hi:[1,0,1]
    v_pk_mul_f32 v[96:97], v[160:161], v[160:161]
    v_pk_mul_f32 v[176:177], v[160:161], v[176:177]
    v_rcp_f32 v136, v136
    v_exp_f32 v140, v140
    v_pk_mul_f32 v[150:151], v[150:151], v[134:135]
    v_pk_add_f32 v[138:139], v[138:139], 1.0 op_sel_hi:[1,0]
    v_pk_mul_f32 v[142:143], v[102:103], v[142:143]
    v_rcp_f32 v137, v137
    s_bfe_u32 s88, s52, 0x40004
    s_lshl_b32 s88, s88, 13
    s_add_u32 s65, s88, s61
    s_add_u32 s65, s65, 4096
    buffer_load_dwordx4 a[24:27], v1, s[28:31], s65 offen sc1
    v_pk_fma_f32 v[96:97], v[96:97], v[112:113], s[48:49] op_sel_hi:[1,0,1]
    v_exp_f32 v141, v141
    v_cvt_pk_bf16_f32 v128, v144, v145
    v_pk_mul_f32 v[98:99], v[162:163], v[162:163]
    v_cvt_pk_bf16_f32 v129, v146, v147
    v_cvt_pk_bf16_f32 v130, v148, v149
    v_cvt_pk_bf16_f32 v131, v150, v151
    v_pk_mul_f32 v[178:179], v[162:163], v[178:179]
    v_rcp_f32 v138, v138
    buffer_store_dwordx4 v[128:131], v1, s[28:31], s57 offen offset:0 sc1
    v_exp_f32 v142, v142
    v_pk_mul_f32 v[152:153], v[152:153], v[136:137]
    s_add_u32 s65, s65, 114688
    buffer_load_dwordx4 a[28:31], v1, s[28:31], s65 offen sc1
    v_pk_add_f32 v[140:141], v[140:141], 1.0 op_sel_hi:[1,0]
    v_pk_mul_f32 v[160:161], v[96:97], v[160:161]
    v_rcp_f32 v139, v139
    v_pk_fma_f32 v[98:99], v[98:99], v[112:113], s[48:49] op_sel_hi:[1,0,1]
    v_exp_f32 v143, v143
    v_pk_mul_f32 v[100:101], v[164:165], v[164:165]
    v_pk_mul_f32 v[180:181], v[164:165], v[180:181]
    v_rcp_f32 v140, v140
    v_exp_f32 v160, v160
    v_pk_mul_f32 v[154:155], v[154:155], v[138:139]
    v_pk_add_f32 v[142:143], v[142:143], 1.0 op_sel_hi:[1,0]
    s_bfe_u32 s81, s54, 0x40004
    s_mul_i32 s81, s81, s82
    s_add_u32 m0, s73, 98304
    s_nop 0
    buffer_load_dwordx4 v4, s[32:35], s81 offen lds
    v_pk_mul_f32 v[162:163], v[98:99], v[162:163]
    v_rcp_f32 v141, v141
    v_exp_f32 v161, v161
    v_pk_fma_f32 v[100:101], v[100:101], v[112:113], s[48:49] op_sel_hi:[1,0,1]
    v_pk_mul_f32 v[102:103], v[166:167], v[166:167]
    v_pk_mul_f32 v[182:183], v[166:167], v[182:183]
    v_rcp_f32 v142, v142
    v_exp_f32 v162, v162
    v_pk_add_f32 v[160:161], v[160:161], 1.0 op_sel_hi:[1,0]
    v_pk_mul_f32 v[156:157], v[156:157], v[140:141]
    v_pk_mul_f32 v[164:165], v[100:101], v[164:165]
    buffer_load_dwordx4 v5, s[32:35], s81 offen offset:1024 lds
    v_rcp_f32 v143, v143
    v_exp_f32 v163, v163
    v_pk_fma_f32 v[102:103], v[102:103], v[112:113], s[48:49] op_sel_hi:[1,0,1]
    v_pk_mul_f32 v[96:97], v[168:169], v[168:169]
    v_pk_mul_f32 v[184:185], v[168:169], v[184:185]
    v_rcp_f32 v160, v160
    v_exp_f32 v164, v164
    v_pk_add_f32 v[162:163], v[162:163], 1.0 op_sel_hi:[1,0]
    v_pk_mul_f32 v[158:159], v[158:159], v[142:143]
    v_pk_mul_f32 v[166:167], v[102:103], v[166:167]
    v_rcp_f32 v161, v161
    v_exp_f32 v165, v165
    s_add_u32 m0, s73, 106496
    s_nop 0
    buffer_load_dwordx4 v4, s[36:39], s81 offen lds
    v_pk_fma_f32 v[96:97], v[96:97], v[112:113], s[48:49] op_sel_hi:[1,0,1]
    v_cvt_pk_bf16_f32 v136, v152, v153
    v_pk_mul_f32 v[98:99], v[170:171], v[170:171]
    v_cvt_pk_bf16_f32 v137, v154, v155
    v_cvt_pk_bf16_f32 v138, v156, v157
    v_cvt_pk_bf16_f32 v139, v158, v159
    v_pk_mul_f32 v[186:187], v[170:171], v[186:187]
    v_rcp_f32 v162, v162
    v_exp_f32 v166, v166
    buffer_store_dwordx4 v[136:139], v1, s[28:31], s57 offen offset:1024 sc1
    v_pk_mul_f32 v[176:177], v[176:177], v[160:161]
    buffer_load_dwordx4 v5, s[36:39], s81 offen offset:1024 lds
    v_pk_add_f32 v[164:165], v[164:165], 1.0 op_sel_hi:[1,0]
    v_pk_mul_f32 v[168:169], v[96:97], v[168:169]
    v_rcp_f32 v163, v163
    v_exp_f32 v167, v167
    v_pk_fma_f32 v[98:99], v[98:99], v[112:113], s[48:49] op_sel_hi:[1,0,1]
    v_pk_mul_f32 v[100:101], v[172:173], v[172:173]
    v_pk_mul_f32 v[188:189], v[172:173], v[188:189]
    v_rcp_f32 v164, v164
    v_exp_f32 v168, v168
    v_pk_mul_f32 v[178:179], v[178:179], v[162:163]
    v_pk_add_f32 v[166:167], v[166:167], 1.0 op_sel_hi:[1,0]
    s_bfe_u32 s88, s52, 0x40008
    s_lshl_b32 s88, s88, 13
    s_add_u32 s65, s88, s61
    buffer_load_dwordx4 a[32:35], v1, s[28:31], s65 offen sc1
    v_pk_mul_f32 v[170:171], v[98:99], v[170:171]
    v_rcp_f32 v165, v165
    v_exp_f32 v169, v169
    v_pk_fma_f32 v[100:101], v[100:101], v[112:113], s[48:49] op_sel_hi:[1,0,1]
    v_pk_mul_f32 v[102:103], v[174:175], v[174:175]
    v_pk_mul_f32 v[190:191], v[174:175], v[190:191]
    v_rcp_f32 v166, v166
    v_exp_f32 v170, v170
    v_pk_mul_f32 v[180:181], v[180:181], v[164:165]
    v_pk_add_f32 v[168:169], v[168:169], 1.0 op_sel_hi:[1,0]
    v_pk_mul_f32 v[172:173], v[100:101], v[172:173]
    v_rcp_f32 v167, v167
    s_add_u32 s65, s65, 114688
    buffer_load_dwordx4 a[36:39], v1, s[28:31], s65 offen sc1
    v_exp_f32 v171, v171
    v_pk_fma_f32 v[102:103], v[102:103], v[112:113], s[48:49] op_sel_hi:[1,0,1]
    v_rcp_f32 v168, v168
    v_exp_f32 v172, v172
    v_pk_mul_f32 v[182:183], v[182:183], v[166:167]
    v_pk_add_f32 v[170:171], v[170:171], 1.0 op_sel_hi:[1,0]
    v_pk_mul_f32 v[174:175], v[102:103], v[174:175]
    v_rcp_f32 v169, v169
    v_exp_f32 v173, v173
    v_cvt_pk_bf16_f32 v160, v176, v177
    v_cvt_pk_bf16_f32 v161, v178, v179
    s_bfe_u32 s88, s52, 0x40008
    s_lshl_b32 s88, s88, 13
    s_add_u32 s65, s88, s61
    s_add_u32 s65, s65, 4096
    buffer_load_dwordx4 a[40:43], v1, s[28:31], s65 offen sc1
    v_cvt_pk_bf16_f32 v162, v180, v181
    v_cvt_pk_bf16_f32 v163, v182, v183
    v_rcp_f32 v170, v170
    s_add_u32 s57, s57, 114688
    buffer_store_dwordx4 v[160:163], v1, s[28:31], s57 offen offset:0 sc1
    v_exp_f32 v174, v174
    v_pk_mul_f32 v[184:185], v[184:185], v[168:169]
    v_pk_add_f32 v[172:173], v[172:173], 1.0 op_sel_hi:[1,0]
    v_rcp_f32 v171, v171
    v_exp_f32 v175, v175
    v_rcp_f32 v172, v172
    v_pk_mul_f32 v[186:187], v[186:187], v[170:171]
    s_add_u32 s65, s65, 114688
    buffer_load_dwordx4 a[44:47], v1, s[28:31], s65 offen sc1
    v_pk_add_f32 v[174:175], v[174:175], 1.0 op_sel_hi:[1,0]
    v_rcp_f32 v173, v173
    v_rcp_f32 v174, v174
    v_pk_mul_f32 v[188:189], v[188:189], v[172:173]
    v_rcp_f32 v175, v175
    s_nop 0
    v_pk_mul_f32 v[190:191], v[190:191], v[174:175]
    v_cvt_pk_bf16_f32 v168, v184, v185
    v_cvt_pk_bf16_f32 v169, v186, v187
    v_cvt_pk_bf16_f32 v170, v188, v189
    v_cvt_pk_bf16_f32 v171, v190, v191
    buffer_store_dwordx4 v[168:171], v1, s[28:31], s57 offen offset:1024 sc1
    s_mov_b32 s92, 0x8000
Lck_8:
    v_cmp_eq_u32 vcc, s79, v18
    s_sub_u32 s92, s92, 1
    s_cbranch_scc1 Lcd_9
    s_andn2_b32 s87, 0x3000, vcc_lo
    s_cbranch_scc0 Lcd_9
    buffer_load_dword v18, v17, s[28:31], s60 offen sc1
    s_sleep 4
    s_branch Lck_8
Lcd_9:
    s_mov_b32 s92, 0x8000
    s_bfe_u32 s88, s53, 0x40000
    s_lshl_b32 s88, s88, 13
    s_add_u32 s65, s88, s61
    buffer_load_dwordx4 a[48:51], v1, s[28:31], s65 offen sc1
    s_add_u32 s65, s65, 114688
    buffer_load_dwordx4 a[52:55], v1, s[28:31], s65 offen sc1
    s_bfe_u32 s88, s53, 0x40000
    s_lshl_b32 s88, s88, 13
    s_add_u32 s65, s88, s61
    s_add_u32 s65, s65, 4096
    buffer_load_dwordx4 a[56:59], v1, s[28:31], s65 offen sc1
    s_add_u32 s65, s65, 114688
    buffer_load_dwordx4 a[60:63], v1, s[28:31], s65 offen sc1
    s_waitcnt vmcnt(52)
    ds_read_b64_tr_b16 v[64:65], v24 offset:0
    ds_read_b64_tr_b16 v[66:67], v24 offset:1024
    ds_read_b64_tr_b16 v[68:69], v27 offset:0
    ds_read_b64_tr_b16 v[70:71], v27 offset:1024
    ds_read_b64_tr_b16 v[72:73], v24 offset:8192
    ds_read_b64_tr_b16 v[74:75], v24 offset:9216
    ds_read_b64_tr_b16 v[76:77], v27 offset:8192
    ds_read_b64_tr_b16 v[78:79], v27 offset:9216
    s_waitcnt vmcnt(22)
    s_waitcnt lgkmcnt(4)
    v_mfma_f32_32x32x16_bf16 v[192:207], v[64:67], a[0:3], 0
    ds_read_b64_tr_b16 v[80:81], v24 offset:16384
    s_bfe_u32 s88, s53, 0x40004
    s_lshl_b32 s88, s88, 13
    s_add_u32 s65, s88, s61
    buffer_load_dwordx4 a[64:67], v1, s[28:31], s65 offen sc1
    v_mfma_f32_32x32x16_bf16 v[208:223], v[68:71], a[0:3], 0
    ds_read_b64_tr_b16 v[82:83], v24 offset:17408
    v_mfma_f32_32x32x16_bf16 v[224:239], v[64:67], a[4:7], 0
    ds_read_b64_tr_b16 v[84:85], v27 offset:16384
    s_add_u32 s65, s65, 114688
    buffer_load_dwordx4 a[68:71], v1, s[28:31], s65 offen sc1
    v_mfma_f32_32x32x16_bf16 v[240:255], v[68:71], a[4:7], 0
    ds_read_b64_tr_b16 v[86:87], v27 offset:17408
    s_waitcnt vmcnt(22)
    s_waitcnt lgkmcnt(4)
    v_mfma_f32_32x32x16_bf16 v[192:207], v[72:75], a[8:11], v[192:207]
    ds_read_b64_tr_b16 v[88:89], v24 offset:24576
    s_bfe_u32 s88, s53, 0x40004
    s_lshl_b32 s88, s88, 13
    s_add_u32 s65, s88, s61
    s_add_u32 s65, s65, 4096
    buffer_load_dwordx4 a[72:75], v1, s[28:31], s65 offen sc1
    v_mfma_f32_32x32x16_bf16 v[208:223], v[76:79], a[8:11], v[208:223]
    ds_read_b64_tr_b16 v[90:91], v24 offset:25600
    s_add_u32 s65, s65, 114688
    buffer_load_dwordx4 a[76:79], v1, s[28:31], s65 offen sc1
    v_mfma_f32_32x32x16_bf16 v[224:239], v[72:75], a[12:15], v[224:239]
    ds_read_b64_tr_b16 v[92:93], v27 offset:24576
    s_bfe_u32 s88, s53, 0x40008
    s_lshl_b32 s88, s88, 13
    s_add_u32 s65, s88, s61
    buffer_load_dwordx4 a[80:83], v1, s[28:31], s65 offen sc1
    v_mfma_f32_32x32x16_bf16 v[240:255], v[76:79], a[12:15], v[240:255]
    ds_read_b64_tr_b16 v[94:95], v27 offset:25600
    s_add_u32 s65, s65, 114688
    buffer_load_dwordx4 a[84:87], v1, s[28:31], s65 offen sc1
    s_waitcnt vmcnt(24)
    s_waitcnt lgkmcnt(4)
    v_mfma_f32_32x32x16_bf16 v[192:207], v[80:83], a[16:19], v[192:207]
    ds_read_b64_tr_b16 v[64:65], v24 offset:32768
    s_bfe_u32 s88, s53, 0x40008
    s_lshl_b32 s88, s88, 13
    s_add_u32 s65, s88, s61
    s_add_u32 s65, s65, 4096
    buffer_load_dwordx4 a[88:91], v1, s[28:31], s65 offen sc1
    v_mfma_f32_32x32x16_bf16 v[208:223], v[84:87], a[16:19], v[208:223]
    ds_read_b64_tr_b16 v[66:67], v24 offset:33792
    v_mfma_f32_32x32x16_bf16 v[224:239], v[80:83], a[20:23], v[224:239]
    ds_read_b64_tr_b16 v[68:69], v27 offset:32768
    s_add_u32 s65, s65, 114688
    buffer_load_dwordx4 a[92:95], v1, s[28:31], s65 offen sc1
    v_mfma_f32_32x32x16_bf16 v[240:255], v[84:87], a[20:23], v[240:255]
    ds_read_b64_tr_b16 v[70:71], v27 offset:33792
    s_waitcnt vmcnt(23)
    s_waitcnt lgkmcnt(4)
    v_mfma_f32_32x32x16_bf16 v[192:207], v[88:91], a[24:27], v[192:207]
    ds_read_b64_tr_b16 v[72:73], v24 offset:40960
    s_bfe_u32 s88, s53, 0x4000c
    s_lshl_b32 s88, s88, 13
    s_add_u32 s65, s88, s61
    buffer_load_dwordx4 a[96:99], v1, s[28:31], s65 offen sc1
    v_mfma_f32_32x32x16_bf16 v[208:223], v[92:95], a[24:27], v[208:223]
    ds_read_b64_tr_b16 v[74:75], v24 offset:41984
    s_add_u32 s65, s65, 114688
    buffer_load_dwordx4 a[100:103], v1, s[28:31], s65 offen sc1
    v_mfma_f32_32x32x16_bf16 v[224:239], v[88:91], a[28:31], v[224:239]
    ds_read_b64_tr_b16 v[76:77], v27 offset:40960
    s_bfe_u32 s88, s53, 0x4000c
    s_lshl_b32 s88, s88, 13
    s_add_u32 s65, s88, s61
    s_add_u32 s65, s65, 4096
    buffer_load_dwordx4 a[104:107], v1, s[28:31], s65 offen sc1
    v_mfma_f32_32x32x16_bf16 v[240:255], v[92:95], a[28:31], v[240:255]
    ds_read_b64_tr_b16 v[78:79], v27 offset:41984
    s_add_u32 s65, s65, 114688
    buffer_load_dwordx4 a[108:111], v1, s[28:31], s65 offen sc1
    s_waitcnt vmcnt(20)
    s_waitcnt lgkmcnt(4)
    v_mfma_f32_32x32x16_bf16 v[192:207], v[64:67], a[32:35], v[192:207]
    ds_read_b64_tr_b16 v[80:81], v24 offset:49152
    s_bfe_u32 s81, s54, 0x40008
    s_mul_i32 s81, s81, s82
    s_add_u32 m0, s73, 0
    s_nop 0
    buffer_load_dwordx4 v4, s[32:35], s81 offen lds
    v_mfma_f32_32x32x16_bf16 v[208:223], v[68:71], a[32:35], v[208:223]
    ds_read_b64_tr_b16 v[82:83], v24 offset:50176
    v_mfma_f32_32x32x16_bf16 v[224:239], v[64:67], a[36:39], v[224:239]
    ds_read_b64_tr_b16 v[84:85], v27 offset:49152
    buffer_load_dwordx4 v5, s[32:35], s81 offen offset:1024 lds
    v_mfma_f32_32x32x16_bf16 v[240:255], v[68:71], a[36:39], v[240:255]
    ds_read_b64_tr_b16 v[86:87], v27 offset:50176
    s_waitcnt vmcnt(19)
    s_waitcnt lgkmcnt(4)
    v_mfma_f32_32x32x16_bf16 v[192:207], v[72:75], a[40:43], v[192:207]
    ds_read_b64_tr_b16 v[88:89], v24 offset:57344
    s_add_u32 m0, s73, 8192
    s_nop 0
    buffer_load_dwordx4 v4, s[36:39], s81 offen lds
    v_mfma_f32_32x32x16_bf16 v[208:223], v[76:79], a[40:43], v[208:223]
    ds_read_b64_tr_b16 v[90:91], v24 offset:58368
    buffer_load_dwordx4 v5, s[36:39], s81 offen offset:1024 lds
    v_mfma_f32_32x32x16_bf16 v[224:239], v[72:75], a[44:47], v[224:239]
    ds_read_b64_tr_b16 v[92:93], v27 offset:57344
    s_bfe_u32 s81, s54, 0x4000c
    s_mul_i32 s81, s81, s82
    s_add_u32 m0, s73, 16384
    s_nop 0
    buffer_load_dwordx4 v4, s[32:35], s81 offen lds
    v_mfma_f32_32x32x16_bf16 v[240:255], v[76:79], a[44:47], v[240:255]
    ds_read_b64_tr_b16 v[94:95], v27 offset:58368
    buffer_load_dwordx4 v5, s[32:35], s81 offen offset:1024 lds
    s_waitcnt vmcnt(20)
Lv_10:
    v_accvgpr_read_b32 v12, a51
    v_accvgpr_read_b32 v13, a55
    v_max_u32 v12, v12, v13
    v_cmp_eq_u32 vcc, -1, v12
    s_cbranch_vccz Lvd_11
    s_call_b64 s[98:99], Lrl1
    s_branch Lv_10
Lvd_11:
    s_waitcnt lgkmcnt(4)
    v_mfma_f32_32x32x16_bf16 v[192:207], v[80:83], a[48:51], v[192:207]
    ds_read_b64_tr_b16 v[64:65], v25 offset:0
    s_add_u32 m0, s73, 24576
    s_nop 0
    buffer_load_dwordx4 v4, s[36:39], s81 offen lds
    v_mfma_f32_32x32x16_bf16 v[208:223], v[84:87], a[48:51], v[208:223]
    ds_read_b64_tr_b16 v[66:67], v25 offset:1024
    v_mfma_f32_32x32x16_bf16 v[224:239], v[80:83], a[52:55], v[224:239]
    ds_read_b64_tr_b16 v[68:69], v28 offset:0
    buffer_load_dwordx4 v5, s[36:39], s81 offen offset:1024 lds
    v_mfma_f32_32x32x16_bf16 v[240:255], v[84:87], a[52:55], v[240:255]
    ds_read_b64_tr_b16 v[70:71], v28 offset:1024
    s_waitcnt vmcnt(20)
Lv_12:
    v_accvgpr_read_b32 v12, a59
    v_accvgpr_read_b32 v13, a63
    v_max_u32 v12, v12, v13
    v_cmp_eq_u32 vcc, -1, v12
    s_cbranch_vccz Lvd_13
    s_call_b64 s[98:99], Lrl1
    s_branch Lv_12
Lvd_13:
    s_waitcnt lgkmcnt(4)
    v_mfma_f32_32x32x16_bf16 v[192:207], v[88:91], a[56:59], v[192:207]
    ds_read_b64_tr_b16 v[72:73], v25 offset:8192
    s_bfe_u32 s81, s54, 0x40010
    s_mul_i32 s81, s81, s82
    s_add_u32 m0, s73, 32768
    s_nop 0
    buffer_load_dwordx4 v4, s[32:35], s81 offen lds
    v_mfma_f32_32x32x16_bf16 v[208:223], v[92:95], a[56:59], v[208:223]
    ds_read_b64_tr_b16 v[74:75], v25 offset:9216
    buffer_load_dwordx4 v5, s[32:35], s81 offen offset:1024 lds
    v_mfma_f32_32x32x16_bf16 v[224:239], v[88:91], a[60:63], v[224:239]
    ds_read_b64_tr_b16 v[76:77], v28 offset:8192
    s_add_u32 m0, s73, 40960
    s_nop 0
    buffer_load_dwordx4 v4, s[36:39], s81 offen lds
    v_mfma_f32_32x32x16_bf16 v[240:255], v[92:95], a[60:63], v[240:255]
    ds_read_b64_tr_b16 v[78:79], v28 offset:9216
    buffer_load_dwordx4 v5, s[36:39], s81 offen offset:1024 lds
    s_waitcnt vmcnt(22)
Lv_14:
    v_accvgpr_read_b32 v12, a67
    v_accvgpr_read_b32 v13, a71
    v_max_u32 v12, v12, v13
    v_cmp_eq_u32 vcc, -1, v12
    s_cbranch_vccz Lvd_15
    s_call_b64 s[98:99], Lrl1
    s_branch Lv_14
Lvd_15:
    s_waitcnt lgkmcnt(4)
    v_mfma_f32_32x32x16_bf16 v[192:207], v[64:67], a[64:67], v[192:207]
    ds_read_b64_tr_b16 v[80:81], v25 offset:49152
    s_bfe_u32 s81, s54, 0x40014
    s_mul_i32 s81, s81, s82
    s_add_u32 m0, s73, 49152
    s_nop 0
    buffer_load_dwordx4 v4, s[32:35], s81 offen lds
    v_mfma_f32_32x32x16_bf16 v[208:223], v[68:71], a[64:67], v[208:223]
    ds_read_b64_tr_b16 v[82:83], v25 offset:50176
    v_mfma_f32_32x32x16_bf16 v[224:239], v[64:67], a[68:71], v[224:239]
    ds_read_b64_tr_b16 v[84:85], v28 offset:49152
    buffer_load_dwordx4 v5, s[32:35], s81 offen offset:1024 lds
    v_mfma_f32_32x32x16_bf16 v[240:255], v[68:71], a[68:71], v[240:255]
    ds_read_b64_tr_b16 v[86:87], v28 offset:50176
    s_waitcnt vmcnt(22)
Lv_16:
    v_accvgpr_read_b32 v12, a75
    v_accvgpr_read_b32 v13, a79
    v_max_u32 v12, v12, v13
    v_cmp_eq_u32 vcc, -1, v12
    s_cbranch_vccz Lvd_17
    s_call_b64 s[98:99], Lrl1
    s_branch Lv_16
Lvd_17:
    s_waitcnt lgkmcnt(4)
    v_mfma_f32_32x32x16_bf16 v[192:207], v[72:75], a[72:75], v[192:207]
    ds_read_b64_tr_b16 v[88:89], v25 offset:57344
    s_add_u32 m0, s73, 57344
    s_nop 0
    buffer_load_dwordx4 v4, s[36:39], s81 offen lds
    v_mfma_f32_32x32x16_bf16 v[208:223], v[76:79], a[72:75], v[208:223]
    ds_read_b64_tr_b16 v[90:91], v25 offset:58368
    v_mfma_f32_32x32x16_bf16 v[224:239], v[72:75], a[76:79], v[224:239]
    ds_read_b64_tr_b16 v[92:93], v28 offset:57344
    buffer_load_dwordx4 v5, s[36:39], s81 offen offset:1024 lds
    v_mfma_f32_32x32x16_bf16 v[240:255], v[76:79], a[76:79], v[240:255]
    ds_read_b64_tr_b16 v[94:95], v28 offset:58368
    s_waitcnt vmcnt(22)
Lv_18:
    v_accvgpr_read_b32 v12, a83
    v_accvgpr_read_b32 v13, a87
    v_max_u32 v12, v12, v13
    v_cmp_eq_u32 vcc, -1, v12
    s_cbranch_vccz Lvd_19
    s_call_b64 s[98:99], Lrl2
    s_branch Lv_18
Lvd_19:
    s_waitcnt lgkmcnt(4)
    v_mfma_f32_32x32x16_bf16 v[192:207], v[80:83], a[80:83], v[192:207]
    ds_read_b64_tr_b16 v[64:65], v25 offset:16384
    s_mov_b32 s92, 0x8000
Lck_20:
    v_cmp_eq_u32 vcc, s79, v18
    s_sub_u32 s92, s92, 1
    s_cbranch_scc1 Lcd_21
    s_andn2_b32 s87, 0xfc0, vcc_lo
    s_cbranch_scc0 Lcd_21
    buffer_load_dword v18, v17, s[28:31], s60 offen sc1
    s_sleep 4
    s_branch Lck_20
Lcd_21:
    s_mov_b32 s92, 0x8000
    s_bfe_u32 s88, s54, 0x40000
    s_lshl_b32 s88, s88, 13
    s_add_u32 s65, s88, s61
    buffer_load_dwordx4 a[112:115], v1, s[28:31], s65 offen sc1
    v_mfma_f32_32x32x16_bf16 v[208:223], v[84:87], a[80:83], v[208:223]
    ds_read_b64_tr_b16 v[66:67], v25 offset:17408
    s_add_u32 s65, s65, 114688
    buffer_load_dwordx4 a[116:119], v1, s[28:31], s65 offen sc1
    v_mfma_f32_32x32x16_bf16 v[224:239], v[80:83], a[84:87], v[224:239]
    ds_read_b64_tr_b16 v[68:69], v28 offset:16384
    s_bfe_u32 s88, s54, 0x40000
    s_lshl_b32 s88, s88, 13
    s_add_u32 s65, s88, s61
    s_add_u32 s65, s65, 4096
    buffer_load_dwordx4 a[120:123], v1, s[28:31], s65 offen sc1
    v_mfma_f32_32x32x16_bf16 v[240:255], v[84:87], a[84:87], v[240:255]
    ds_read_b64_tr_b16 v[70:71], v28 offset:17408
    s_add_u32 s65, s65, 114688
    buffer_load_dwordx4 a[124:127], v1, s[28:31], s65 offen sc1
    s_waitcnt vmcnt(24)
Lv_22:
    v_accvgpr_read_b32 v12, a91
    v_accvgpr_read_b32 v13, a95
    v_max_u32 v12, v12, v13
    v_cmp_eq_u32 vcc, -1, v12
    s_cbranch_vccz Lvd_23
    s_call_b64 s[98:99], Lrl2
    s_branch Lv_22
Lvd_23:
    s_waitcnt lgkmcnt(4)
    v_mfma_f32_32x32x16_bf16 v[192:207], v[88:91], a[88:91], v[192:207]
    ds_read_b64_tr_b16 v[72:73], v25 offset:24576
    s_bfe_u32 s88, s54, 0x40004
    s_lshl_b32 s88, s88, 13
    s_add_u32 s65, s88, s61
    buffer_load_dwordx4 a[128:131], v1, s[28:31], s65 offen sc1
    v_mfma_f32_32x32x16_bf16 v[208:223], v[92:95], a[88:91], v[208:223]
    ds_read_b64_tr_b16 v[74:75], v25 offset:25600
    s_add_u32 s65, s65, 114688
    buffer_load_dwordx4 a[132:135], v1, s[28:31], s65 offen sc1
    v_mfma_f32_32x32x16_bf16 v[224:239], v[88:91], a[92:95], v[224:239]
    ds_read_b64_tr_b16 v[76:77], v28 offset:24576
    s_bfe_u32 s88, s54, 0x40004
    s_lshl_b32 s88, s88, 13
    s_add_u32 s65, s88, s61
    s_add_u32 s65, s65, 4096
    buffer_load_dwordx4 a[136:139], v1, s[28:31], s65 offen sc1
    v_mfma_f32_32x32x16_bf16 v[240:255], v[92:95], a[92:95], v[240:255]
    ds_read_b64_tr_b16 v[78:79], v28 offset:25600
    s_add_u32 s65, s65, 114688
    buffer_load_dwordx4 a[140:143], v1, s[28:31], s65 offen sc1
    s_waitcnt vmcnt(26)
Lv_24:
    v_accvgpr_read_b32 v12, a99
    v_accvgpr_read_b32 v13, a103
    v_max_u32 v12, v12, v13
    v_cmp_eq_u32 vcc, -1, v12
    s_cbranch_vccz Lvd_25
    s_call_b64 s[98:99], Lrl2
    s_branch Lv_24
Lvd_25:
    s_waitcnt lgkmcnt(4)
    v_mfma_f32_32x32x16_bf16 v[192:207], v[64:67], a[96:99], v[192:207]
    ds_read_b64_tr_b16 v[80:81], v26 offset:0
    s_bfe_u32 s88, s54, 0x40008
    s_lshl_b32 s88, s88, 13
    s_add_u32 s65, s88, s61
    buffer_load_dwordx4 a[144:147], v1, s[28:31], s65 offen sc1
    v_mfma_f32_32x32x16_bf16 v[208:223], v[68:71], a[96:99], v[208:223]
    ds_read_b64_tr_b16 v[82:83], v26 offset:1024
    s_add_u32 s65, s65, 114688
    buffer_load_dwordx4 a[148:151], v1, s[28:31], s65 offen sc1
    v_mfma_f32_32x32x16_bf16 v[224:239], v[64:67], a[100:103], v[224:239]
    ds_read_b64_tr_b16 v[84:85], v29 offset:0
    buffer_load_dword v18, v17, s[28:31], s60 offen sc1
    v_mfma_f32_32x32x16_bf16 v[240:255], v[68:71], a[100:103], v[240:255]
    ds_read_b64_tr_b16 v[86:87], v29 offset:1024
    s_waitcnt vmcnt(27)
Lv_26:
    v_accvgpr_read_b32 v12, a107
    v_accvgpr_read_b32 v13, a111
    v_max_u32 v12, v12, v13
    v_cmp_eq_u32 vcc, -1, v12
    s_cbranch_vccz Lvd_27
    s_call_b64 s[98:99], Lrl2
    s_branch Lv_26
Lvd_27:
    s_waitcnt lgkmcnt(4)
    v_mfma_f32_32x32x16_bf16 v[192:207], v[72:75], a[104:107], v[192:207]
    ds_read_b64_tr_b16 v[88:89], v26 offset:8192
    s_bfe_u32 s88, s54, 0x40008
    s_lshl_b32 s88, s88, 13
    s_add_u32 s65, s88, s61
    s_add_u32 s65, s65, 4096
    buffer_load_dwordx4 a[152:155], v1, s[28:31], s65 offen sc1
    v_mfma_f32_32x32x16_bf16 v[208:223], v[76:79], a[104:107], v[208:223]
    ds_read_b64_tr_b16 v[90:91], v26 offset:9216
    s_add_u32 s65, s65, 114688
    buffer_load_dwordx4 a[156:159], v1, s[28:31], s65 offen sc1
    v_mfma_f32_32x32x16_bf16 v[224:239], v[72:75], a[108:111], v[224:239]
    ds_read_b64_tr_b16 v[92:93], v29 offset:8192
    s_bfe_u32 s88, s54, 0x4000c
    s_lshl_b32 s88, s88, 13
    s_add_u32 s65, s88, s61
    buffer_load_dwordx4 a[160:163], v1, s[28:31], s65 offen sc1
    v_mfma_f32_32x32x16_bf16 v[240:255], v[76:79], a[108:111], v[240:255]
    ds_read_b64_tr_b16 v[94:95], v29 offset:9216
    s_add_u32 s65, s65, 114688
    buffer_load_dwordx4 a[164:167], v1, s[28:31], s65 offen sc1
    s_waitcnt vmcnt(13)
Lv_28:
    v_accvgpr_read_b32 v12, a115
    v_accvgpr_read_b32 v13, a119
    v_max_u32 v12, v12, v13
    v_cmp_eq_u32 vcc, -1, v12
    s_cbranch_vccz Lvd_29
    s_call_b64 s[98:99], Lrl3
    s_branch Lv_28
Lvd_29:
    s_waitcnt lgkmcnt(4)
    v_mfma_f32_32x32x16_bf16 v[192:207], v[80:83], a[112:115], v[192:207]
    ds_read_b64_tr_b16 v[64:65], v25 offset:32768
    s_bfe_u32 s88, s54, 0x4000c
    s_lshl_b32 s88, s88, 13
    s_add_u32 s65, s88, s61
    s_add_u32 s65, s65, 4096
    buffer_load_dwordx4 a[168:171], v1, s[28:31], s65 offen sc1
    v_mfma_f32_32x32x16_bf16 v[208:223], v[84:87], a[112:115], v[208:223]
    ds_read_b64_tr_b16 v[66:67], v25 offset:33792
    v_mfma_f32_32x32x16_bf16 v[224:239], v[80:83], a[116:119], v[224:239]
    ds_read_b64_tr_b16 v[68:69], v28 offset:32768
    s_add_u32 s65, s65, 114688
    buffer_load_dwordx4 a[172:175], v1, s[28:31], s65 offen sc1
    v_mfma_f32_32x32x16_bf16 v[240:255], v[84:87], a[116:119], v[240:255]
    ds_read_b64_tr_b16 v[70:71], v28 offset:33792
    s_waitcnt vmcnt(13)
Lv_30:
    v_accvgpr_read_b32 v12, a123
    v_accvgpr_read_b32 v13, a127
    v_max_u32 v12, v12, v13
    v_cmp_eq_u32 vcc, -1, v12
    s_cbranch_vccz Lvd_31
    s_call_b64 s[98:99], Lrl3
    s_branch Lv_30
Lvd_31:
    s_waitcnt lgkmcnt(4)
    v_mfma_f32_32x32x16_bf16 v[192:207], v[88:91], a[120:123], v[192:207]
    ds_read_b64_tr_b16 v[72:73], v25 offset:40960
    s_bfe_u32 s88, s54, 0x40010
    s_lshl_b32 s88, s88, 13
    s_add_u32 s65, s88, s61
    buffer_load_dwordx4 a[176:179], v1, s[28:31], s65 offen sc1
    v_mfma_f32_32x32x16_bf16 v[208:223], v[92:95], a[120:123], v[208:223]
    ds_read_b64_tr_b16 v[74:75], v25 offset:41984
    s_add_u32 s65, s65, 114688
    buffer_load_dwordx4 a[180:183], v1, s[28:31], s65 offen sc1
    v_mfma_f32_32x32x16_bf16 v[224:239], v[88:91], a[124:127], v[224:239]
    ds_read_b64_tr_b16 v[76:77], v28 offset:40960
    s_bfe_u32 s88, s54, 0x40010
    s_lshl_b32 s88, s88, 13
    s_add_u32 s65, s88, s61
    s_add_u32 s65, s65, 4096
    buffer_load_dwordx4 a[184:187], v1, s[28:31], s65 offen sc1
    v_mfma_f32_32x32x16_bf16 v[240:255], v[92:95], a[124:127], v[240:255]
    ds_read_b64_tr_b16 v[78:79], v28 offset:41984
    s_add_u32 s65, s65, 114688
    buffer_load_dwordx4 a[188:191], v1, s[28:31], s65 offen sc1
    s_waitcnt vmcnt(15)
Lv_32:
    v_accvgpr_read_b32 v12, a131
    v_accvgpr_read_b32 v13, a135
    v_max_u32 v12, v12, v13
    v_cmp_eq_u32 vcc, -1, v12
    s_cbranch_vccz Lvd_33
    s_call_b64 s[98:99], Lrl3
    s_branch Lv_32
Lvd_33:
    s_waitcnt lgkmcnt(4)
    v_mfma_f32_32x32x16_bf16 v[192:207], v[64:67], a[128:131], v[192:207]
    ds_read_b64_tr_b16 v[80:81], v24 offset:0
    s_bfe_u32 s88, s54, 0x40014
    s_lshl_b32 s88, s88, 13
    s_add_u32 s65, s88, s61
    buffer_load_dwordx4 a[192:195], v1, s[28:31], s65 offen sc1
    v_mfma_f32_32x32x16_bf16 v[208:223], v[68:71], a[128:131], v[208:223]
    ds_read_b64_tr_b16 v[82:83], v24 offset:1024
    v_mfma_f32_32x32x16_bf16 v[224:239], v[64:67], a[132:135], v[224:239]
    ds_read_b64_tr_b16 v[84:85], v27 offset:0
    s_add_u32 s65, s65, 114688
    buffer_load_dwordx4 a[196:199], v1, s[28:31], s65 offen sc1
    v_mfma_f32_32x32x16_bf16 v[240:255], v[68:71], a[132:135], v[240:255]
    ds_read_b64_tr_b16 v[86:87], v27 offset:1024
    s_waitcnt vmcnt(15)
Lv_34:
    v_accvgpr_read_b32 v12, a139
    v_accvgpr_read_b32 v13, a143
    v_max_u32 v12, v12, v13
    v_cmp_eq_u32 vcc, -1, v12
    s_cbranch_vccz Lvd_35
    s_call_b64 s[98:99], Lrl3
    s_branch Lv_34
Lvd_35:
    s_waitcnt lgkmcnt(4)
    v_mfma_f32_32x32x16_bf16 v[192:207], v[72:75], a[136:139], v[192:207]
    ds_read_b64_tr_b16 v[88:89], v24 offset:8192
    s_mov_b32 s81, 13
    s_mul_i32 s81, s81, s82
    s_add_u32 m0, s73, 65536
    s_nop 0
    buffer_load_dwordx4 v4, s[32:35], s81 offen lds
    v_mfma_f32_32x32x16_bf16 v[208:223], v[76:79], a[136:139], v[208:223]
    ds_read_b64_tr_b16 v[90:91], v24 offset:9216
    buffer_load_dwordx4 v5, s[32:35], s81 offen offset:1024 lds
    v_mfma_f32_32x32x16_bf16 v[224:239], v[72:75], a[140:143], v[224:239]
    ds_read_b64_tr_b16 v[92:93], v27 offset:8192
    s_add_u32 m0, s73, 73728
    s_nop 0
    buffer_load_dwordx4 v4, s[36:39], s81 offen lds
    v_mfma_f32_32x32x16_bf16 v[240:255], v[76:79], a[140:143], v[240:255]
    ds_read_b64_tr_b16 v[94:95], v27 offset:9216
    buffer_load_dwordx4 v5, s[36:39], s81 offen offset:1024 lds
    s_waitcnt vmcnt(17)
Lv_36:
    v_accvgpr_read_b32 v12, a147
    v_accvgpr_read_b32 v13, a151
    v_max_u32 v12, v12, v13
    v_cmp_eq_u32 vcc, -1, v12
    s_cbranch_vccz Lvd_37
    s_call_b64 s[98:99], Lrl4
    s_branch Lv_36
Lvd_37:
    s_waitcnt lgkmcnt(4)
    v_mfma_f32_32x32x16_bf16 v[192:207], v[80:83], a[144:147], v[192:207]
    ds_read_b64_tr_b16 v[64:65], v24 offset:16384
    s_bfe_u32 s88, s54, 0x40014
    s_lshl_b32 s88, s88, 13
    s_add_u32 s65, s88, s61
    s_add_u32 s65, s65, 4096
    buffer_load_dwordx4 a[200:203], v1, s[28:31], s65 offen sc1
    v_mfma_f32_32x32x16_bf16 v[208:223], v[84:87], a[144:147], v[208:223]
    ds_read_b64_tr_b16 v[66:67], v24 offset:17408
    v_mfma_f32_32x32x16_bf16 v[224:239], v[80:83], a[148:151], v[224:239]
    ds_read_b64_tr_b16 v[68:69], v27 offset:16384
    s_add_u32 s65, s65, 114688
    buffer_load_dwordx4 a[204:207], v1, s[28:31], s65 offen sc1
    v_mfma_f32_32x32x16_bf16 v[240:255], v[84:87], a[148:151], v[240:255]
    ds_read_b64_tr_b16 v[70:71], v27 offset:17408
    s_waitcnt vmcnt(16)
Lv_38:
    v_accvgpr_read_b32 v12, a155
    v_accvgpr_read_b32 v13, a159
    v_max_u32 v12, v12, v13
    v_cmp_eq_u32 vcc, -1, v12
    s_cbranch_vccz Lvd_39
    s_call_b64 s[98:99], Lrl4
    s_branch Lv_38
Lvd_39:
    s_waitcnt lgkmcnt(4)
    v_mfma_f32_32x32x16_bf16 v[192:207], v[88:91], a[152:155], v[192:207]
    ds_read_b64_tr_b16 v[72:73], v24 offset:24576
    s_lshl_b32 s87, s86, 7
    s_add_u32 s32, s10, s87
    s_addc_u32 s33, s11, 0
    s_sub_u32 s34, 401408, s87
    s_add_u32 s36, s32, 14336
    s_addc_u32 s37, s33, 0
    s_sub_u32 s38, s34, 14336
    s_mov_b32 s82, 100352
    s_mul_i32 s87, s72, 10752
    v_add_u32 v4, s87, v4
    v_add_u32 v5, s87, v5
    s_bfe_u32 s81, s55, 0x40000
    s_mul_i32 s81, s81, s82
    s_add_u32 m0, s73, 114688
    s_nop 0
    buffer_load_dwordx4 v4, s[32:35], s81 offen lds
    v_mfma_f32_32x32x16_bf16 v[208:223], v[92:95], a[152:155], v[208:223]
    ds_read_b64_tr_b16 v[74:75], v24 offset:25600
    buffer_load_dwordx4 v5, s[32:35], s81 offen offset:1024 lds
    v_mfma_f32_32x32x16_bf16 v[224:239], v[88:91], a[156:159], v[224:239]
    ds_read_b64_tr_b16 v[76:77], v27 offset:24576
    s_add_u32 m0, s73, 122880
    s_nop 0
    buffer_load_dwordx4 v4, s[36:39], s81 offen lds
    v_mfma_f32_32x32x16_bf16 v[240:255], v[92:95], a[156:159], v[240:255]
    ds_read_b64_tr_b16 v[78:79], v27 offset:25600
    buffer_load_dwordx4 v5, s[36:39], s81 offen offset:1024 lds
    s_waitcnt vmcnt(18)
Lv_40:
    v_accvgpr_read_b32 v12, a163
    v_accvgpr_read_b32 v13, a167
    v_max_u32 v12, v12, v13
    v_cmp_eq_u32 vcc, -1, v12
    s_cbranch_vccz Lvd_41
    s_call_b64 s[98:99], Lrl4
    s_branch Lv_40
Lvd_41:
    s_waitcnt lgkmcnt(4)
    v_mfma_f32_32x32x16_bf16 v[192:207], v[64:67], a[160:163], v[192:207]
    ds_read_b64_tr_b16 v[80:81], v24 offset:32768
    s_bfe_u32 s81, s55, 0x40004
    s_mul_i32 s81, s81, s82
    s_add_u32 m0, s73, 81920
    s_nop 0
    buffer_load_dwordx4 v4, s[32:35], s81 offen lds
    v_mfma_f32_32x32x16_bf16 v[208:223], v[68:71], a[160:163], v[208:223]
    ds_read_b64_tr_b16 v[82:83], v24 offset:33792
    v_mfma_f32_32x32x16_bf16 v[224:239], v[64:67], a[164:167], v[224:239]
    ds_read_b64_tr_b16 v[84:85], v27 offset:32768
    buffer_load_dwordx4 v5, s[32:35], s81 offen offset:1024 lds
    v_mfma_f32_32x32x16_bf16 v[240:255], v[68:71], a[164:167], v[240:255]
    ds_read_b64_tr_b16 v[86:87], v27 offset:33792
    s_waitcnt vmcnt(18)
Lv_42:
    v_accvgpr_read_b32 v12, a171
    v_accvgpr_read_b32 v13, a175
    v_max_u32 v12, v12, v13
    v_cmp_eq_u32 vcc, -1, v12
    s_cbranch_vccz Lvd_43
    s_call_b64 s[98:99], Lrl4
    s_branch Lv_42
Lvd_43:
    s_waitcnt lgkmcnt(4)
    v_mfma_f32_32x32x16_bf16 v[192:207], v[72:75], a[168:171], v[192:207]
    ds_read_b64_tr_b16 v[88:89], v24 offset:40960
    s_add_u32 m0, s73, 90112
    s_nop 0
    buffer_load_dwordx4 v4, s[36:39], s81 offen lds
    v_mfma_f32_32x32x16_bf16 v[208:223], v[76:79], a[168:171], v[208:223]
    ds_read_b64_tr_b16 v[90:91], v24 offset:41984
    buffer_load_dwordx4 v5, s[36:39], s81 offen offset:1024 lds
    v_mfma_f32_32x32x16_bf16 v[224:239], v[72:75], a[172:175], v[224:239]
    ds_read_b64_tr_b16 v[92:93], v27 offset:40960
    s_bfe_u32 s81, s55, 0x40008
    s_mul_i32 s81, s81, s82
    s_add_u32 m0, s73, 131072
    s_nop 0
    buffer_load_dwordx4 v4, s[32:35], s81 offen lds
    v_mfma_f32_32x32x16_bf16 v[240:255], v[76:79], a[172:175], v[240:255]
    ds_read_b64_tr_b16 v[94:95], v27 offset:41984
    buffer_load_dwordx4 v5, s[32:35], s81 offen offset:1024 lds
    s_waitcnt vmcnt(20)
Lv_44:
    v_accvgpr_read_b32 v12, a179
    v_accvgpr_read_b32 v13, a183
    v_max_u32 v12, v12, v13
    v_cmp_eq_u32 vcc, -1, v12
    s_cbranch_vccz Lvd_45
    s_call_b64 s[98:99], Lrl5
    s_branch Lv_44
Lvd_45:
    s_waitcnt lgkmcnt(4)
    v_mfma_f32_32x32x16_bf16 v[192:207], v[80:83], a[176:179], v[192:207]
    ds_read_b64_tr_b16 v[64:65], v24 offset:49152
    s_mov_b32 s88, 13
    s_lshl_b32 s88, s88, 13
    s_add_u32 s65, s88, s61
    buffer_load_dwordx4 a[208:211], v1, s[28:31], s65 offen sc1
    v_mfma_f32_32x32x16_bf16 v[208:223], v[84:87], a[176:179], v[208:223]
    ds_read_b64_tr_b16 v[66:67], v24 offset:50176
    v_mfma_f32_32x32x16_bf16 v[224:239], v[80:83], a[180:183], v[224:239]
    ds_read_b64_tr_b16 v[68:69], v27 offset:49152
    s_add_u32 s65, s65, 114688
    buffer_load_dwordx4 a[212:215], v1, s[28:31], s65 offen sc1
    v_mfma_f32_32x32x16_bf16 v[240:255], v[84:87], a[180:183], v[240:255]
    ds_read_b64_tr_b16 v[70:71], v27 offset:50176
    s_waitcnt vmcnt(20)
Lv_46:
    v_accvgpr_read_b32 v12, a187
    v_accvgpr_read_b32 v13, a191
    v_max_u32 v12, v12, v13
    v_cmp_eq_u32 vcc, -1, v12
    s_cbranch_vccz Lvd_47
    s_call_b64 s[98:99], Lrl5
    s_branch Lv_46
Lvd_47:
    s_waitcnt lgkmcnt(4)
    v_mfma_f32_32x32x16_bf16 v[192:207], v[88:91], a[184:187], v[192:207]
    ds_read_b64_tr_b16 v[72:73], v24 offset:57344
    s_mov_b32 s88, 13
    s_lshl_b32 s88, s88, 13
    s_add_u32 s65, s88, s61
    s_add_u32 s65, s65, 4096
    buffer_load_dwordx4 a[216:219], v1, s[28:31], s65 offen sc1
    v_mfma_f32_32x32x16_bf16 v[208:223], v[92:95], a[184:187], v[208:223]
    ds_read_b64_tr_b16 v[74:75], v24 offset:58368
    s_add_u32 s65, s65, 114688
    buffer_load_dwordx4 a[220:223], v1, s[28:31], s65 offen sc1
    v_mfma_f32_32x32x16_bf16 v[224:239], v[88:91], a[188:191], v[224:239]
    ds_read_b64_tr_b16 v[76:77], v27 offset:57344
    s_add_u32 m0, s73, 139264
    s_nop 0
    buffer_load_dwordx4 v4, s[36:39], s81 offen lds
    v_mfma_f32_32x32x16_bf16 v[240:255], v[92:95], a[188:191], v[240:255]
    ds_read_b64_tr_b16 v[78:79], v27 offset:58368
    buffer_load_dwordx4 v5, s[36:39], s81 offen offset:1024 lds
    s_waitcnt vmcnt(18)
Lv_48:
    v_accvgpr_read_b32 v12, a195
    v_accvgpr_read_b32 v13, a199
    v_max_u32 v12, v12, v13
    v_cmp_eq_u32 vcc, -1, v12
    s_cbranch_vccz Lvd_49
    s_call_b64 s[98:99], Lrl5
    s_branch Lv_48
Lvd_49:
    s_waitcnt lgkmcnt(4)
    v_mfma_f32_32x32x16_bf16 v[192:207], v[64:67], a[192:195], v[192:207]
    ds_read_b64_tr_b16 v[80:81], v25 offset:0
    s_mov_b32 s92, 0x8000
Lck_50:
    v_cmp_eq_u32 vcc, s79, v18
    s_sub_u32 s92, s92, 1
    s_cbranch_scc1 Lcd_51
    s_andn2_b32 s87, 0x4000, vcc_lo
    s_cbranch_scc0 Lcd_51
    buffer_load_dword v18, v17, s[28:31], s60 offen sc1
    s_sleep 4
    s_branch Lck_50
Lcd_51:
    s_mov_b32 s92, 0x8000
    v_mfma_f32_32x32x16_bf16 v[208:223], v[68:71], a[192:195], v[208:223]
    ds_read_b64_tr_b16 v[82:83], v25 offset:1024
    s_bfe_u32 s88, s55, 0x40000
    s_lshl_b32 s88, s88, 13
    s_add_u32 s65, s88, s62
    buffer_load_dwordx4 v[128:131], v1, s[28:31], s65 offen sc1
    v_mfma_f32_32x32x16_bf16 v[224:239], v[64:67], a[196:199], v[224:239]
    ds_read_b64_tr_b16 v[84:85], v28 offset:0
    s_add_u32 s65, s65, 32768
    buffer_load_dwordx4 v[132:135], v1, s[28:31], s65 offen sc1
    buffer_load_dword v30, v23, s[28:31], 0 offen offset:0 sc1
    buffer_load_dword v31, v23, s[28:31], 0 offen offset:128 sc1
    v_mfma_f32_32x32x16_bf16 v[240:255], v[68:71], a[196:199], v[240:255]
    ds_read_b64_tr_b16 v[86:87], v28 offset:1024
    s_waitcnt vmcnt(20)
Lv_52:
    v_accvgpr_read_b32 v12, a203
    v_accvgpr_read_b32 v13, a207
    v_max_u32 v12, v12, v13
    v_cmp_eq_u32 vcc, -1, v12
    s_cbranch_vccz Lvd_53
    s_call_b64 s[98:99], Lrl5
    s_branch Lv_52
Lvd_53:
    s_waitcnt lgkmcnt(4)
    v_mfma_f32_32x32x16_bf16 v[192:207], v[72:75], a[200:203], v[192:207]
    ds_read_b64_tr_b16 v[88:89], v25 offset:8192
    s_bfe_u32 s88, s55, 0x40000
    s_lshl_b32 s88, s88, 13
    s_add_u32 s65, s88, s62
    buffer_load_dwordx4 v[136:139], v1, s[28:31], s65 offen offset:1024 sc1
    v_mfma_f32_32x32x16_bf16 v[208:223], v[76:79], a[200:203], v[208:223]
    ds_read_b64_tr_b16 v[90:91], v25 offset:9216
    s_add_u32 s65, s65, 32768
    buffer_load_dwordx4 v[140:143], v1, s[28:31], s65 offen offset:1024 sc1
    v_mfma_f32_32x32x16_bf16 v[224:239], v[72:75], a[204:207], v[224:239]
    ds_read_b64_tr_b16 v[92:93], v28 offset:8192
    s_bfe_u32 s81, s55, 0x4000c
    s_mul_i32 s81, s81, s82
    s_add_u32 m0, s73, 98304
    s_nop 0
    buffer_load_dwordx4 v4, s[32:35], s81 offen lds
    v_mfma_f32_32x32x16_bf16 v[240:255], v[76:79], a[204:207], v[240:255]
    ds_read_b64_tr_b16 v[94:95], v28 offset:9216
    buffer_load_dwordx4 v5, s[32:35], s81 offen offset:1024 lds
    s_waitcnt vmcnt(12)
Lv_54:
    v_accvgpr_read_b32 v12, a211
    v_accvgpr_read_b32 v13, a215
    v_max_u32 v12, v12, v13
    v_cmp_eq_u32 vcc, -1, v12
    s_cbranch_vccz Lvd_55
    s_call_b64 s[98:99], Lrl6
    s_branch Lv_54
Lvd_55:
    s_waitcnt lgkmcnt(4)
    v_mfma_f32_32x32x16_bf16 v[192:207], v[80:83], a[208:211], v[192:207]
    ds_read_b64_tr_b16 v[64:65], v25 offset:49152
    s_bfe_u32 s88, s55, 0x40004
    s_lshl_b32 s88, s88, 13
    s_add_u32 s65, s88, s62
    buffer_load_dwordx4 v[144:147], v1, s[28:31], s65 offen sc1
    v_mfma_f32_32x32x16_bf16 v[208:223], v[84:87], a[208:211], v[208:223]
    ds_read_b64_tr_b16 v[66:67], v25 offset:50176
    v_mfma_f32_32x32x16_bf16 v[224:239], v[80:83], a[212:215], v[224:239]
    ds_read_b64_tr_b16 v[68:69], v28 offset:49152
    s_add_u32 s65, s65, 32768
    buffer_load_dwordx4 v[148:151], v1, s[28:31], s65 offen sc1
    v_mfma_f32_32x32x16_bf16 v[240:255], v[84:87], a[212:215], v[240:255]
    ds_read_b64_tr_b16 v[70:71], v28 offset:50176
    s_waitcnt vmcnt(12)
Lv_56:
    v_accvgpr_read_b32 v12, a219
    v_accvgpr_read_b32 v13, a223
    v_max_u32 v12, v12, v13
    v_cmp_eq_u32 vcc, -1, v12
    s_cbranch_vccz Lvd_57
    s_call_b64 s[98:99], Lrl6
    s_branch Lv_56
Lvd_57:
    s_waitcnt lgkmcnt(4)
    v_mfma_f32_32x32x16_bf16 v[192:207], v[88:91], a[216:219], v[192:207]
    ds_read_b64_tr_b16 v[72:73], v25 offset:57344
    s_barrier
    s_bfe_u32 s88, s55, 0x40004
    s_lshl_b32 s88, s88, 13
    s_add_u32 s65, s88, s62
    buffer_load_dwordx4 v[152:155], v1, s[28:31], s65 offen offset:1024 sc1
    v_mfma_f32_32x32x16_bf16 v[208:223], v[92:95], a[216:219], v[208:223]
    ds_read_b64_tr_b16 v[74:75], v25 offset:58368
    s_add_u32 s65, s65, 32768
    buffer_load_dwordx4 v[156:159], v1, s[28:31], s65 offen offset:1024 sc1
    v_mfma_f32_32x32x16_bf16 v[224:239], v[88:91], a[220:223], v[224:239]
    ds_read_b64_tr_b16 v[76:77], v28 offset:57344
    s_add_u32 m0, s73, 106496
    s_nop 0
    buffer_load_dwordx4 v4, s[36:39], s81 offen lds
    v_mfma_f32_32x32x16_bf16 v[240:255], v[92:95], a[220:223], v[240:255]
    ds_read_b64_tr_b16 v[78:79], v28 offset:58368
    buffer_load_dwordx4 v5, s[36:39], s81 offen offset:1024 lds
    s_waitcnt vmcnt(12)
Lv_58:
    v_max_u32 v12, v131, v135
    v_cmp_eq_u32 vcc, -1, v12
    s_cbranch_vccz Lvd_59
    s_call_b64 s[98:99], Lrl7
    s_branch Lv_58
Lvd_59:
    s_waitcnt lgkmcnt(4)
    v_mfma_f32_32x32x16_bf16 v[192:207], v[64:67], v[128:131], v[192:207]
    ds_read_b64_tr_b16 v[80:81], v25 offset:16384
    s_bfe_u32 s88, s55, 0x40008
    s_lshl_b32 s88, s88, 13
    s_add_u32 s65, s88, s62
    buffer_load_dwordx4 v[160:163], v1, s[28:31], s65 offen sc1
    v_mfma_f32_32x32x16_bf16 v[208:223], v[68:71], v[128:131], v[208:223]
    ds_read_b64_tr_b16 v[82:83], v25 offset:17408
    v_mfma_f32_32x32x16_bf16 v[224:239], v[64:67], v[132:135], v[224:239]
    ds_read_b64_tr_b16 v[84:85], v28 offset:16384
    s_add_u32 s65, s65, 32768
    buffer_load_dwordx4 v[164:167], v1, s[28:31], s65 offen sc1
    v_mfma_f32_32x32x16_bf16 v[240:255], v[68:71], v[132:135], v[240:255]
    ds_read_b64_tr_b16 v[86:87], v28 offset:17408
    s_waitcnt vmcnt(10)
Lv_60:
    v_max_u32 v12, v139, v143
    v_cmp_eq_u32 vcc, -1, v12
    s_cbranch_vccz Lvd_61
    s_call_b64 s[98:99], Lrl7
    s_branch Lv_60
Lvd_61:
    s_waitcnt lgkmcnt(4)
    v_mfma_f32_32x32x16_bf16 v[192:207], v[72:75], v[136:139], v[192:207]
    ds_read_b64_tr_b16 v[88:89], v25 offset:24576
    s_bfe_u32 s88, s55, 0x40008
    s_lshl_b32 s88, s88, 13
    s_add_u32 s65, s88, s62
    buffer_load_dwordx4 v[168:171], v1, s[28:31], s65 offen offset:1024 sc1
    v_mfma_f32_32x32x16_bf16 v[208:223], v[76:79], v[136:139], v[208:223]
    ds_read_b64_tr_b16 v[90:91], v25 offset:25600
    v_mfma_f32_32x32x16_bf16 v[224:239], v[72:75], v[140:143], v[224:239]
    ds_read_b64_tr_b16 v[92:93], v28 offset:24576
    s_add_u32 s65, s65, 32768
    buffer_load_dwordx4 v[172:175], v1, s[28:31], s65 offen offset:1024 sc1
    v_mfma_f32_32x32x16_bf16 v[240:255], v[76:79], v[140:143], v[240:255]
    ds_read_b64_tr_b16 v[94:95], v28 offset:25600
    s_waitcnt vmcnt(8)
Lv_62:
    v_max_u32 v12, v147, v151
    v_cmp_eq_u32 vcc, -1, v12
    s_cbranch_vccz Lvd_63
    s_call_b64 s[98:99], Lrl7
    s_branch Lv_62
Lvd_63:
    s_waitcnt lgkmcnt(4)
    v_mfma_f32_32x32x16_bf16 v[192:207], v[80:83], v[144:147], v[192:207]
    ds_read_b64_tr_b16 v[64:65], v26 offset:0
    s_bfe_u32 s88, s55, 0x4000c
    s_lshl_b32 s88, s88, 13
    s_add_u32 s65, s88, s62
    buffer_load_dwordx4 v[176:179], v1, s[28:31], s65 offen sc1
    v_mfma_f32_32x32x16_bf16 v[208:223], v[84:87], v[144:147], v[208:223]
    ds_read_b64_tr_b16 v[66:67], v26 offset:1024
    v_mfma_f32_32x32x16_bf16 v[224:239], v[80:83], v[148:151], v[224:239]
    ds_read_b64_tr_b16 v[68:69], v29 offset:0
    s_add_u32 s65, s65, 32768
    buffer_load_dwordx4 v[180:183], v1, s[28:31], s65 offen sc1
    v_mfma_f32_32x32x16_bf16 v[240:255], v[84:87], v[148:151], v[240:255]
    ds_read_b64_tr_b16 v[70:71], v29 offset:1024
    s_waitcnt vmcnt(8)
Lv_64:
    v_max_u32 v12, v155, v159
    v_cmp_eq_u32 vcc, -1, v12
    s_cbranch_vccz Lvd_65
    s_call_b64 s[98:99], Lrl7
    s_branch Lv_64
Lvd_65:
    s_waitcnt lgkmcnt(4)
    v_mfma_f32_32x32x16_bf16 v[192:207], v[88:91], v[152:155], v[192:207]
    ds_read_b64_tr_b16 v[72:73], v26 offset:8192
    s_bfe_u32 s88, s55, 0x4000c
    s_lshl_b32 s88, s88, 13
    s_add_u32 s65, s88, s62
    buffer_load_dwordx4 v[184:187], v1, s[28:31], s65 offen offset:1024 sc1
    v_mfma_f32_32x32x16_bf16 v[208:223], v[92:95], v[152:155], v[208:223]
    ds_read_b64_tr_b16 v[74:75], v26 offset:9216
    v_mfma_f32_32x32x16_bf16 v[224:239], v[88:91], v[156:159], v[224:239]
    ds_read_b64_tr_b16 v[76:77], v29 offset:8192
    s_add_u32 s65, s65, 32768
    buffer_load_dwordx4 v[188:191], v1, s[28:31], s65 offen offset:1024 sc1
    v_mfma_f32_32x32x16_bf16 v[240:255], v[92:95], v[156:159], v[240:255]
    ds_read_b64_tr_b16 v[78:79], v29 offset:9216
    s_waitcnt vmcnt(6)
Lv_66:
    v_max_u32 v12, v163, v167
    v_cmp_eq_u32 vcc, -1, v12
    s_cbranch_vccz Lvd_67
    s_call_b64 s[98:99], Lrl8
    s_branch Lv_66
Lvd_67:
    s_waitcnt lgkmcnt(4)
    v_mfma_f32_32x32x16_bf16 v[192:207], v[64:67], v[160:163], v[192:207]
    ds_read_b64_tr_b16 v[80:81], v25 offset:32768
    v_mfma_f32_32x32x16_bf16 v[208:223], v[68:71], v[160:163], v[208:223]
    ds_read_b64_tr_b16 v[82:83], v25 offset:33792
    v_mfma_f32_32x32x16_bf16 v[224:239], v[64:67], v[164:167], v[224:239]
    ds_read_b64_tr_b16 v[84:85], v28 offset:32768
    v_mfma_f32_32x32x16_bf16 v[240:255], v[68:71], v[164:167], v[240:255]
    ds_read_b64_tr_b16 v[86:87], v28 offset:33792
    s_waitcnt vmcnt(4)
Lv_68:
    v_max_u32 v12, v171, v175
    v_cmp_eq_u32 vcc, -1, v12
    s_cbranch_vccz Lvd_69
    s_call_b64 s[98:99], Lrl8
    s_branch Lv_68
Lvd_69:
    s_waitcnt lgkmcnt(4)
    v_mfma_f32_32x32x16_bf16 v[192:207], v[72:75], v[168:171], v[192:207]
    ds_read_b64_tr_b16 v[88:89], v25 offset:40960
    v_mfma_f32_32x32x16_bf16 v[208:223], v[76:79], v[168:171], v[208:223]
    ds_read_b64_tr_b16 v[90:91], v25 offset:41984
    v_mfma_f32_32x32x16_bf16 v[224:239], v[72:75], v[172:175], v[224:239]
    ds_read_b64_tr_b16 v[92:93], v28 offset:40960
    v_mfma_f32_32x32x16_bf16 v[240:255], v[76:79], v[172:175], v[240:255]
    ds_read_b64_tr_b16 v[94:95], v28 offset:41984
    s_waitcnt vmcnt(2)
Lv_70:
    v_max_u32 v12, v179, v183
    v_cmp_eq_u32 vcc, -1, v12
    s_cbranch_vccz Lvd_71
    s_call_b64 s[98:99], Lrl8
    s_branch Lv_70
Lvd_71:
    s_waitcnt lgkmcnt(4)
    v_mfma_f32_32x32x16_bf16 v[192:207], v[80:83], v[176:179], v[192:207]
    v_mfma_f32_32x32x16_bf16 v[208:223], v[84:87], v[176:179], v[208:223]
    v_mfma_f32_32x32x16_bf16 v[224:239], v[80:83], v[180:183], v[224:239]
    v_mfma_f32_32x32x16_bf16 v[240:255], v[84:87], v[180:183], v[240:255]
    s_waitcnt vmcnt(0)
Lv_72:
    v_max_u32 v12, v187, v191
    v_cmp_eq_u32 vcc, -1, v12
    s_cbranch_vccz Lvd_73
    s_call_b64 s[98:99], Lrl8
    s_branch Lv_72
Lvd_73:
    s_waitcnt lgkmcnt(0)
    v_mfma_f32_32x32x16_bf16 v[192:207], v[88:91], v[184:187], v[192:207]
    v_mfma_f32_32x32x16_bf16 v[208:223], v[92:95], v[184:187], v[208:223]
    v_mfma_f32_32x32x16_bf16 v[224:239], v[88:91], v[188:191], v[224:239]
    v_mfma_f32_32x32x16_bf16 v[240:255], v[92:95], v[188:191], v[240:255]
    s_cmp_lg_u32 s72, 0
    s_cbranch_scc1 Lrs_74
    s_nop 10
    ds_write_b128 v1, v[200:203] offset:12288
    ds_write_b128 v1, v[204:207] offset:13312
    ds_write_b128 v1, v[208:211] offset:24576
    ds_write_b128 v1, v[212:215] offset:25600
    ds_write_b128 v1, v[216:219] offset:36864
    ds_write_b128 v1, v[220:223] offset:37888
    ds_write_b128 v1, v[232:235] offset:14336
    ds_write_b128 v1, v[236:239] offset:15360
    ds_write_b128 v1, v[240:243] offset:26624
    ds_write_b128 v1, v[244:247] offset:27648
    ds_write_b128 v1, v[248:251] offset:38912
    ds_write_b128 v1, v[252:255] offset:39936
    v_mov_b32 v112, v192
    v_mov_b32 v113, v193
    v_mov_b32 v114, v194
    v_mov_b32 v115, v195
    v_mov_b32 v116, v196
    v_mov_b32 v117, v197
    v_mov_b32 v118, v198
    v_mov_b32 v119, v199
    v_mov_b32 v120, v224
    v_mov_b32 v121, v225
    v_mov_b32 v122, v226
    v_mov_b32 v123, v227
    v_mov_b32 v124, v228
    v_mov_b32 v125, v229
    v_mov_b32 v126, v230
    v_mov_b32 v127, v231
    s_branch Lrs_done
Lrs_74:
    s_cmp_lg_u32 s72, 1
    s_cbranch_scc1 Lrs_75
    s_nop 10
    ds_write_b128 v1, v[192:195] offset:0
    ds_write_b128 v1, v[196:199] offset:1024
    ds_write_b128 v1, v[208:211] offset:28672
    ds_write_b128 v1, v[212:215] offset:29696
    ds_write_b128 v1, v[216:219] offset:40960
    ds_write_b128 v1, v[220:223] offset:41984
    ds_write_b128 v1, v[224:227] offset:2048
    ds_write_b128 v1, v[228:231] offset:3072
    ds_write_b128 v1, v[240:243] offset:30720
    ds_write_b128 v1, v[244:247] offset:31744
    ds_write_b128 v1, v[248:251] offset:43008
    ds_write_b128 v1, v[252:255] offset:44032
    v_mov_b32 v112, v200
    v_mov_b32 v113, v201
    v_mov_b32 v114, v202
    v_mov_b32 v115, v203
    v_mov_b32 v116, v204
    v_mov_b32 v117, v205
    v_mov_b32 v118, v206
    v_mov_b32 v119, v207
    v_mov_b32 v120, v232
    v_mov_b32 v121, v233
    v_mov_b32 v122, v234
    v_mov_b32 v123, v235
    v_mov_b32 v124, v236
    v_mov_b32 v125, v237
    v_mov_b32 v126, v238
    v_mov_b32 v127, v239
    s_branch Lrs_done
Lrs_75:
    s_cmp_lg_u32 s72, 2
    s_cbranch_scc1 Lrs_76
    s_nop 10
    ds_write_b128 v1, v[192:195] offset:4096
    ds_write_b128 v1, v[196:199] offset:5120
    ds_write_b128 v1, v[200:203] offset:16384
    ds_write_b128 v1, v[204:207] offset:17408
    ds_write_b128 v1, v[216:219] offset:45056
    ds_write_b128 v1, v[220:223] offset:46080
    ds_write_b128 v1, v[224:227] offset:6144
    ds_write_b128 v1, v[228:231] offset:7168
    ds_write_b128 v1, v[232:235] offset:18432
    ds_write_b128 v1, v[236:239] offset:19456
    ds_write_b128 v1, v[248:251] offset:47104
    ds_write_b128 v1, v[252:255] offset:48128
    v_mov_b32 v112, v208
    v_mov_b32 v113, v209
    v_mov_b32 v114, v210
    v_mov_b32 v115, v211
    v_mov_b32 v116, v212
    v_mov_b32 v117, v213
    v_mov_b32 v118, v214
    v_mov_b32 v119, v215
    v_mov_b32 v120, v240
    v_mov_b32 v121, v241
    v_mov_b32 v122, v242
    v_mov_b32 v123, v243
    v_mov_b32 v124, v244
    v_mov_b32 v125, v245
    v_mov_b32 v126, v246
    v_mov_b32 v127, v247
    s_branch Lrs_done
Lrs_76:
    s_nop 10
    ds_write_b128 v1, v[192:195] offset:8192
    ds_write_b128 v1, v[196:199] offset:9216
    ds_write_b128 v1, v[200:203] offset:20480
    ds_write_b128 v1, v[204:207] offset:21504
    ds_write_b128 v1, v[208:211] offset:32768
    ds_write_b128 v1, v[212:215] offset:33792
    ds_write_b128 v1, v[224:227] offset:10240
    ds_write_b128 v1, v[228:231] offset:11264
    ds_write_b128 v1, v[232:235] offset:22528
    ds_write_b128 v1, v[236:239] offset:23552
    ds_write_b128 v1, v[240:243] offset:34816
    ds_write_b128 v1, v[244:247] offset:35840
    v_mov_b32 v112, v216
    v_mov_b32 v113, v217
    v_mov_b32 v114, v218
    v_mov_b32 v115, v219
    v_mov_b32 v116, v220
    v_mov_b32 v117, v221
    v_mov_b32 v118, v222
    v_mov_b32 v119, v223
    v_mov_b32 v120, v248
    v_mov_b32 v121, v249
    v_mov_b32 v122, v250
    v_mov_b32 v123, v251
    v_mov_b32 v124, v252
    v_mov_b32 v125, v253
    v_mov_b32 v126, v254
    v_mov_b32 v127, v255
Lrs_done:
    s_waitcnt lgkmcnt(0)
    s_barrier
    ds_read_b128 v[128:131], v33 offset:0
    ds_read_b128 v[132:135], v33 offset:1024
    ds_read_b128 v[136:139], v33 offset:2048
    ds_read_b128 v[140:143], v33 offset:3072
    ds_read_b128 v[144:147], v33 offset:4096
    ds_read_b128 v[148:151], v33 offset:5120
    ds_read_b128 v[152:155], v33 offset:6144
    ds_read_b128 v[156:159], v33 offset:7168
    ds_read_b128 v[160:163], v33 offset:8192
    ds_read_b128 v[164:167], v33 offset:9216
    ds_read_b128 v[168:171], v33 offset:10240
    ds_read_b128 v[172:175], v33 offset:11264
    s_waitcnt lgkmcnt(8)
    v_pk_add_f32 v[112:113], v[112:113], v[128:129]
    v_pk_add_f32 v[114:115], v[114:115], v[130:131]
    v_pk_add_f32 v[116:117], v[116:117], v[132:133]
    v_pk_add_f32 v[118:119], v[118:119], v[134:135]
    v_pk_add_f32 v[120:121], v[120:121], v[136:137]
    v_pk_add_f32 v[122:123], v[122:123], v[138:139]
    v_pk_add_f32 v[124:125], v[124:125], v[140:141]
    v_pk_add_f32 v[126:127], v[126:127], v[142:143]
    s_waitcnt lgkmcnt(4)
    v_pk_add_f32 v[112:113], v[112:113], v[144:145]
    v_pk_add_f32 v[114:115], v[114:115], v[146:147]
    v_pk_add_f32 v[116:117], v[116:117], v[148:149]
    v_pk_add_f32 v[118:119], v[118:119], v[150:151]
    v_pk_add_f32 v[120:121], v[120:121], v[152:153]
    v_pk_add_f32 v[122:123], v[122:123], v[154:155]
    v_pk_add_f32 v[124:125], v[124:125], v[156:157]
    v_pk_add_f32 v[126:127], v[126:127], v[158:159]
    s_waitcnt lgkmcnt(0)
    v_pk_add_f32 v[112:113], v[112:113], v[160:161]
    v_pk_add_f32 v[114:115], v[114:115], v[162:163]
    v_pk_add_f32 v[116:117], v[116:117], v[164:165]
    v_pk_add_f32 v[118:119], v[118:119], v[166:167]
    v_pk_add_f32 v[120:121], v[120:121], v[168:169]
    v_pk_add_f32 v[122:123], v[122:123], v[170:171]
    v_pk_add_f32 v[124:125], v[124:125], v[172:173]
    v_pk_add_f32 v[126:127], v[126:127], v[174:175]
    v_mul_f32 v112, v112, v30
    v_mul_f32 v113, v113, v30
    v_mul_f32 v114, v114, v30
    v_mul_f32 v115, v115, v30
    v_mul_f32 v116, v116, v30
    v_mul_f32 v117, v117, v30
    v_mul_f32 v118, v118, v30
    v_mul_f32 v119, v119, v30
    v_cvt_pk_bf16_f32 v64, v112, v113
    v_cvt_pk_bf16_f32 v65, v114, v115
    v_cvt_pk_bf16_f32 v66, v116, v117
    v_cvt_pk_bf16_f32 v67, v118, v119
    s_nop 0
    v_permlane32_swap_b32 v64, v66
    v_permlane32_swap_b32 v65, v67
    s_mov_b32 s87, 0
    buffer_store_dwordx4 v[64:67], v34, s[44:47], s87 offen
    v_mul_f32 v120, v120, v31
    v_mul_f32 v121, v121, v31
    v_mul_f32 v122, v122, v31
    v_mul_f32 v123, v123, v31
    v_mul_f32 v124, v124, v31
    v_mul_f32 v125, v125, v31
    v_mul_f32 v126, v126, v31
    v_mul_f32 v127, v127, v31
    v_cvt_pk_bf16_f32 v68, v120, v121
    v_cvt_pk_bf16_f32 v69, v122, v123
    v_cvt_pk_bf16_f32 v70, v124, v125
    v_cvt_pk_bf16_f32 v71, v126, v127
    s_nop 0
    v_permlane32_swap_b32 v68, v70
    v_permlane32_swap_b32 v69, v71
    s_mov_b32 s87, 28672
    buffer_store_dwordx4 v[68:71], v34, s[44:47], s87 offen
Lend:
    s_endpgm
Lother:
    s_nop 7
    s_mov_b32 s50, s91
    s_mov_b32 s51, s91
    s_waitcnt lgkmcnt(0)
    s_cmp_eq_u32 s77, 3
    s_cbranch_scc1 Lq
    s_cmp_eq_u32 s77, 6
    s_cbranch_scc1 Lr1
    v_mov_b32 v8, v35
    v_add_u32 v9, 0x10000, v35
    ds_read_b64_tr_b16 v[64:65], v8 offset:0
    ds_read_b64_tr_b16 v[66:67], v8 offset:512
    ds_read_b64_tr_b16 v[68:69], v8 offset:8192
    ds_read_b64_tr_b16 v[70:71], v8 offset:8704
    ds_read_b64_tr_b16 v[72:73], v8 offset:2048
    ds_read_b64_tr_b16 v[74:75], v8 offset:2560
    ds_read_b64_tr_b16 v[76:77], v8 offset:10240
    ds_read_b64_tr_b16 v[78:79], v8 offset:10752
    s_waitcnt lgkmcnt(4)
    v_mfma_f32_32x32x16_bf16 v[192:207], v[64:67], a[0:3], 0
    ds_read_b64_tr_b16 v[80:81], v8 offset:4096
    s_add_u32 m0, s73, 98304
    s_nop 0
    buffer_load_dwordx4 v4, s[32:35], s81 offen lds
    v_cvt_pk_bf16_f32 v144, v144, v145
    v_cvt_pk_bf16_f32 v145, v146, v147
    v_cvt_pk_bf16_f32 v146, v148, v149
    v_cvt_pk_bf16_f32 v147, v150, v151
    v_cvt_pk_bf16_f32 v148, v152, v153
    v_cvt_pk_bf16_f32 v149, v154, v155
    v_cvt_pk_bf16_f32 v150, v156, v157
    v_mfma_f32_32x32x16_bf16 v[208:223], v[68:71], a[0:3], 0
    ds_read_b64_tr_b16 v[82:83], v8 offset:4608
    buffer_load_dwordx4 v5, s[32:35], s81 offen offset:1024 lds
    v_cvt_pk_bf16_f32 v151, v158, v159
    v_mov_b32 v14, 0x3f80
    v_cndmask_b32 v150, v150, v14, s[96:97]
    v_cndmask_b32 v151, v151, 0, s[96:97]
    ds_write_b64 v48, v[144:145] offset:0
    ds_write_b64 v49, v[146:147] offset:0
    v_mfma_f32_32x32x16_bf16 v[224:239], v[64:67], a[112:115], 0
    ds_read_b64_tr_b16 v[84:85], v8 offset:12288
    s_bfe_u32 s87, s78, 0x80008
    s_lshl_b32 s87, s87, 12
    s_add_u32 s48, s87, s58
    buffer_store_dwordx4 v[36:39], v1, s[28:31], s48 offen offset:0 sc1
    ds_write_b64 v50, v[148:149] offset:0
    ds_write_b64 v51, v[150:151] offset:0
    v_cvt_pk_bf16_f32 v176, v176, v177
    v_cvt_pk_bf16_f32 v177, v178, v179
    v_cvt_pk_bf16_f32 v178, v180, v181
    v_cvt_pk_bf16_f32 v179, v182, v183
    v_mfma_f32_32x32x16_bf16 v[240:255], v[68:71], a[112:115], 0
    ds_read_b64_tr_b16 v[86:87], v8 offset:12800
    s_add_u32 m0, s73, 106496
    s_nop 0
    buffer_load_dwordx4 v4, s[36:39], s81 offen lds
    v_cvt_pk_bf16_f32 v180, v184, v185
    v_cvt_pk_bf16_f32 v181, v186, v187
    v_cvt_pk_bf16_f32 v182, v188, v189
    v_cvt_pk_bf16_f32 v183, v190, v191
    v_mov_b32 v14, 0x3f80
    v_cndmask_b32 v182, v182, v14, s[96:97]
    s_waitcnt lgkmcnt(4)
    v_mfma_f32_32x32x16_bf16 v[192:207], v[72:75], a[4:7], v[192:207]
    ds_read_b64_tr_b16 v[88:89], v8 offset:6144
    buffer_load_dwordx4 v5, s[36:39], s81 offen offset:1024 lds
    s_add_u32 s81, s81, s82
    s_cmp_eq_u32 s81, s83
    s_cselect_b32 s81, 0, s81
    v_cndmask_b32 v183, v183, 0, s[96:97]
    ds_write_b64 v48, v[176:177] offset:2048
    ds_write_b64 v49, v[178:179] offset:2048
    ds_write_b64 v50, v[180:181] offset:2048
    ds_write_b64 v51, v[182:183] offset:2048
    v_cvt_pk_bf16_f32 v104, v128, v129
    v_mfma_f32_32x32x16_bf16 v[208:223], v[76:79], a[4:7], v[208:223]
    ds_read_b64_tr_b16 v[90:91], v8 offset:6656
    v_cvt_pk_bf16_f32 v105, v130, v131
    v_cvt_pk_bf16_f32 v106, v132, v133
    v_cvt_pk_bf16_f32 v107, v134, v135
    v_cvt_pk_bf16_f32 v108, v136, v137
    v_cvt_pk_bf16_f32 v109, v138, v139
    v_cvt_pk_bf16_f32 v110, v140, v141
    v_mfma_f32_32x32x16_bf16 v[224:239], v[72:75], a[116:119], v[224:239]
    ds_read_b64_tr_b16 v[92:93], v8 offset:14336
    s_bfe_u32 s87, s78, 0x80010
    s_lshl_b32 s87, s87, 7
    s_add_u32 s32, s14, s87
    s_addc_u32 s33, s15, 0
    s_add_u32 s36, s16, s87
    s_addc_u32 s37, s17, 0
    s_sub_u32 s34, 1605632, s87
    s_mov_b32 s38, s34
    v_cvt_pk_bf16_f32 v111, v142, v143
    v_cndmask_b32 v110, v110, 0, s[96:97]
    v_cndmask_b32 v111, v111, 0, s[96:97]
    v_mfma_f32_32x32x16_bf16 v[128:143], v[112:115], v[104:107], 0
    s_nop 0
    v_mfma_f32_32x32x16_bf16 v[128:143], v[116:119], v[108:111], v[128:143]
    v_cvt_pk_bf16_f32 v96, v160, v161
    v_mfma_f32_32x32x16_bf16 v[240:255], v[76:79], a[116:119], v[240:255]
    ds_read_b64_tr_b16 v[94:95], v8 offset:14848
    v_cvt_pk_bf16_f32 v97, v162, v163
    v_cvt_pk_bf16_f32 v98, v164, v165
    v_cvt_pk_bf16_f32 v99, v166, v167
    v_cvt_pk_bf16_f32 v100, v168, v169
    v_cvt_pk_bf16_f32 v101, v170, v171
    v_cvt_pk_bf16_f32 v102, v172, v173
    s_waitcnt lgkmcnt(4)
    v_mfma_f32_32x32x16_bf16 v[192:207], v[80:83], a[8:11], v[192:207]
    s_waitcnt lgkmcnt(0)
    s_waitcnt vmcnt(21)
    s_barrier
    ds_read_b64_tr_b16 v[64:65], v8 offset:16384
    buffer_store_dwordx4 v[36:39], v1, s[28:31], s48 offen offset:1024 sc1
    v_cvt_pk_bf16_f32 v103, v174, v175
    v_cndmask_b32 v102, v102, 0, s[96:97]
    v_cndmask_b32 v103, v103, 0, s[96:97]
    v_mfma_f32_32x32x16_bf16 v[160:175], v[112:115], v[96:99], 0
    s_nop 0
    v_mfma_f32_32x32x16_bf16 v[160:175], v[116:119], v[100:103], v[160:175]
    v_mov_b32 v12, 0x7f800000
    v_mov_b32 v13, 0xff800000
    v_mfma_f32_32x32x16_bf16 v[208:223], v[84:87], a[8:11], v[208:223]
    ds_read_b64_tr_b16 v[66:67], v8 offset:16896
    s_add_u32 m0, s73, 0
    s_nop 0
    buffer_load_dwordx4 v4, s[32:35], s81 offen lds
    v_max3_f32 v96, v128, v129, v130
    v_min3_f32 v98, v128, v129, v130
    v_cndmask_b32 v140, v140, v128, s[96:97]
    v_cndmask_b32 v141, v141, v128, s[96:97]
    v_cndmask_b32 v142, v142, v128, s[96:97]
    v_cndmask_b32 v143, v143, v128, s[96:97]
    v_mfma_f32_32x32x16_bf16 v[224:239], v[80:83], a[120:123], v[224:239]
    ds_read_b64_tr_b16 v[68:69], v8 offset:24576
    v_max3_f32 v96, v96, v131, v132
    v_min3_f32 v98, v98, v131, v132
    v_max3_f32 v96, v96, v133, v134
    v_min3_f32 v98, v98, v133, v134
    v_max3_f32 v96, v96, v135, v136
    v_min3_f32 v98, v98, v135, v136
    v_mfma_f32_32x32x16_bf16 v[240:255], v[84:87], a[120:123], v[240:255]
    ds_read_b64_tr_b16 v[70:71], v8 offset:25088
    v_max3_f32 v96, v96, v137, v138
    v_min3_f32 v98, v98, v137, v138
    v_max3_f32 v96, v96, v139, v140
    v_min3_f32 v98, v98, v139, v140
    v_max3_f32 v96, v96, v141, v142
    v_min3_f32 v98, v98, v141, v142
    v_mfma_f32_32x32x16_bf16 v[192:207], v[88:91], a[12:15], v[192:207]
    ds_read_b64_tr_b16 v[72:73], v8 offset:18432
    buffer_load_dwordx4 v5, s[32:35], s81 offen offset:1024 lds
    v_max_f32 v96, v96, v143
    v_min_f32 v98, v98, v143
    v_mov_b32 v97, v96
    v_mov_b32 v99, v98
    s_nop 0
    v_permlane32_swap_b32 v96, v97
    v_permlane32_swap_b32 v98, v99
    v_mfma_f32_32x32x16_bf16 v[208:223], v[92:95], a[12:15], v[208:223]
    ds_read_b64_tr_b16 v[74:75], v8 offset:18944
    v_max_f32 v96, v96, v97
    v_min_f32 v98, v98, v99
    v_mul_f32 v96, s91, v96
    v_mul_f32 v98, s91, v98
    v_cndmask_b32 v100, v96, v12, s[96:97]
    v_cndmask_b32 v102, v98, v13, s[96:97]
    v_mfma_f32_32x32x16_bf16 v[224:239], v[88:91], a[124:127], v[224:239]
    ds_read_b64_tr_b16 v[76:77], v8 offset:26624
    s_add_u32 s48, s48, 114688
    buffer_store_dwordx4 v[36:39], v1, s[28:31], s48 offen offset:0 sc1
    v_fma_f32 v112, -v128, s91, v98
    v_fma_f32 v128, v128, s91, -v96
    v_fma_f32 v113, -v129, s91, v98
    v_fma_f32 v129, v129, s91, -v96
    v_exp_f32 v112, v112
    v_fma_f32 v114, -v130, s91, v98
    v_mfma_f32_32x32x16_bf16 v[240:255], v[92:95], a[124:127], v[240:255]
    ds_read_b64_tr_b16 v[78:79], v8 offset:27136
    v_exp_f32 v128, v128
    v_fma_f32 v130, v130, s91, -v96
    v_exp_f32 v113, v113
    v_fma_f32 v115, -v131, s91, v98
    v_exp_f32 v129, v129
    v_fma_f32 v131, v131, s91, -v96
    s_waitcnt lgkmcnt(4)
    v_mfma_f32_32x32x16_bf16 v[192:207], v[64:67], a[16:19], v[192:207]
    ds_read_b64_tr_b16 v[80:81], v8 offset:20480
    s_add_u32 m0, s73, 8192
    s_nop 0
    buffer_load_dwordx4 v4, s[36:39], s81 offen lds
    v_exp_f32 v114, v114
    v_fma_f32 v116, -v132, s91, v98
    v_exp_f32 v130, v130
    v_fma_f32 v132, v132, s91, -v96
    v_exp_f32 v115, v115
    v_fma_f32 v117, -v133, s91, v98
    v_mfma_f32_32x32x16_bf16 v[208:223], v[68:71], a[16:19], v[208:223]
    ds_read_b64_tr_b16 v[82:83], v8 offset:20992
    v_exp_f32 v131, v131
    v_fma_f32 v133, v133, s91, -v96
    v_exp_f32 v116, v116
    v_add_f32 v14, v112, v114
    v_fma_f32 v118, -v134, s91, v98
    v_exp_f32 v132, v132
    v_add_f32 v12, v128, v130
    v_mfma_f32_32x32x16_bf16 v[224:239], v[64:67], a[128:131], v[224:239]
    ds_read_b64_tr_b16 v[84:85], v8 offset:28672
    v_fma_f32 v134, v134, s91, -v96
    v_exp_f32 v117, v117
    v_add_f32 v15, v113, v115
    v_fma_f32 v119, -v135, s91, v98
    v_exp_f32 v133, v133
    v_add_f32 v13, v129, v131
    v_mfma_f32_32x32x16_bf16 v[240:255], v[68:71], a[128:131], v[240:255]
    ds_read_b64_tr_b16 v[86:87], v8 offset:29184
    v_fma_f32 v135, v135, s91, -v96
    v_exp_f32 v118, v118
    v_add_f32 v14, v14, v116
    v_fma_f32 v120, -v136, s91, v98
    v_exp_f32 v134, v134
    v_add_f32 v12, v12, v132
    s_waitcnt lgkmcnt(4)
    v_mfma_f32_32x32x16_bf16 v[192:207], v[72:75], a[20:23], v[192:207]
    ds_read_b64_tr_b16 v[88:89], v8 offset:22528
    buffer_load_dwordx4 v5, s[36:39], s81 offen offset:1024 lds
    s_add_u32 s81, s81, s82
    s_cmp_eq_u32 s81, s83
    s_cselect_b32 s81, 0, s81
    buffer_store_dwordx4 v[36:39], v1, s[28:31], s48 offen offset:1024 sc1
    v_fma_f32 v136, v136, s91, -v96
    v_exp_f32 v119, v119
    v_add_f32 v15, v15, v117
    v_fma_f32 v121, -v137, s91, v98
    v_exp_f32 v135, v135
    v_add_f32 v13, v13, v133
    v_mfma_f32_32x32x16_bf16 v[208:223], v[76:79], a[20:23], v[208:223]
    ds_read_b64_tr_b16 v[90:91], v8 offset:23040
    v_fma_f32 v137, v137, s91, -v96
    v_exp_f32 v120, v120
    v_add_f32 v14, v14, v118
    v_fma_f32 v122, -v138, s91, v98
    v_exp_f32 v136, v136
    v_add_f32 v12, v12, v134
    v_mfma_f32_32x32x16_bf16 v[224:239], v[72:75], a[132:135], v[224:239]
    ds_read_b64_tr_b16 v[92:93], v8 offset:30720
    v_fma_f32 v138, v138, s91, -v96
    v_exp_f32 v121, v121
    v_add_f32 v15, v15, v119
    v_fma_f32 v123, -v139, s91, v98
    v_exp_f32 v137, v137
    v_add_f32 v13, v13, v135
    v_mfma_f32_32x32x16_bf16 v[240:255], v[76:79], a[132:135], v[240:255]
    ds_read_b64_tr_b16 v[94:95], v8 offset:31232
    v_fma_f32 v139, v139, s91, -v96
    v_exp_f32 v122, v122
    v_add_f32 v14, v14, v120
    v_fma_f32 v124, -v140, s91, v102
    v_exp_f32 v138, v138
    v_add_f32 v12, v12, v136
    s_waitcnt lgkmcnt(4)
    v_mfma_f32_32x32x16_bf16 v[192:207], v[80:83], a[24:27], v[192:207]
    s_waitcnt lgkmcnt(0)
    s_waitcnt vmcnt(24)
    s_barrier
    ds_read_b64_tr_b16 v[64:65], v8 offset:32768
    v_fma_f32 v140, v140, s91, -v100
    v_exp_f32 v123, v123
    v_add_f32 v15, v15, v121
    v_fma_f32 v125, -v141, s91, v102
    v_exp_f32 v139, v139
    v_add_f32 v13, v13, v137
    v_mfma_f32_32x32x16_bf16 v[208:223], v[84:87], a[24:27], v[208:223]
    ds_read_b64_tr_b16 v[66:67], v8 offset:33280
    s_add_u32 m0, s73, 16384
    s_nop 0
    buffer_load_dwordx4 v4, s[32:35], s81 offen lds
    v_fma_f32 v141, v141, s91, -v100
    v_exp_f32 v124, v124
    v_add_f32 v14, v14, v122
    v_fma_f32 v126, -v142, s91, v102
    v_exp_f32 v140, v140
    v_add_f32 v12, v12, v138
    v_mfma_f32_32x32x16_bf16 v[224:239], v[80:83], a[136:139], v[224:239]
    ds_read_b64_tr_b16 v[68:69], v8 offset:40960
    s_bfe_u32 s87, s78, 0x80010
    s_lshl_b32 s87, s87, 12
    s_add_u32 s48, s87, s58
    buffer_store_dwordx4 v[36:39], v1, s[28:31], s48 offen offset:0 sc1
    v_fma_f32 v142, v142, s91, -v100
    v_exp_f32 v125, v125
    v_add_f32 v15, v15, v123
    v_fma_f32 v127, -v143, s91, v102
    v_exp_f32 v141, v141
    v_add_f32 v13, v13, v139
    v_fma_f32 v143, v143, s91, -v100
    v_mfma_f32_32x32x16_bf16 v[240:255], v[84:87], a[136:139], v[240:255]
    ds_read_b64_tr_b16 v[70:71], v8 offset:41472
    v_exp_f32 v126, v126
    v_add_f32 v14, v14, v124
    v_exp_f32 v142, v142
    v_add_f32 v12, v12, v140
    v_exp_f32 v127, v127
    v_add_f32 v15, v15, v125
    v_mfma_f32_32x32x16_bf16 v[192:207], v[88:91], a[28:31], v[192:207]
    ds_read_b64_tr_b16 v[72:73], v8 offset:34816
    buffer_load_dwordx4 v5, s[32:35], s81 offen offset:1024 lds
    v_exp_f32 v143, v143
    v_add_f32 v13, v13, v141
    v_add_f32 v14, v14, v126
    v_add_f32 v12, v12, v142
    v_add_f32 v15, v15, v127
    v_add_f32 v13, v13, v143
    v_mfma_f32_32x32x16_bf16 v[208:223], v[92:95], a[28:31], v[208:223]
    ds_read_b64_tr_b16 v[74:75], v8 offset:35328
    v_add_f32 v14, v14, v15
    v_add_f32 v12, v12, v13
    v_mov_b32 v15, v14
    v_mov_b32 v13, v12
    s_nop 0
    v_permlane32_swap_b32 v14, v15
    v_permlane32_swap_b32 v12, v13
    v_mfma_f32_32x32x16_bf16 v[224:239], v[88:91], a[140:143], v[224:239]
    ds_read_b64_tr_b16 v[76:77], v8 offset:43008
    v_add_f32 v14, v14, v15
    v_add_f32 v12, v12, v13
    v_rcp_f32 v14, v14
    v_rcp_f32 v12, v12
    v_mul_f32 v112, v112, v14
    v_mul_f32 v113, v113, v14
    v_mfma_f32_32x32x16_bf16 v[240:255], v[92:95], a[140:143], v[240:255]
    ds_read_b64_tr_b16 v[78:79], v8 offset:43520
    v_mul_f32 v114, v114, v14
    v_mul_f32 v115, v115, v14
    v_mul_f32 v116, v116, v14
    v_mul_f32 v117, v117, v14
    v_mul_f32 v118, v118, v14
    v_mul_f32 v119, v119, v14
    s_waitcnt lgkmcnt(4)
    v_mfma_f32_32x32x16_bf16 v[192:207], v[64:67], a[32:35], v[192:207]
    ds_read_b64_tr_b16 v[80:81], v8 offset:36864
    s_add_u32 m0, s73, 24576
    s_nop 0
    buffer_load_dwordx4 v4, s[36:39], s81 offen lds
    buffer_store_dwordx4 v[36:39], v1, s[28:31], s48 offen offset:1024 sc1
    v_mul_f32 v120, v120, v14
    v_mul_f32 v121, v121, v14
    v_mul_f32 v122, v122, v14
    v_mul_f32 v123, v123, v14
    v_mul_f32 v124, v124, v14
    v_mul_f32 v125, v125, v14
    v_mfma_f32_32x32x16_bf16 v[208:223], v[68:71], a[32:35], v[208:223]
    ds_read_b64_tr_b16 v[82:83], v8 offset:37376
    v_mul_f32 v126, v126, v14
    v_mul_f32 v127, v127, v14
    v_mul_f32 v128, v128, v12
    v_mul_f32 v129, v129, v12
    v_mul_f32 v130, v130, v12
    v_mul_f32 v131, v131, v12
    v_mfma_f32_32x32x16_bf16 v[224:239], v[64:67], a[144:147], v[224:239]
    ds_read_b64_tr_b16 v[84:85], v8 offset:45056
    v_mul_f32 v132, v132, v12
    v_mul_f32 v133, v133, v12
    v_mul_f32 v134, v134, v12
    v_mul_f32 v135, v135, v12
    v_mul_f32 v136, v136, v12
    v_mul_f32 v137, v137, v12
    v_mfma_f32_32x32x16_bf16 v[240:255], v[68:71], a[144:147], v[240:255]
    ds_read_b64_tr_b16 v[86:87], v8 offset:45568
    v_mul_f32 v138, v138, v12
    v_mul_f32 v139, v139, v12
    v_mul_f32 v140, v140, v12
    v_mul_f32 v141, v141, v12
    v_mul_f32 v142, v142, v12
    v_mul_f32 v143, v143, v12
    v_cvt_pk_bf16_f32 v128, v128, v129
    s_waitcnt lgkmcnt(4)
    v_mfma_f32_32x32x16_bf16 v[192:207], v[72:75], a[36:39], v[192:207]
    ds_read_b64_tr_b16 v[88:89], v8 offset:38912
    buffer_load_dwordx4 v5, s[36:39], s81 offen offset:1024 lds
    s_add_u32 s81, s81, s82
    s_cmp_eq_u32 s81, s83
    s_cselect_b32 s81, 0, s81
    v_cvt_pk_bf16_f32 v129, v130, v131
    v_cvt_pk_bf16_f32 v130, v132, v133
    v_cvt_pk_bf16_f32 v131, v134, v135
    v_cvt_pk_bf16_f32 v132, v136, v137
    v_cvt_pk_bf16_f32 v133, v138, v139
    v_cvt_pk_bf16_f32 v134, v140, v141
    v_mfma_f32_32x32x16_bf16 v[208:223], v[76:79], a[36:39], v[208:223]
    ds_read_b64_tr_b16 v[90:91], v8 offset:39424
    v_cvt_pk_bf16_f32 v135, v142, v143
    v_cvt_pk_bf16_f32 v136, v112, v113
    v_cvt_pk_bf16_f32 v137, v114, v115
    v_cvt_pk_bf16_f32 v138, v116, v117
    v_cvt_pk_bf16_f32 v139, v118, v119
    v_cvt_pk_bf16_f32 v140, v120, v121
    v_mfma_f32_32x32x16_bf16 v[224:239], v[72:75], a[148:151], v[224:239]
    ds_read_b64_tr_b16 v[92:93], v8 offset:47104
    s_add_u32 s48, s48, 114688
    buffer_store_dwordx4 v[36:39], v1, s[28:31], s48 offen offset:0 sc1
    v_cvt_pk_bf16_f32 v141, v122, v123
    v_cvt_pk_bf16_f32 v142, v124, v125
    v_cvt_pk_bf16_f32 v143, v126, v127
    ds_write_b64 v48, v[128:129] offset:8192
    ds_write_b64 v49, v[130:131] offset:8192
    ds_write_b64 v50, v[132:133] offset:8192
    v_mfma_f32_32x32x16_bf16 v[240:255], v[76:79], a[148:151], v[240:255]
    ds_read_b64_tr_b16 v[94:95], v8 offset:47616
    ds_write_b64 v51, v[134:135] offset:8192
    ds_write_b64 v48, v[136:137] offset:16384
    ds_write_b64 v49, v[138:139] offset:16384
    ds_write_b64 v50, v[140:141] offset:16384
    ds_write_b64 v51, v[142:143] offset:16384
    v_mov_b32 v12, 0x7f800000
    s_waitcnt lgkmcnt(4)
    v_mfma_f32_32x32x16_bf16 v[192:207], v[80:83], a[40:43], v[192:207]
    s_waitcnt lgkmcnt(0)
    s_waitcnt vmcnt(27)
    s_barrier
    ds_read_b64_tr_b16 v[64:65], v8 offset:49152
    v_mov_b32 v13, 0xff800000
    v_max3_f32 v96, v160, v161, v162
    v_min3_f32 v98, v160, v161, v162
    v_cndmask_b32 v172, v172, v160, s[96:97]
    v_cndmask_b32 v173, v173, v160, s[96:97]
    v_cndmask_b32 v174, v174, v160, s[96:97]
    v_mfma_f32_32x32x16_bf16 v[208:223], v[84:87], a[40:43], v[208:223]
    ds_read_b64_tr_b16 v[66:67], v8 offset:49664
    s_add_u32 m0, s73, 32768
    s_nop 0
    buffer_load_dwordx4 v4, s[32:35], s81 offen lds
    v_cndmask_b32 v175, v175, v160, s[96:97]
    v_max3_f32 v96, v96, v163, v164
    v_min3_f32 v98, v98, v163, v164
    v_max3_f32 v96, v96, v165, v166
    v_min3_f32 v98, v98, v165, v166
    v_max3_f32 v96, v96, v167, v168
    v_mfma_f32_32x32x16_bf16 v[224:239], v[80:83], a[152:155], v[224:239]
    ds_read_b64_tr_b16 v[68:69], v8 offset:57344
    v_min3_f32 v98, v98, v167, v168
    v_max3_f32 v96, v96, v169, v170
    v_min3_f32 v98, v98, v169, v170
    v_max3_f32 v96, v96, v171, v172
    v_min3_f32 v98, v98, v171, v172
    v_max3_f32 v96, v96, v173, v174
    v_mfma_f32_32x32x16_bf16 v[240:255], v[84:87], a[152:155], v[240:255]
    ds_read_b64_tr_b16 v[70:71], v8 offset:57856
    v_min3_f32 v98, v98, v173, v174
    v_max_f32 v96, v96, v175
    v_min_f32 v98, v98, v175
    v_mov_b32 v97, v96
    v_mov_b32 v99, v98
    s_nop 0
    v_permlane32_swap_b32 v96, v97
    v_mfma_f32_32x32x16_bf16 v[192:207], v[88:91], a[44:47], v[192:207]
    ds_read_b64_tr_b16 v[72:73], v8 offset:51200
    buffer_load_dwordx4 v5, s[32:35], s81 offen offset:1024 lds
    buffer_store_dwordx4 v[36:39], v1, s[28:31], s48 offen offset:1024 sc1
    v_permlane32_swap_b32 v98, v99
    v_max_f32 v96, v96, v97
    v_min_f32 v98, v98, v99
    v_mul_f32 v96, s91, v96
    v_mul_f32 v98, s91, v98
    v_cndmask_b32 v100, v96, v12, s[96:97]
    v_cndmask_b32 v102, v98, v13, s[96:97]
    v_mfma_f32_32x32x16_bf16 v[208:223], v[92:95], a[44:47], v[208:223]
    ds_read_b64_tr_b16 v[74:75], v8 offset:51712
    v_fma_f32 v112, -v160, s91, v98
    v_fma_f32 v160, v160, s91, -v96
    v_fma_f32 v113, -v161, s91, v98
    v_fma_f32 v161, v161, s91, -v96
    v_exp_f32 v112, v112
    v_fma_f32 v114, -v162, s91, v98
    v_mfma_f32_32x32x16_bf16 v[224:239], v[88:91], a[156:159], v[224:239]
    ds_read_b64_tr_b16 v[76:77], v8 offset:59392
    v_exp_f32 v160, v160
    v_fma_f32 v162, v162, s91, -v96
    v_exp_f32 v113, v113
    v_fma_f32 v115, -v163, s91, v98
    v_exp_f32 v161, v161
    v_fma_f32 v163, v163, s91, -v96
    v_mfma_f32_32x32x16_bf16 v[240:255], v[92:95], a[156:159], v[240:255]
    ds_read_b64_tr_b16 v[78:79], v8 offset:59904
    v_exp_f32 v114, v114
    v_fma_f32 v116, -v164, s91, v98
    v_exp_f32 v162, v162
    v_fma_f32 v164, v164, s91, -v96
    v_exp_f32 v115, v115
    v_fma_f32 v117, -v165, s91, v98
    s_waitcnt lgkmcnt(4)
    v_mfma_f32_32x32x16_bf16 v[192:207], v[64:67], a[48:51], v[192:207]
    ds_read_b64_tr_b16 v[80:81], v8 offset:53248
    s_add_u32 m0, s73, 40960
    s_nop 0
    buffer_load_dwordx4 v4, s[36:39], s81 offen lds
    v_exp_f32 v163, v163
    v_fma_f32 v165, v165, s91, -v96
    v_exp_f32 v116, v116
    v_add_f32 v14, v112, v114
    v_fma_f32 v118, -v166, s91, v98
    v_exp_f32 v164, v164
    v_mfma_f32_32x32x16_bf16 v[208:223], v[68:71], a[48:51], v[208:223]
    ds_read_b64_tr_b16 v[82:83], v8 offset:53760
    v_add_f32 v12, v160, v162
    v_fma_f32 v166, v166, s91, -v96
    v_exp_f32 v117, v117
    v_add_f32 v15, v113, v115
    v_fma_f32 v119, -v167, s91, v98
    v_exp_f32 v165, v165
    v_mfma_f32_32x32x16_bf16 v[224:239], v[64:67], a[160:163], v[224:239]
    ds_read_b64_tr_b16 v[84:85], v8 offset:61440
    v_add_f32 v13, v161, v163
    v_fma_f32 v167, v167, s91, -v96
    v_exp_f32 v118, v118
    v_add_f32 v14, v14, v116
    v_fma_f32 v120, -v168, s91, v98
    v_exp_f32 v166, v166
    v_mfma_f32_32x32x16_bf16 v[240:255], v[68:71], a[160:163], v[240:255]
    ds_read_b64_tr_b16 v[86:87], v8 offset:61952
    v_add_f32 v12, v12, v164
    v_fma_f32 v168, v168, s91, -v96
    v_exp_f32 v119, v119
    v_add_f32 v15, v15, v117
    v_fma_f32 v121, -v169, s91, v98
    v_exp_f32 v167, v167
    s_waitcnt lgkmcnt(4)
    v_mfma_f32_32x32x16_bf16 v[192:207], v[72:75], a[52:55], v[192:207]
    ds_read_b64_tr_b16 v[88:89], v8 offset:55296
    buffer_load_dwordx4 v5, s[36:39], s81 offen offset:1024 lds
    s_add_u32 s81, s81, s82
    s_cmp_eq_u32 s81, s83
    s_cselect_b32 s81, 0, s81
    v_add_f32 v13, v13, v165
    v_fma_f32 v169, v169, s91, -v96
    v_exp_f32 v120, v120
    v_add_f32 v14, v14, v118
    v_fma_f32 v122, -v170, s91, v98
    v_exp_f32 v168, v168
    v_mfma_f32_32x32x16_bf16 v[208:223], v[76:79], a[52:55], v[208:223]
    ds_read_b64_tr_b16 v[90:91], v8 offset:55808
    v_add_f32 v12, v12, v166
    v_fma_f32 v170, v170, s91, -v96
    v_exp_f32 v121, v121
    v_add_f32 v15, v15, v119
    v_fma_f32 v123, -v171, s91, v98
    v_exp_f32 v169, v169
    v_add_f32 v13, v13, v167
    v_mfma_f32_32x32x16_bf16 v[224:239], v[72:75], a[164:167], v[224:239]
    ds_read_b64_tr_b16 v[92:93], v8 offset:63488
    v_fma_f32 v171, v171, s91, -v96
    v_exp_f32 v122, v122
    v_add_f32 v14, v14, v120
    v_fma_f32 v124, -v172, s91, v102
    v_exp_f32 v170, v170
    v_add_f32 v12, v12, v168
    v_mfma_f32_32x32x16_bf16 v[240:255], v[76:79], a[164:167], v[240:255]
    ds_read_b64_tr_b16 v[94:95], v8 offset:64000
    v_fma_f32 v172, v172, s91, -v100
    v_exp_f32 v123, v123
    v_add_f32 v15, v15, v121
    v_fma_f32 v125, -v173, s91, v102
    v_exp_f32 v171, v171
    v_add_f32 v13, v13, v169
    s_waitcnt lgkmcnt(4)
    v_mfma_f32_32x32x16_bf16 v[192:207], v[80:83], a[56:59], v[192:207]
    s_waitcnt lgkmcnt(0)
    s_waitcnt vmcnt(28)
    s_barrier
    ds_read_b64_tr_b16 v[64:65], v9 offset:0
    v_fma_f32 v173, v173, s91, -v100
    v_exp_f32 v124, v124
    v_add_f32 v14, v14, v122
    v_fma_f32 v126, -v174, s91, v102
    v_exp_f32 v172, v172
    v_add_f32 v12, v12, v170
    v_mfma_f32_32x32x16_bf16 v[208:223], v[84:87], a[56:59], v[208:223]
    ds_read_b64_tr_b16 v[66:67], v9 offset:512
    s_add_u32 m0, s73, 49152
    s_nop 0
    buffer_load_dwordx4 v4, s[32:35], s81 offen lds
    v_fma_f32 v174, v174, s91, -v100
    v_exp_f32 v125, v125
    v_add_f32 v15, v15, v123
    v_fma_f32 v127, -v175, s91, v102
    v_exp_f32 v173, v173
    v_add_f32 v13, v13, v171
    v_mfma_f32_32x32x16_bf16 v[224:239], v[80:83], a[168:171], v[224:239]
    ds_read_b64_tr_b16 v[68:69], v9 offset:8192
    v_fma_f32 v175, v175, s91, -v100
    v_exp_f32 v126, v126
    v_add_f32 v14, v14, v124
    v_exp_f32 v174, v174
    v_add_f32 v12, v12, v172
    v_exp_f32 v127, v127
    v_mfma_f32_32x32x16_bf16 v[240:255], v[84:87], a[168:171], v[240:255]
    ds_read_b64_tr_b16 v[70:71], v9 offset:8704
    v_add_f32 v15, v15, v125
    v_exp_f32 v175, v175
    v_add_f32 v13, v13, v173
    v_add_f32 v14, v14, v126
    v_add_f32 v12, v12, v174
    v_add_f32 v15, v15, v127
    v_mfma_f32_32x32x16_bf16 v[192:207], v[88:91], a[60:63], v[192:207]
    ds_read_b64_tr_b16 v[72:73], v9 offset:2048
    buffer_load_dwordx4 v5, s[32:35], s81 offen offset:1024 lds
    v_add_f32 v13, v13, v175
    v_add_f32 v14, v14, v15
    v_add_f32 v12, v12, v13
    v_mov_b32 v15, v14
    v_mov_b32 v13, v12
    s_nop 0
    v_permlane32_swap_b32 v14, v15
    v_mfma_f32_32x32x16_bf16 v[208:223], v[92:95], a[60:63], v[208:223]
    ds_read_b64_tr_b16 v[74:75], v9 offset:2560
    v_permlane32_swap_b32 v12, v13
    v_add_f32 v14, v14, v15
    v_add_f32 v12, v12, v13
    v_rcp_f32 v14, v14
    v_rcp_f32 v12, v12
    v_mul_f32 v112, v112, v14
    v_mfma_f32_32x32x16_bf16 v[224:239], v[88:91], a[172:175], v[224:239]
    ds_read_b64_tr_b16 v[76:77], v9 offset:10240
    v_mul_f32 v113, v113, v14
    v_mul_f32 v114, v114, v14
    v_mul_f32 v115, v115, v14
    v_mul_f32 v116, v116, v14
    v_mul_f32 v117, v117, v14
    v_mul_f32 v118, v118, v14
    v_mul_f32 v119, v119, v14
    v_mfma_f32_32x32x16_bf16 v[240:255], v[92:95], a[172:175], v[240:255]
    ds_read_b64_tr_b16 v[78:79], v9 offset:10752
    v_mul_f32 v120, v120, v14
    v_mul_f32 v121, v121, v14
    v_mul_f32 v122, v122, v14
    v_mul_f32 v123, v123, v14
    v_mul_f32 v124, v124, v14
    v_mul_f32 v125, v125, v14
    s_waitcnt lgkmcnt(4)
    v_mfma_f32_32x32x16_bf16 v[192:207], v[64:67], a[64:67], v[192:207]
    ds_read_b64_tr_b16 v[80:81], v9 offset:4096
    s_add_u32 m0, s73, 57344
    s_nop 0
    buffer_load_dwordx4 v4, s[36:39], s81 offen lds
    v_mul_f32 v126, v126, v14
    v_mul_f32 v127, v127, v14
    v_mul_f32 v160, v160, v12
    v_mul_f32 v161, v161, v12
    v_mul_f32 v162, v162, v12
    v_mul_f32 v163, v163, v12
    v_mfma_f32_32x32x16_bf16 v[208:223], v[68:71], a[64:67], v[208:223]
    ds_read_b64_tr_b16 v[82:83], v9 offset:4608
    v_mul_f32 v164, v164, v12
    v_mul_f32 v165, v165, v12
    v_mul_f32 v166, v166, v12
    v_mul_f32 v167, v167, v12
    v_mul_f32 v168, v168, v12
    v_mul_f32 v169, v169, v12
    v_mfma_f32_32x32x16_bf16 v[224:239], v[64:67], a[176:179], v[224:239]
    ds_read_b64_tr_b16 v[84:85], v9 offset:12288
    v_mul_f32 v170, v170, v12
    v_mul_f32 v171, v171, v12
    v_mul_f32 v172, v172, v12
    v_mul_f32 v173, v173, v12
    v_mul_f32 v174, v174, v12
    v_mul_f32 v175, v175, v12
    v_mfma_f32_32x32x16_bf16 v[240:255], v[68:71], a[176:179], v[240:255]
    ds_read_b64_tr_b16 v[86:87], v9 offset:12800
    v_cvt_pk_bf16_f32 v160, v160, v161
    v_cvt_pk_bf16_f32 v161, v162, v163
    v_cvt_pk_bf16_f32 v162, v164, v165
    v_cvt_pk_bf16_f32 v163, v166, v167
    v_cvt_pk_bf16_f32 v164, v168, v169
    v_cvt_pk_bf16_f32 v165, v170, v171
    s_waitcnt lgkmcnt(4)
    v_mfma_f32_32x32x16_bf16 v[192:207], v[72:75], a[68:71], v[192:207]
    ds_read_b64_tr_b16 v[88:89], v9 offset:6144
    buffer_load_dwordx4 v5, s[36:39], s81 offen offset:1024 lds
    s_add_u32 s81, s81, s82
    s_cmp_eq_u32 s81, s83
    s_cselect_b32 s81, 0, s81
    v_cvt_pk_bf16_f32 v166, v172, v173
    v_cvt_pk_bf16_f32 v167, v174, v175
    v_cvt_pk_bf16_f32 v168, v112, v113
    v_cvt_pk_bf16_f32 v169, v114, v115
    v_cvt_pk_bf16_f32 v170, v116, v117
    v_cvt_pk_bf16_f32 v171, v118, v119
    v_mfma_f32_32x32x16_bf16 v[208:223], v[76:79], a[68:71], v[208:223]
    ds_read_b64_tr_b16 v[90:91], v9 offset:6656
    v_cvt_pk_bf16_f32 v172, v120, v121
    v_cvt_pk_bf16_f32 v173, v122, v123
    v_cvt_pk_bf16_f32 v174, v124, v125
    v_cvt_pk_bf16_f32 v175, v126, v127
    ds_write_b64 v48, v[160:161] offset:10240
    ds_write_b64 v49, v[162:163] offset:10240
    v_mfma_f32_32x32x16_bf16 v[224:239], v[72:75], a[180:183], v[224:239]
    ds_read_b64_tr_b16 v[92:93], v9 offset:14336
    ds_write_b64 v50, v[164:165] offset:10240
    ds_write_b64 v51, v[166:167] offset:10240
    ds_write_b64 v48, v[168:169] offset:18432
    ds_write_b64 v49, v[170:171] offset:18432
    ds_write_b64 v50, v[172:173] offset:18432
    ds_write_b64 v51, v[174:175] offset:18432
    v_mfma_f32_32x32x16_bf16 v[240:255], v[76:79], a[180:183], v[240:255]
    ds_read_b64_tr_b16 v[94:95], v9 offset:14848
    s_waitcnt lgkmcnt(4)
    v_mfma_f32_32x32x16_bf16 v[192:207], v[80:83], a[72:75], v[192:207]
    s_waitcnt lgkmcnt(0)
    s_waitcnt vmcnt(28)
    s_barrier
    ds_read_b64_tr_b16 v[144:145], v54 offset:0
    ds_read_b64_tr_b16 v[146:147], v55 offset:0
    ds_read_b64_tr_b16 v[148:149], v52 offset:0
    ds_read_b64_tr_b16 v[150:151], v53 offset:0
    ds_read_b64_tr_b16 v[152:153], v54 offset:1024
    ds_read_b64_tr_b16 v[154:155], v55 offset:1024
    ds_read_b64_tr_b16 v[156:157], v52 offset:1024
    ds_read_b64_tr_b16 v[158:159], v53 offset:1024
    ds_read_b64_tr_b16 v[160:161], v54 offset:2048
    ds_read_b64_tr_b16 v[162:163], v55 offset:2048
    ds_read_b64_tr_b16 v[164:165], v52 offset:2048
    ds_read_b64_tr_b16 v[166:167], v53 offset:2048
    s_waitcnt lgkmcnt(8)
    v_mfma_f32_32x32x16_bf16 v[128:143], v[144:147], v[148:151], 0
    ds_read_b64_tr_b16 v[168:169], v54 offset:3072
    ds_read_b64_tr_b16 v[170:171], v55 offset:3072
    ds_read_b64_tr_b16 v[172:173], v52 offset:3072
    ds_read_b64_tr_b16 v[174:175], v53 offset:3072
    s_waitcnt lgkmcnt(8)
    v_mfma_f32_32x32x16_bf16 v[128:143], v[152:155], v[156:159], v[128:143]
    ds_read_b64_tr_b16 v[144:145], v54 offset:4096
    ds_read_b64_tr_b16 v[146:147], v55 offset:4096
    ds_read_b64_tr_b16 v[148:149], v52 offset:4096
    ds_read_b64_tr_b16 v[150:151], v53 offset:4096
    s_waitcnt lgkmcnt(8)
    v_mfma_f32_32x32x16_bf16 v[128:143], v[160:163], v[164:167], v[128:143]
    ds_read_b64_tr_b16 v[152:153], v54 offset:5120
    ds_read_b64_tr_b16 v[154:155], v55 offset:5120
    ds_read_b64_tr_b16 v[156:157], v52 offset:5120
    ds_read_b64_tr_b16 v[158:159], v53 offset:5120
    s_waitcnt lgkmcnt(8)
    v_mfma_f32_32x32x16_bf16 v[128:143], v[168:171], v[172:175], v[128:143]
    ds_read_b64_tr_b16 v[160:161], v54 offset:6144
    ds_read_b64_tr_b16 v[162:163], v55 offset:6144
    ds_read_b64_tr_b16 v[164:165], v52 offset:6144
    ds_read_b64_tr_b16 v[166:167], v53 offset:6144
    s_waitcnt lgkmcnt(8)
    v_mfma_f32_32x32x16_bf16 v[128:143], v[144:147], v[148:151], v[128:143]
    ds_read_b64_tr_b16 v[168:169], v54 offset:7168
    ds_read_b64_tr_b16 v[170:171], v55 offset:7168
    ds_read_b64_tr_b16 v[172:173], v52 offset:7168
    ds_read_b64_tr_b16 v[174:175], v53 offset:7168
    s_waitcnt lgkmcnt(8)
    v_mfma_f32_32x32x16_bf16 v[128:143], v[152:155], v[156:159], v[128:143]
    s_waitcnt lgkmcnt(4)
    v_mfma_f32_32x32x16_bf16 v[128:143], v[160:163], v[164:167], v[128:143]
    s_waitcnt lgkmcnt(0)
    v_mfma_f32_32x32x16_bf16 v[128:143], v[168:171], v[172:175], v[128:143]
    ds_read_b64_tr_b16 v[64:65], v9 offset:16384
    v_mfma_f32_32x32x16_bf16 v[208:223], v[84:87], a[72:75], v[208:223]
    ds_read_b64_tr_b16 v[66:67], v9 offset:16896
    s_add_u32 m0, s73, 65536
    s_nop 0
    buffer_load_dwordx4 v4, s[32:35], s81 offen lds
    v_mfma_f32_32x32x16_bf16 v[224:239], v[80:83], a[184:187], v[224:239]
    ds_read_b64_tr_b16 v[68:69], v9 offset:24576
    v_mfma_f32_32x32x16_bf16 v[240:255], v[84:87], a[184:187], v[240:255]
    ds_read_b64_tr_b16 v[70:71], v9 offset:25088
    v_mfma_f32_32x32x16_bf16 v[192:207], v[88:91], a[76:79], v[192:207]
    ds_read_b64_tr_b16 v[72:73], v9 offset:18432
    buffer_load_dwordx4 v5, s[32:35], s81 offen offset:1024 lds
    s_and_b32 s87, s78, 0xff
    s_lshl_b32 s87, s87, 2
    s_add_u32 s87, s87, s72
    s_lshl_b32 s88, s87, 16
    s_lshl_b32 s89, s76, 10
    s_add_u32 s88, s88, s89
    s_add_u32 s49, s88, 10485760
    v_and_b32 v14, 3, v0
    v_lshlrev_b32 v14, 3, v14
    v_lshrrev_b32 v14, v14, v22
    v_and_b32 v14, 0xff, v14
    s_movk_i32 s87, 0xff
    v_bfi_b32 v128, s87, v14, v128
    v_bfi_b32 v132, s87, v14, v132
    v_bfi_b32 v136, s87, v14, v136
    v_bfi_b32 v140, s87, v14, v140
    buffer_store_dwordx4 v[128:131], v1, s[28:31], s49 offen sc1
    s_add_u32 s49, s49, 16384
    buffer_store_dwordx4 v[132:135], v1, s[28:31], s49 offen sc1
    s_add_u32 s49, s49, 16384
    buffer_store_dwordx4 v[136:139], v1, s[28:31], s49 offen sc1
    s_add_u32 s49, s49, 16384
    buffer_store_dwordx4 v[140:143], v1, s[28:31], s49 offen sc1
    v_mfma_f32_32x32x16_bf16 v[208:223], v[92:95], a[76:79], v[208:223]
    ds_read_b64_tr_b16 v[74:75], v9 offset:18944
    v_mfma_f32_32x32x16_bf16 v[224:239], v[88:91], a[188:191], v[224:239]
    ds_read_b64_tr_b16 v[76:77], v9 offset:26624
    v_mfma_f32_32x32x16_bf16 v[240:255], v[92:95], a[188:191], v[240:255]
    ds_read_b64_tr_b16 v[78:79], v9 offset:27136
    s_waitcnt lgkmcnt(4)
    v_mfma_f32_32x32x16_bf16 v[192:207], v[64:67], a[80:83], v[192:207]
    ds_read_b64_tr_b16 v[80:81], v9 offset:20480
    s_add_u32 m0, s73, 73728
    s_nop 0
    buffer_load_dwordx4 v4, s[36:39], s81 offen lds
    v_mfma_f32_32x32x16_bf16 v[208:223], v[68:71], a[80:83], v[208:223]
    ds_read_b64_tr_b16 v[82:83], v9 offset:20992
    v_mfma_f32_32x32x16_bf16 v[224:239], v[64:67], a[192:195], v[224:239]
    ds_read_b64_tr_b16 v[84:85], v9 offset:28672
    v_mfma_f32_32x32x16_bf16 v[240:255], v[68:71], a[192:195], v[240:255]
    ds_read_b64_tr_b16 v[86:87], v9 offset:29184
    s_waitcnt lgkmcnt(4)
    v_mfma_f32_32x32x16_bf16 v[192:207], v[72:75], a[84:87], v[192:207]
    ds_read_b64_tr_b16 v[88:89], v9 offset:22528
    buffer_load_dwordx4 v5, s[36:39], s81 offen offset:1024 lds
    s_add_u32 s81, s81, s82
    s_cmp_eq_u32 s81, s83
    s_cselect_b32 s81, 0, s81
    v_mfma_f32_32x32x16_bf16 v[208:223], v[76:79], a[84:87], v[208:223]
    ds_read_b64_tr_b16 v[90:91], v9 offset:23040
    v_mfma_f32_32x32x16_bf16 v[224:239], v[72:75], a[196:199], v[224:239]
    ds_read_b64_tr_b16 v[92:93], v9 offset:30720
    v_mfma_f32_32x32x16_bf16 v[240:255], v[76:79], a[196:199], v[240:255]
    ds_read_b64_tr_b16 v[94:95], v9 offset:31232
    s_waitcnt lgkmcnt(4)
    v_mfma_f32_32x32x16_bf16 v[192:207], v[80:83], a[88:91], v[192:207]
    s_waitcnt lgkmcnt(0)
    s_waitcnt vmcnt(10)
    s_barrier
    s_cmp_lg_u32 s63, 1
    s_cbranch_scc1 Lwf_1
    v_mov_b32 v15, s79
    s_mov_b64 exec, 0xff
    buffer_store_dword v15, v19, s[28:31], s59 offen sc1
    s_mov_b64 exec, -1
Lwf_1:
    s_mov_b32 s63, 0
    ds_read_b64_tr_b16 v[64:65], v9 offset:32768
    v_mfma_f32_32x32x16_bf16 v[208:223], v[84:87], a[88:91], v[208:223]
    ds_read_b64_tr_b16 v[66:67], v9 offset:33280
    s_add_u32 m0, s73, 81920
    s_nop 0
    buffer_load_dwordx4 v4, s[32:35], s81 offen lds
    v_mfma_f32_32x32x16_bf16 v[224:239], v[80:83], a[200:203], v[224:239]
    ds_read_b64_tr_b16 v[68:69], v9 offset:40960
    v_mfma_f32_32x32x16_bf16 v[240:255], v[84:87], a[200:203], v[240:255]
    ds_read_b64_tr_b16 v[70:71], v9 offset:41472
    v_mfma_f32_32x32x16_bf16 v[192:207], v[88:91], a[92:95], v[192:207]
    ds_read_b64_tr_b16 v[72:73], v9 offset:34816
    buffer_load_dwordx4 v5, s[32:35], s81 offen offset:1024 lds
    v_mfma_f32_32x32x16_bf16 v[208:223], v[92:95], a[92:95], v[208:223]
    ds_read_b64_tr_b16 v[74:75], v9 offset:35328
    v_mfma_f32_32x32x16_bf16 v[224:239], v[88:91], a[204:207], v[224:239]
    ds_read_b64_tr_b16 v[76:77], v9 offset:43008
    v_mfma_f32_32x32x16_bf16 v[240:255], v[92:95], a[204:207], v[240:255]
    ds_read_b64_tr_b16 v[78:79], v9 offset:43520
    s_waitcnt lgkmcnt(4)
    v_mfma_f32_32x32x16_bf16 v[192:207], v[64:67], a[96:99], v[192:207]
    ds_read_b64_tr_b16 v[80:81], v9 offset:36864
    s_add_u32 m0, s73, 90112
    s_nop 0
    buffer_load_dwordx4 v4, s[36:39], s81 offen lds
    v_mfma_f32_32x32x16_bf16 v[208:223], v[68:71], a[96:99], v[208:223]
    ds_read_b64_tr_b16 v[82:83], v9 offset:37376
    v_mfma_f32_32x32x16_bf16 v[224:239], v[64:67], a[208:211], v[224:239]
    ds_read_b64_tr_b16 v[84:85], v9 offset:45056
    v_mfma_f32_32x32x16_bf16 v[240:255], v[68:71], a[208:211], v[240:255]
    ds_read_b64_tr_b16 v[86:87], v9 offset:45568
    s_waitcnt lgkmcnt(4)
    v_mfma_f32_32x32x16_bf16 v[192:207], v[72:75], a[100:103], v[192:207]
    ds_read_b64_tr_b16 v[88:89], v9 offset:38912
    buffer_load_dwordx4 v5, s[36:39], s81 offen offset:1024 lds
    s_add_u32 s81, s81, s82
    s_cmp_eq_u32 s81, s83
    s_cselect_b32 s81, 0, s81
    v_mfma_f32_32x32x16_bf16 v[208:223], v[76:79], a[100:103], v[208:223]
    ds_read_b64_tr_b16 v[90:91], v9 offset:39424
    v_mfma_f32_32x32x16_bf16 v[224:239], v[72:75], a[212:215], v[224:239]
    ds_read_b64_tr_b16 v[92:93], v9 offset:47104
    v_mfma_f32_32x32x16_bf16 v[240:255], v[76:79], a[212:215], v[240:255]
    ds_read_b64_tr_b16 v[94:95], v9 offset:47616
    s_waitcnt lgkmcnt(4)
    v_mfma_f32_32x32x16_bf16 v[192:207], v[80:83], a[104:107], v[192:207]
    s_waitcnt lgkmcnt(0)
    s_barrier
    ds_read_b64_tr_b16 v[64:65], v8 offset:0
    v_mfma_f32_32x32x16_bf16 v[208:223], v[84:87], a[104:107], v[208:223]
    ds_read_b64_tr_b16 v[66:67], v8 offset:512
    v_mfma_f32_32x32x16_bf16 v[224:239], v[80:83], a[216:219], v[224:239]
    ds_read_b64_tr_b16 v[68:69], v8 offset:8192
    v_mfma_f32_32x32x16_bf16 v[240:255], v[84:87], a[216:219], v[240:255]
    ds_read_b64_tr_b16 v[70:71], v8 offset:8704
    v_mfma_f32_32x32x16_bf16 v[192:207], v[88:91], a[108:111], v[192:207]
    ds_read_b64_tr_b16 v[72:73], v8 offset:2048
    v_mfma_f32_32x32x16_bf16 v[208:223], v[92:95], a[108:111], v[208:223]
    ds_read_b64_tr_b16 v[74:75], v8 offset:2560
    v_mfma_f32_32x32x16_bf16 v[224:239], v[88:91], a[220:223], v[224:239]
    ds_read_b64_tr_b16 v[76:77], v8 offset:10240
    v_mfma_f32_32x32x16_bf16 v[240:255], v[92:95], a[220:223], v[240:255]
    ds_read_b64_tr_b16 v[78:79], v8 offset:10752
    s_lshr_b32 s78, s78, 8
    s_branch Lmc
Lr1:
    v_cvt_pk_bf16_f32 v144, v144, v145
    v_cvt_pk_bf16_f32 v145, v146, v147
    v_cvt_pk_bf16_f32 v146, v148, v149
    v_cvt_pk_bf16_f32 v147, v150, v151
    v_cvt_pk_bf16_f32 v148, v152, v153
    v_cvt_pk_bf16_f32 v149, v154, v155
    v_cvt_pk_bf16_f32 v150, v156, v157
    v_cvt_pk_bf16_f32 v151, v158, v159
    v_mov_b32 v14, 0x3f80
    v_cndmask_b32 v150, v150, v14, s[96:97]
    v_cndmask_b32 v151, v151, 0, s[96:97]
    ds_write_b64 v48, v[144:145] offset:0
    ds_write_b64 v49, v[146:147] offset:0
    ds_write_b64 v50, v[148:149] offset:0
    ds_write_b64 v51, v[150:151] offset:0
    v_cvt_pk_bf16_f32 v176, v176, v177
    v_cvt_pk_bf16_f32 v177, v178, v179
    v_cvt_pk_bf16_f32 v178, v180, v181
    v_cvt_pk_bf16_f32 v179, v182, v183
    v_cvt_pk_bf16_f32 v180, v184, v185
    v_cvt_pk_bf16_f32 v181, v186, v187
    v_cvt_pk_bf16_f32 v182, v188, v189
    v_cvt_pk_bf16_f32 v183, v190, v191
    v_mov_b32 v14, 0x3f80
    v_cndmask_b32 v182, v182, v14, s[96:97]
    v_cndmask_b32 v183, v183, 0, s[96:97]
    ds_write_b64 v48, v[176:177] offset:2048
    ds_write_b64 v49, v[178:179] offset:2048
    ds_write_b64 v50, v[180:181] offset:2048
    ds_write_b64 v51, v[182:183] offset:2048
    v_cvt_pk_bf16_f32 v104, v128, v129
    v_cvt_pk_bf16_f32 v105, v130, v131
    v_cvt_pk_bf16_f32 v106, v132, v133
    v_cvt_pk_bf16_f32 v107, v134, v135
    v_cvt_pk_bf16_f32 v108, v136, v137
    v_cvt_pk_bf16_f32 v109, v138, v139
    v_cvt_pk_bf16_f32 v110, v140, v141
    v_cvt_pk_bf16_f32 v111, v142, v143
    v_cndmask_b32 v110, v110, 0, s[96:97]
    v_cndmask_b32 v111, v111, 0, s[96:97]
    v_mfma_f32_32x32x16_bf16 v[128:143], v[112:115], v[104:107], 0
    s_nop 0
    v_mfma_f32_32x32x16_bf16 v[128:143], v[116:119], v[108:111], v[128:143]
    v_cvt_pk_bf16_f32 v96, v160, v161
    v_cvt_pk_bf16_f32 v97, v162, v163
    v_cvt_pk_bf16_f32 v98, v164, v165
    v_cvt_pk_bf16_f32 v99, v166, v167
    v_cvt_pk_bf16_f32 v100, v168, v169
    v_cvt_pk_bf16_f32 v101, v170, v171
    v_cvt_pk_bf16_f32 v102, v172, v173
    v_cvt_pk_bf16_f32 v103, v174, v175
    v_cndmask_b32 v102, v102, 0, s[96:97]
    v_cndmask_b32 v103, v103, 0, s[96:97]
    v_mfma_f32_32x32x16_bf16 v[160:175], v[112:115], v[96:99], 0
    s_nop 0
    v_mfma_f32_32x32x16_bf16 v[160:175], v[116:119], v[100:103], v[160:175]
    v_mov_b32 v8, v35
    v_add_u32 v9, 0x10000, v35
    v_mov_b32 v12, 0x7f800000
    v_mov_b32 v13, 0xff800000
    v_max3_f32 v96, v128, v129, v130
    v_min3_f32 v98, v128, v129, v130
    v_cndmask_b32 v140, v140, v128, s[96:97]
    v_cndmask_b32 v141, v141, v128, s[96:97]
    v_cndmask_b32 v142, v142, v128, s[96:97]
    v_cndmask_b32 v143, v143, v128, s[96:97]
    v_max3_f32 v96, v96, v131, v132
    v_min3_f32 v98, v98, v131, v132
    v_max3_f32 v96, v96, v133, v134
    v_min3_f32 v98, v98, v133, v134
    v_max3_f32 v96, v96, v135, v136
    v_min3_f32 v98, v98, v135, v136
    v_max3_f32 v96, v96, v137, v138
    v_min3_f32 v98, v98, v137, v138
    v_max3_f32 v96, v96, v139, v140
    v_min3_f32 v98, v98, v139, v140
    v_max3_f32 v96, v96, v141, v142
    v_min3_f32 v98, v98, v141, v142
    v_max_f32 v96, v96, v143
    v_min_f32 v98, v98, v143
    v_mov_b32 v97, v96
    v_mov_b32 v99, v98
    s_nop 0
    v_permlane32_swap_b32 v96, v97
    v_permlane32_swap_b32 v98, v99
    v_max_f32 v96, v96, v97
    v_min_f32 v98, v98, v99
    v_mul_f32 v96, s91, v96
    v_mul_f32 v98, s91, v98
    v_cndmask_b32 v100, v96, v12, s[96:97]
    v_cndmask_b32 v102, v98, v13, s[96:97]
    v_pk_fma_f32 v[112:113], v[128:129], s[50:51], v[98:99] op_sel_hi:[1,1,0] neg_lo:[1,0,0] neg_hi:[1,0,0]
    v_pk_fma_f32 v[128:129], v[128:129], s[50:51], v[96:97] op_sel_hi:[1,1,0] neg_lo:[0,0,1] neg_hi:[0,0,1]
    v_exp_f32 v112, v112
    v_pk_fma_f32 v[114:115], v[130:131], s[50:51], v[98:99] op_sel_hi:[1,1,0] neg_lo:[1,0,0] neg_hi:[1,0,0]
    v_exp_f32 v128, v128
    v_pk_fma_f32 v[130:131], v[130:131], s[50:51], v[96:97] op_sel_hi:[1,1,0] neg_lo:[0,0,1] neg_hi:[0,0,1]
    v_exp_f32 v113, v113
    v_exp_f32 v129, v129
    v_exp_f32 v114, v114
    v_pk_fma_f32 v[116:117], v[132:133], s[50:51], v[98:99] op_sel_hi:[1,1,0] neg_lo:[1,0,0] neg_hi:[1,0,0]
    v_exp_f32 v130, v130
    v_pk_fma_f32 v[132:133], v[132:133], s[50:51], v[96:97] op_sel_hi:[1,1,0] neg_lo:[0,0,1] neg_hi:[0,0,1]
    v_exp_f32 v115, v115
    v_exp_f32 v131, v131
    v_exp_f32 v116, v116
    v_pk_fma_f32 v[118:119], v[134:135], s[50:51], v[98:99] op_sel_hi:[1,1,0] neg_lo:[1,0,0] neg_hi:[1,0,0]
    v_exp_f32 v132, v132
    v_pk_fma_f32 v[134:135], v[134:135], s[50:51], v[96:97] op_sel_hi:[1,1,0] neg_lo:[0,0,1] neg_hi:[0,0,1]
    v_exp_f32 v117, v117
    v_pk_add_f32 v[14:15], v[112:113], v[114:115]
    v_exp_f32 v133, v133
    v_pk_add_f32 v[12:13], v[128:129], v[130:131]
    v_exp_f32 v118, v118
    v_pk_fma_f32 v[120:121], v[136:137], s[50:51], v[98:99] op_sel_hi:[1,1,0] neg_lo:[1,0,0] neg_hi:[1,0,0]
    v_exp_f32 v134, v134
    v_pk_fma_f32 v[136:137], v[136:137], s[50:51], v[96:97] op_sel_hi:[1,1,0] neg_lo:[0,0,1] neg_hi:[0,0,1]
    v_exp_f32 v119, v119
    v_pk_add_f32 v[14:15], v[14:15], v[116:117]
    v_exp_f32 v135, v135
    v_pk_add_f32 v[12:13], v[12:13], v[132:133]
    v_exp_f32 v120, v120
    v_pk_fma_f32 v[122:123], v[138:139], s[50:51], v[98:99] op_sel_hi:[1,1,0] neg_lo:[1,0,0] neg_hi:[1,0,0]
    v_exp_f32 v136, v136
    v_pk_fma_f32 v[138:139], v[138:139], s[50:51], v[96:97] op_sel_hi:[1,1,0] neg_lo:[0,0,1] neg_hi:[0,0,1]
    v_exp_f32 v121, v121
    v_pk_add_f32 v[14:15], v[14:15], v[118:119]
    v_exp_f32 v137, v137
    v_pk_add_f32 v[12:13], v[12:13], v[134:135]
    v_exp_f32 v122, v122
    v_pk_fma_f32 v[124:125], v[140:141], s[50:51], v[102:103] op_sel_hi:[1,1,0] neg_lo:[1,0,0] neg_hi:[1,0,0]
    v_exp_f32 v138, v138
    v_pk_fma_f32 v[140:141], v[140:141], s[50:51], v[100:101] op_sel_hi:[1,1,0] neg_lo:[0,0,1] neg_hi:[0,0,1]
    v_exp_f32 v123, v123
    v_pk_add_f32 v[14:15], v[14:15], v[120:121]
    v_exp_f32 v139, v139
    v_pk_add_f32 v[12:13], v[12:13], v[136:137]
    v_exp_f32 v124, v124
    v_pk_fma_f32 v[126:127], v[142:143], s[50:51], v[102:103] op_sel_hi:[1,1,0] neg_lo:[1,0,0] neg_hi:[1,0,0]
    v_exp_f32 v140, v140
    v_pk_fma_f32 v[142:143], v[142:143], s[50:51], v[100:101] op_sel_hi:[1,1,0] neg_lo:[0,0,1] neg_hi:[0,0,1]
    v_exp_f32 v125, v125
    v_pk_add_f32 v[14:15], v[14:15], v[122:123]
    v_exp_f32 v141, v141
    v_pk_add_f32 v[12:13], v[12:13], v[138:139]
    v_exp_f32 v126, v126
    v_exp_f32 v142, v142
    v_exp_f32 v127, v127
    v_pk_add_f32 v[14:15], v[14:15], v[124:125]
    v_exp_f32 v143, v143
    v_pk_add_f32 v[12:13], v[12:13], v[140:141]
    v_pk_add_f32 v[14:15], v[14:15], v[126:127]
    v_pk_add_f32 v[12:13], v[12:13], v[142:143]
    v_add_f32 v14, v14, v15
    v_add_f32 v12, v12, v13
    v_mov_b32 v15, v14
    v_mov_b32 v13, v12
    s_nop 0
    v_permlane32_swap_b32 v14, v15
    v_permlane32_swap_b32 v12, v13
    v_add_f32 v14, v14, v15
    v_add_f32 v12, v12, v13
    v_rcp_f32 v14, v14
    v_rcp_f32 v12, v12
    v_pk_mul_f32 v[112:113], v[112:113], v[14:15] op_sel_hi:[1,0]
    v_pk_mul_f32 v[114:115], v[114:115], v[14:15] op_sel_hi:[1,0]
    v_pk_mul_f32 v[116:117], v[116:117], v[14:15] op_sel_hi:[1,0]
    v_pk_mul_f32 v[118:119], v[118:119], v[14:15] op_sel_hi:[1,0]
    v_pk_mul_f32 v[120:121], v[120:121], v[14:15] op_sel_hi:[1,0]
    v_pk_mul_f32 v[122:123], v[122:123], v[14:15] op_sel_hi:[1,0]
    v_pk_mul_f32 v[124:125], v[124:125], v[14:15] op_sel_hi:[1,0]
    v_pk_mul_f32 v[126:127], v[126:127], v[14:15] op_sel_hi:[1,0]
    v_pk_mul_f32 v[128:129], v[128:129], v[12:13] op_sel_hi:[1,0]
    v_pk_mul_f32 v[130:131], v[130:131], v[12:13] op_sel_hi:[1,0]
    v_pk_mul_f32 v[132:133], v[132:133], v[12:13] op_sel_hi:[1,0]
    v_pk_mul_f32 v[134:135], v[134:135], v[12:13] op_sel_hi:[1,0]
    v_pk_mul_f32 v[136:137], v[136:137], v[12:13] op_sel_hi:[1,0]
    v_pk_mul_f32 v[138:139], v[138:139], v[12:13] op_sel_hi:[1,0]
    v_pk_mul_f32 v[140:141], v[140:141], v[12:13] op_sel_hi:[1,0]
    v_pk_mul_f32 v[142:143], v[142:143], v[12:13] op_sel_hi:[1,0]
    v_cvt_pk_bf16_f32 v128, v128, v129
    v_cvt_pk_bf16_f32 v129, v130, v131
    v_cvt_pk_bf16_f32 v130, v132, v133
    v_cvt_pk_bf16_f32 v131, v134, v135
    v_cvt_pk_bf16_f32 v132, v136, v137
    v_cvt_pk_bf16_f32 v133, v138, v139
    v_cvt_pk_bf16_f32 v134, v140, v141
    v_cvt_pk_bf16_f32 v135, v142, v143
    v_cvt_pk_bf16_f32 v136, v112, v113
    v_cvt_pk_bf16_f32 v137, v114, v115
    v_cvt_pk_bf16_f32 v138, v116, v117
    v_cvt_pk_bf16_f32 v139, v118, v119
    v_cvt_pk_bf16_f32 v140, v120, v121
    v_cvt_pk_bf16_f32 v141, v122, v123
    v_cvt_pk_bf16_f32 v142, v124, v125
    v_cvt_pk_bf16_f32 v143, v126, v127
    ds_write_b64 v48, v[128:129] offset:8192
    ds_write_b64 v49, v[130:131] offset:8192
    ds_write_b64 v50, v[132:133] offset:8192
    ds_write_b64 v51, v[134:135] offset:8192
    ds_write_b64 v48, v[136:137] offset:16384
    ds_write_b64 v49, v[138:139] offset:16384
    ds_write_b64 v50, v[140:141] offset:16384
    ds_write_b64 v51, v[142:143] offset:16384
    v_mov_b32 v12, 0x7f800000
    v_mov_b32 v13, 0xff800000
    v_max3_f32 v96, v160, v161, v162
    v_min3_f32 v98, v160, v161, v162
    v_cndmask_b32 v172, v172, v160, s[96:97]
    v_cndmask_b32 v173, v173, v160, s[96:97]
    v_cndmask_b32 v174, v174, v160, s[96:97]
    v_cndmask_b32 v175, v175, v160, s[96:97]
    v_max3_f32 v96, v96, v163, v164
    v_min3_f32 v98, v98, v163, v164
    v_max3_f32 v96, v96, v165, v166
    v_min3_f32 v98, v98, v165, v166
    v_max3_f32 v96, v96, v167, v168
    v_min3_f32 v98, v98, v167, v168
    v_max3_f32 v96, v96, v169, v170
    v_min3_f32 v98, v98, v169, v170
    v_max3_f32 v96, v96, v171, v172
    v_min3_f32 v98, v98, v171, v172
    v_max3_f32 v96, v96, v173, v174
    v_min3_f32 v98, v98, v173, v174
    v_max_f32 v96, v96, v175
    v_min_f32 v98, v98, v175
    v_mov_b32 v97, v96
    v_mov_b32 v99, v98
    s_nop 0
    v_permlane32_swap_b32 v96, v97
    v_permlane32_swap_b32 v98, v99
    v_max_f32 v96, v96, v97
    v_min_f32 v98, v98, v99
    v_mul_f32 v96, s91, v96
    v_mul_f32 v98, s91, v98
    v_cndmask_b32 v100, v96, v12, s[96:97]
    v_cndmask_b32 v102, v98, v13, s[96:97]
    v_pk_fma_f32 v[112:113], v[160:161], s[50:51], v[98:99] op_sel_hi:[1,1,0] neg_lo:[1,0,0] neg_hi:[1,0,0]
    v_pk_fma_f32 v[160:161], v[160:161], s[50:51], v[96:97] op_sel_hi:[1,1,0] neg_lo:[0,0,1] neg_hi:[0,0,1]
    v_exp_f32 v112, v112
    v_pk_fma_f32 v[114:115], v[162:163], s[50:51], v[98:99] op_sel_hi:[1,1,0] neg_lo:[1,0,0] neg_hi:[1,0,0]
    v_exp_f32 v160, v160
    v_pk_fma_f32 v[162:163], v[162:163], s[50:51], v[96:97] op_sel_hi:[1,1,0] neg_lo:[0,0,1] neg_hi:[0,0,1]
    v_exp_f32 v113, v113
    v_exp_f32 v161, v161
    v_exp_f32 v114, v114
    v_pk_fma_f32 v[116:117], v[164:165], s[50:51], v[98:99] op_sel_hi:[1,1,0] neg_lo:[1,0,0] neg_hi:[1,0,0]
    v_exp_f32 v162, v162
    v_pk_fma_f32 v[164:165], v[164:165], s[50:51], v[96:97] op_sel_hi:[1,1,0] neg_lo:[0,0,1] neg_hi:[0,0,1]
    v_exp_f32 v115, v115
    v_exp_f32 v163, v163
    v_exp_f32 v116, v116
    v_pk_fma_f32 v[118:119], v[166:167], s[50:51], v[98:99] op_sel_hi:[1,1,0] neg_lo:[1,0,0] neg_hi:[1,0,0]
    v_exp_f32 v164, v164
    v_pk_fma_f32 v[166:167], v[166:167], s[50:51], v[96:97] op_sel_hi:[1,1,0] neg_lo:[0,0,1] neg_hi:[0,0,1]
    v_exp_f32 v117, v117
    v_pk_add_f32 v[14:15], v[112:113], v[114:115]
    v_exp_f32 v165, v165
    v_pk_add_f32 v[12:13], v[160:161], v[162:163]
    v_exp_f32 v118, v118
    v_pk_fma_f32 v[120:121], v[168:169], s[50:51], v[98:99] op_sel_hi:[1,1,0] neg_lo:[1,0,0] neg_hi:[1,0,0]
    v_exp_f32 v166, v166
    v_pk_fma_f32 v[168:169], v[168:169], s[50:51], v[96:97] op_sel_hi:[1,1,0] neg_lo:[0,0,1] neg_hi:[0,0,1]
    v_exp_f32 v119, v119
    v_pk_add_f32 v[14:15], v[14:15], v[116:117]
    v_exp_f32 v167, v167
    v_pk_add_f32 v[12:13], v[12:13], v[164:165]
    v_exp_f32 v120, v120
    v_pk_fma_f32 v[122:123], v[170:171], s[50:51], v[98:99] op_sel_hi:[1,1,0] neg_lo:[1,0,0] neg_hi:[1,0,0]
    v_exp_f32 v168, v168
    v_pk_fma_f32 v[170:171], v[170:171], s[50:51], v[96:97] op_sel_hi:[1,1,0] neg_lo:[0,0,1] neg_hi:[0,0,1]
    v_exp_f32 v121, v121
    v_pk_add_f32 v[14:15], v[14:15], v[118:119]
    v_exp_f32 v169, v169
    v_pk_add_f32 v[12:13], v[12:13], v[166:167]
    v_exp_f32 v122, v122
    v_pk_fma_f32 v[124:125], v[172:173], s[50:51], v[102:103] op_sel_hi:[1,1,0] neg_lo:[1,0,0] neg_hi:[1,0,0]
    v_exp_f32 v170, v170
    v_pk_fma_f32 v[172:173], v[172:173], s[50:51], v[100:101] op_sel_hi:[1,1,0] neg_lo:[0,0,1] neg_hi:[0,0,1]
    v_exp_f32 v123, v123
    v_pk_add_f32 v[14:15], v[14:15], v[120:121]
    v_exp_f32 v171, v171
    v_pk_add_f32 v[12:13], v[12:13], v[168:169]
    v_exp_f32 v124, v124
    v_pk_fma_f32 v[126:127], v[174:175], s[50:51], v[102:103] op_sel_hi:[1,1,0] neg_lo:[1,0,0] neg_hi:[1,0,0]
    v_exp_f32 v172, v172
    v_pk_fma_f32 v[174:175], v[174:175], s[50:51], v[100:101] op_sel_hi:[1,1,0] neg_lo:[0,0,1] neg_hi:[0,0,1]
    v_exp_f32 v125, v125
    v_pk_add_f32 v[14:15], v[14:15], v[122:123]
    v_exp_f32 v173, v173
    v_pk_add_f32 v[12:13], v[12:13], v[170:171]
    v_exp_f32 v126, v126
    v_exp_f32 v174, v174
    v_exp_f32 v127, v127
    v_pk_add_f32 v[14:15], v[14:15], v[124:125]
    v_exp_f32 v175, v175
    v_pk_add_f32 v[12:13], v[12:13], v[172:173]
    v_pk_add_f32 v[14:15], v[14:15], v[126:127]
    v_pk_add_f32 v[12:13], v[12:13], v[174:175]
    v_add_f32 v14, v14, v15
    v_add_f32 v12, v12, v13
    v_mov_b32 v15, v14
    v_mov_b32 v13, v12
    s_nop 0
    v_permlane32_swap_b32 v14, v15
    v_permlane32_swap_b32 v12, v13
    v_add_f32 v14, v14, v15
    v_add_f32 v12, v12, v13
    v_rcp_f32 v14, v14
    v_rcp_f32 v12, v12
    v_pk_mul_f32 v[112:113], v[112:113], v[14:15] op_sel_hi:[1,0]
    v_pk_mul_f32 v[114:115], v[114:115], v[14:15] op_sel_hi:[1,0]
    v_pk_mul_f32 v[116:117], v[116:117], v[14:15] op_sel_hi:[1,0]
    v_pk_mul_f32 v[118:119], v[118:119], v[14:15] op_sel_hi:[1,0]
    v_pk_mul_f32 v[120:121], v[120:121], v[14:15] op_sel_hi:[1,0]
    v_pk_mul_f32 v[122:123], v[122:123], v[14:15] op_sel_hi:[1,0]
    v_pk_mul_f32 v[124:125], v[124:125], v[14:15] op_sel_hi:[1,0]
    v_pk_mul_f32 v[126:127], v[126:127], v[14:15] op_sel_hi:[1,0]
    v_pk_mul_f32 v[160:161], v[160:161], v[12:13] op_sel_hi:[1,0]
    v_pk_mul_f32 v[162:163], v[162:163], v[12:13] op_sel_hi:[1,0]
    v_pk_mul_f32 v[164:165], v[164:165], v[12:13] op_sel_hi:[1,0]
    v_pk_mul_f32 v[166:167], v[166:167], v[12:13] op_sel_hi:[1,0]
    v_pk_mul_f32 v[168:169], v[168:169], v[12:13] op_sel_hi:[1,0]
    v_pk_mul_f32 v[170:171], v[170:171], v[12:13] op_sel_hi:[1,0]
    v_pk_mul_f32 v[172:173], v[172:173], v[12:13] op_sel_hi:[1,0]
    v_pk_mul_f32 v[174:175], v[174:175], v[12:13] op_sel_hi:[1,0]
    v_cvt_pk_bf16_f32 v160, v160, v161
    v_cvt_pk_bf16_f32 v161, v162, v163
    v_cvt_pk_bf16_f32 v162, v164, v165
    v_cvt_pk_bf16_f32 v163, v166, v167
    v_cvt_pk_bf16_f32 v164, v168, v169
    v_cvt_pk_bf16_f32 v165, v170, v171
    v_cvt_pk_bf16_f32 v166, v172, v173
    v_cvt_pk_bf16_f32 v167, v174, v175
    v_cvt_pk_bf16_f32 v168, v112, v113
    v_cvt_pk_bf16_f32 v169, v114, v115
    v_cvt_pk_bf16_f32 v170, v116, v117
    v_cvt_pk_bf16_f32 v171, v118, v119
    v_cvt_pk_bf16_f32 v172, v120, v121
    v_cvt_pk_bf16_f32 v173, v122, v123
    v_cvt_pk_bf16_f32 v174, v124, v125
    v_cvt_pk_bf16_f32 v175, v126, v127
    ds_write_b64 v48, v[160:161] offset:10240
    ds_write_b64 v49, v[162:163] offset:10240
    ds_write_b64 v50, v[164:165] offset:10240
    ds_write_b64 v51, v[166:167] offset:10240
    ds_write_b64 v48, v[168:169] offset:18432
    ds_write_b64 v49, v[170:171] offset:18432
    ds_write_b64 v50, v[172:173] offset:18432
    ds_write_b64 v51, v[174:175] offset:18432
    s_waitcnt lgkmcnt(0)
    s_barrier
    ds_read_b64_tr_b16 v[144:145], v54 offset:0
    ds_read_b64_tr_b16 v[146:147], v55 offset:0
    ds_read_b64_tr_b16 v[148:149], v52 offset:0
    ds_read_b64_tr_b16 v[150:151], v53 offset:0
    ds_read_b64_tr_b16 v[152:153], v54 offset:1024
    ds_read_b64_tr_b16 v[154:155], v55 offset:1024
    ds_read_b64_tr_b16 v[156:157], v52 offset:1024
    ds_read_b64_tr_b16 v[158:159], v53 offset:1024
    ds_read_b64_tr_b16 v[160:161], v54 offset:2048
    ds_read_b64_tr_b16 v[162:163], v55 offset:2048
    ds_read_b64_tr_b16 v[164:165], v52 offset:2048
    ds_read_b64_tr_b16 v[166:167], v53 offset:2048
    s_waitcnt lgkmcnt(8)
    v_mfma_f32_32x32x16_bf16 v[128:143], v[144:147], v[148:151], 0
    ds_read_b64_tr_b16 v[168:169], v54 offset:3072
    ds_read_b64_tr_b16 v[170:171], v55 offset:3072
    ds_read_b64_tr_b16 v[172:173], v52 offset:3072
    ds_read_b64_tr_b16 v[174:175], v53 offset:3072
    s_waitcnt lgkmcnt(8)
    v_mfma_f32_32x32x16_bf16 v[128:143], v[152:155], v[156:159], v[128:143]
    ds_read_b64_tr_b16 v[144:145], v54 offset:4096
    ds_read_b64_tr_b16 v[146:147], v55 offset:4096
    ds_read_b64_tr_b16 v[148:149], v52 offset:4096
    ds_read_b64_tr_b16 v[150:151], v53 offset:4096
    s_waitcnt lgkmcnt(8)
    v_mfma_f32_32x32x16_bf16 v[128:143], v[160:163], v[164:167], v[128:143]
    ds_read_b64_tr_b16 v[152:153], v54 offset:5120
    ds_read_b64_tr_b16 v[154:155], v55 offset:5120
    ds_read_b64_tr_b16 v[156:157], v52 offset:5120
    ds_read_b64_tr_b16 v[158:159], v53 offset:5120
    s_waitcnt lgkmcnt(8)
    v_mfma_f32_32x32x16_bf16 v[128:143], v[168:171], v[172:175], v[128:143]
    ds_read_b64_tr_b16 v[160:161], v54 offset:6144
    ds_read_b64_tr_b16 v[162:163], v55 offset:6144
    ds_read_b64_tr_b16 v[164:165], v52 offset:6144
    ds_read_b64_tr_b16 v[166:167], v53 offset:6144
    s_waitcnt lgkmcnt(8)
    v_mfma_f32_32x32x16_bf16 v[128:143], v[144:147], v[148:151], v[128:143]
    ds_read_b64_tr_b16 v[168:169], v54 offset:7168
    ds_read_b64_tr_b16 v[170:171], v55 offset:7168
    ds_read_b64_tr_b16 v[172:173], v52 offset:7168
    ds_read_b64_tr_b16 v[174:175], v53 offset:7168
    s_waitcnt lgkmcnt(8)
    v_mfma_f32_32x32x16_bf16 v[128:143], v[152:155], v[156:159], v[128:143]
    s_waitcnt lgkmcnt(4)
    v_mfma_f32_32x32x16_bf16 v[128:143], v[160:163], v[164:167], v[128:143]
    s_waitcnt lgkmcnt(0)
    v_mfma_f32_32x32x16_bf16 v[128:143], v[168:171], v[172:175], v[128:143]
    s_and_b32 s87, s78, 0xff
    s_lshl_b32 s87, s87, 2
    s_add_u32 s87, s87, s72
    s_lshl_b32 s88, s87, 16
    s_lshl_b32 s89, s76, 10
    s_add_u32 s88, s88, s89
    s_add_u32 s49, s88, 10485760
    v_and_b32 v14, 3, v0
    v_lshlrev_b32 v14, 3, v14
    v_lshrrev_b32 v14, v14, v22
    v_and_b32 v14, 0xff, v14
    s_movk_i32 s87, 0xff
    v_bfi_b32 v128, s87, v14, v128
    v_bfi_b32 v132, s87, v14, v132
    v_bfi_b32 v136, s87, v14, v136
    v_bfi_b32 v140, s87, v14, v140
    buffer_store_dwordx4 v[128:131], v1, s[28:31], s49 offen sc1
    s_add_u32 s49, s49, 16384
    buffer_store_dwordx4 v[132:135], v1, s[28:31], s49 offen sc1
    s_add_u32 s49, s49, 16384
    buffer_store_dwordx4 v[136:139], v1, s[28:31], s49 offen sc1
    s_add_u32 s49, s49, 16384
    buffer_store_dwordx4 v[140:143], v1, s[28:31], s49 offen sc1
    s_barrier
    ds_read_b64_tr_b16 v[64:65], v8 offset:0
    ds_read_b64_tr_b16 v[66:67], v8 offset:512
    ds_read_b64_tr_b16 v[68:69], v8 offset:8192
    ds_read_b64_tr_b16 v[70:71], v8 offset:8704
    ds_read_b64_tr_b16 v[72:73], v8 offset:2048
    ds_read_b64_tr_b16 v[74:75], v8 offset:2560
    ds_read_b64_tr_b16 v[76:77], v8 offset:10240
    ds_read_b64_tr_b16 v[78:79], v8 offset:10752
    s_waitcnt lgkmcnt(4)
    v_mfma_f32_32x32x16_bf16 v[128:143], v[64:67], a[0:3], 0
    ds_read_b64_tr_b16 v[80:81], v8 offset:4096
    s_add_u32 m0, s73, 98304
    s_nop 0
    buffer_load_dwordx4 v4, s[32:35], s81 offen lds
    v_mfma_f32_32x32x16_bf16 v[144:159], v[68:71], a[0:3], 0
    ds_read_b64_tr_b16 v[82:83], v8 offset:4608
    buffer_load_dwordx4 v5, s[32:35], s81 offen offset:1024 lds
    v_mfma_f32_32x32x16_bf16 v[160:175], v[64:67], a[112:115], 0
    ds_read_b64_tr_b16 v[84:85], v8 offset:12288
    s_add_u32 m0, s73, 106496
    s_nop 0
    buffer_load_dwordx4 v4, s[36:39], s81 offen lds
    s_bfe_u32 s87, s78, 0x80008
    s_lshl_b32 s87, s87, 12
    s_add_u32 s48, s87, s58
    buffer_store_dwordx4 v[36:39], v1, s[28:31], s48 offen offset:0 sc1
    v_mfma_f32_32x32x16_bf16 v[176:191], v[68:71], a[112:115], 0
    ds_read_b64_tr_b16 v[86:87], v8 offset:12800
    buffer_load_dwordx4 v5, s[36:39], s81 offen offset:1024 lds
    s_add_u32 s81, s81, s82
    s_cmp_eq_u32 s81, s83
    s_cselect_b32 s81, 0, s81
    s_waitcnt lgkmcnt(4)
    v_mfma_f32_32x32x16_bf16 v[128:143], v[72:75], a[4:7], v[128:143]
    ds_read_b64_tr_b16 v[88:89], v8 offset:6144
    s_lshl_b32 s87, s86, 7
    s_add_u32 s32, s18, s87
    s_addc_u32 s33, s19, 0
    s_sub_u32 s34, 1605632, s87
    buffer_store_dwordx4 v[36:39], v1, s[28:31], s48 offen offset:1024 sc1
    v_mfma_f32_32x32x16_bf16 v[144:159], v[76:79], a[4:7], v[144:159]
    ds_read_b64_tr_b16 v[90:91], v8 offset:6656
    s_add_u32 s36, s32, 57344
    s_addc_u32 s37, s33, 0
    s_sub_u32 s38, s34, 57344
    s_mov_b32 s82, 114688
    v_mfma_f32_32x32x16_bf16 v[160:175], v[72:75], a[116:119], v[160:175]
    ds_read_b64_tr_b16 v[92:93], v8 offset:14336
    s_movk_i32 s87, 896
    v_mad_u32_u24 v4, v2, s87, v3
    v_add_u32 v5, 6144, v4
    v_mfma_f32_32x32x16_bf16 v[176:191], v[76:79], a[116:119], v[176:191]
    ds_read_b64_tr_b16 v[94:95], v8 offset:14848
    s_add_u32 s48, s48, 114688
    buffer_store_dwordx4 v[36:39], v1, s[28:31], s48 offen offset:0 sc1
    s_waitcnt lgkmcnt(4)
    v_mfma_f32_32x32x16_bf16 v[128:143], v[80:83], a[8:11], v[128:143]
    s_waitcnt lgkmcnt(0)
    s_waitcnt vmcnt(23)
    s_barrier
    ds_read_b64_tr_b16 v[64:65], v8 offset:16384
    v_mfma_f32_32x32x16_bf16 v[144:159], v[84:87], a[8:11], v[144:159]
    ds_read_b64_tr_b16 v[66:67], v8 offset:16896
    s_bfe_u32 s81, s52, 0x40000
    s_mul_i32 s81, s81, s82
    s_add_u32 m0, s73, 0
    s_nop 0
    buffer_load_dwordx4 v4, s[32:35], s81 offen lds
    v_mfma_f32_32x32x16_bf16 v[160:175], v[80:83], a[120:123], v[160:175]
    ds_read_b64_tr_b16 v[68:69], v8 offset:24576
    buffer_store_dwordx4 v[36:39], v1, s[28:31], s48 offen offset:1024 sc1
    v_mfma_f32_32x32x16_bf16 v[176:191], v[84:87], a[120:123], v[176:191]
    ds_read_b64_tr_b16 v[70:71], v8 offset:25088
    v_mfma_f32_32x32x16_bf16 v[128:143], v[88:91], a[12:15], v[128:143]
    ds_read_b64_tr_b16 v[72:73], v8 offset:18432
    buffer_load_dwordx4 v5, s[32:35], s81 offen offset:1024 lds
    v_mfma_f32_32x32x16_bf16 v[144:159], v[92:95], a[12:15], v[144:159]
    ds_read_b64_tr_b16 v[74:75], v8 offset:18944
    s_lshl_b32 s87, s93, 2
    s_add_u32 s87, s87, s72
    s_mul_i32 s87, s87, 3
    s_add_u32 s87, s87, 0
    s_min_u32 s87, s87, 127
    s_lshl_b32 s88, s76, 7
    s_add_u32 s87, s87, s88
    s_lshl_b32 s87, s87, 10
    s_add_u32 s87, s87, 8388608
    buffer_store_dwordx4 v[36:39], v1, s[28:31], s87 offen sc1
    v_mfma_f32_32x32x16_bf16 v[160:175], v[88:91], a[124:127], v[160:175]
    ds_read_b64_tr_b16 v[76:77], v8 offset:26624
    v_mfma_f32_32x32x16_bf16 v[176:191], v[92:95], a[124:127], v[176:191]
    ds_read_b64_tr_b16 v[78:79], v8 offset:27136
    s_waitcnt lgkmcnt(4)
    v_mfma_f32_32x32x16_bf16 v[128:143], v[64:67], a[16:19], v[128:143]
    ds_read_b64_tr_b16 v[80:81], v8 offset:20480
    s_add_u32 m0, s73, 8192
    s_nop 0
    buffer_load_dwordx4 v4, s[36:39], s81 offen lds
    s_lshl_b32 s87, s93, 2
    s_add_u32 s87, s87, s72
    s_mul_i32 s87, s87, 3
    s_add_u32 s87, s87, 1
    s_min_u32 s87, s87, 127
    s_lshl_b32 s88, s76, 7
    s_add_u32 s87, s87, s88
    s_lshl_b32 s87, s87, 10
    s_add_u32 s87, s87, 8388608
    buffer_store_dwordx4 v[36:39], v1, s[28:31], s87 offen sc1
    v_mfma_f32_32x32x16_bf16 v[144:159], v[68:71], a[16:19], v[144:159]
    ds_read_b64_tr_b16 v[82:83], v8 offset:20992
    v_mfma_f32_32x32x16_bf16 v[160:175], v[64:67], a[128:131], v[160:175]
    ds_read_b64_tr_b16 v[84:85], v8 offset:28672
    v_mfma_f32_32x32x16_bf16 v[176:191], v[68:71], a[128:131], v[176:191]
    ds_read_b64_tr_b16 v[86:87], v8 offset:29184
    s_lshl_b32 s87, s93, 2
    s_add_u32 s87, s87, s72
    s_mul_i32 s87, s87, 3
    s_add_u32 s87, s87, 2
    s_min_u32 s87, s87, 127
    s_lshl_b32 s88, s76, 7
    s_add_u32 s87, s87, s88
    s_lshl_b32 s87, s87, 10
    s_add_u32 s87, s87, 8388608
    buffer_store_dwordx4 v[36:39], v1, s[28:31], s87 offen sc1
    s_waitcnt lgkmcnt(4)
    v_mfma_f32_32x32x16_bf16 v[128:143], v[72:75], a[20:23], v[128:143]
    ds_read_b64_tr_b16 v[88:89], v8 offset:22528
    buffer_load_dwordx4 v5, s[36:39], s81 offen offset:1024 lds
    v_mfma_f32_32x32x16_bf16 v[144:159], v[76:79], a[20:23], v[144:159]
    ds_read_b64_tr_b16 v[90:91], v8 offset:23040
    v_mfma_f32_32x32x16_bf16 v[160:175], v[72:75], a[132:135], v[160:175]
    ds_read_b64_tr_b16 v[92:93], v8 offset:30720
    v_mfma_f32_32x32x16_bf16 v[176:191], v[76:79], a[132:135], v[176:191]
    ds_read_b64_tr_b16 v[94:95], v8 offset:31232
    s_waitcnt lgkmcnt(4)
    v_mfma_f32_32x32x16_bf16 v[128:143], v[80:83], a[24:27], v[128:143]
    s_waitcnt lgkmcnt(0)
    s_waitcnt vmcnt(27)
    s_barrier
    ds_read_b64_tr_b16 v[64:65], v8 offset:32768
    v_mfma_f32_32x32x16_bf16 v[144:159], v[84:87], a[24:27], v[144:159]
    ds_read_b64_tr_b16 v[66:67], v8 offset:33280
    s_bfe_u32 s81, s52, 0x40004
    s_mul_i32 s81, s81, s82
    s_add_u32 m0, s73, 16384
    s_nop 0
    buffer_load_dwordx4 v4, s[32:35], s81 offen lds
    v_mfma_f32_32x32x16_bf16 v[160:175], v[80:83], a[136:139], v[160:175]
    ds_read_b64_tr_b16 v[68:69], v8 offset:40960
    v_mfma_f32_32x32x16_bf16 v[176:191], v[84:87], a[136:139], v[176:191]
    ds_read_b64_tr_b16 v[70:71], v8 offset:41472
    v_mfma_f32_32x32x16_bf16 v[128:143], v[88:91], a[28:31], v[128:143]
    ds_read_b64_tr_b16 v[72:73], v8 offset:34816
    buffer_load_dwordx4 v5, s[32:35], s81 offen offset:1024 lds
    v_mfma_f32_32x32x16_bf16 v[144:159], v[92:95], a[28:31], v[144:159]
    ds_read_b64_tr_b16 v[74:75], v8 offset:35328
    v_mfma_f32_32x32x16_bf16 v[160:175], v[88:91], a[140:143], v[160:175]
    ds_read_b64_tr_b16 v[76:77], v8 offset:43008
    v_mfma_f32_32x32x16_bf16 v[176:191], v[92:95], a[140:143], v[176:191]
    ds_read_b64_tr_b16 v[78:79], v8 offset:43520
    s_waitcnt lgkmcnt(4)
    v_mfma_f32_32x32x16_bf16 v[128:143], v[64:67], a[32:35], v[128:143]
    ds_read_b64_tr_b16 v[80:81], v8 offset:36864
    s_add_u32 m0, s73, 24576
    s_nop 0
    buffer_load_dwordx4 v4, s[36:39], s81 offen lds
    v_mfma_f32_32x32x16_bf16 v[144:159], v[68:71], a[32:35], v[144:159]
    ds_read_b64_tr_b16 v[82:83], v8 offset:37376
    v_mfma_f32_32x32x16_bf16 v[160:175], v[64:67], a[144:147], v[160:175]
    ds_read_b64_tr_b16 v[84:85], v8 offset:45056
    v_mfma_f32_32x32x16_bf16 v[176:191], v[68:71], a[144:147], v[176:191]
    ds_read_b64_tr_b16 v[86:87], v8 offset:45568
    s_waitcnt lgkmcnt(4)
    v_mfma_f32_32x32x16_bf16 v[128:143], v[72:75], a[36:39], v[128:143]
    ds_read_b64_tr_b16 v[88:89], v8 offset:38912
    buffer_load_dwordx4 v5, s[36:39], s81 offen offset:1024 lds
    v_mfma_f32_32x32x16_bf16 v[144:159], v[76:79], a[36:39], v[144:159]
    ds_read_b64_tr_b16 v[90:91], v8 offset:39424
    v_mfma_f32_32x32x16_bf16 v[160:175], v[72:75], a[148:151], v[160:175]
    ds_read_b64_tr_b16 v[92:93], v8 offset:47104
    v_mfma_f32_32x32x16_bf16 v[176:191], v[76:79], a[148:151], v[176:191]
    ds_read_b64_tr_b16 v[94:95], v8 offset:47616
    s_waitcnt lgkmcnt(4)
    v_mfma_f32_32x32x16_bf16 v[128:143], v[80:83], a[40:43], v[128:143]
    s_waitcnt lgkmcnt(0)
    s_waitcnt vmcnt(5)
    s_barrier
    s_cmp_lg_u32 s63, 1
    s_cbranch_scc1 Lwf_3
    v_mov_b32 v15, s79
    s_mov_b64 exec, 0xff
    buffer_store_dword v15, v19, s[28:31], s59 offen sc1
    s_mov_b64 exec, -1
Lwf_3:
    ds_read_b64_tr_b16 v[64:65], v8 offset:49152
    v_mfma_f32_32x32x16_bf16 v[144:159], v[84:87], a[40:43], v[144:159]
    ds_read_b64_tr_b16 v[66:67], v8 offset:49664
    s_bfe_u32 s81, s52, 0x40008
    s_mul_i32 s81, s81, s82
    s_add_u32 m0, s73, 32768
    s_nop 0
    buffer_load_dwordx4 v4, s[32:35], s81 offen lds
    v_mfma_f32_32x32x16_bf16 v[160:175], v[80:83], a[152:155], v[160:175]
    ds_read_b64_tr_b16 v[68:69], v8 offset:57344
    v_mfma_f32_32x32x16_bf16 v[176:191], v[84:87], a[152:155], v[176:191]
    ds_read_b64_tr_b16 v[70:71], v8 offset:57856
    v_mfma_f32_32x32x16_bf16 v[128:143], v[88:91], a[44:47], v[128:143]
    ds_read_b64_tr_b16 v[72:73], v8 offset:51200
    buffer_load_dwordx4 v5, s[32:35], s81 offen offset:1024 lds
    v_mfma_f32_32x32x16_bf16 v[144:159], v[92:95], a[44:47], v[144:159]
    ds_read_b64_tr_b16 v[74:75], v8 offset:51712
    v_mfma_f32_32x32x16_bf16 v[160:175], v[88:91], a[156:159], v[160:175]
    ds_read_b64_tr_b16 v[76:77], v8 offset:59392
    v_mfma_f32_32x32x16_bf16 v[176:191], v[92:95], a[156:159], v[176:191]
    ds_read_b64_tr_b16 v[78:79], v8 offset:59904
    s_waitcnt lgkmcnt(4)
    v_mfma_f32_32x32x16_bf16 v[128:143], v[64:67], a[48:51], v[128:143]
    ds_read_b64_tr_b16 v[80:81], v8 offset:53248
    s_add_u32 m0, s73, 40960
    s_nop 0
    buffer_load_dwordx4 v4, s[36:39], s81 offen lds
    v_mfma_f32_32x32x16_bf16 v[144:159], v[68:71], a[48:51], v[144:159]
    ds_read_b64_tr_b16 v[82:83], v8 offset:53760
    v_mfma_f32_32x32x16_bf16 v[160:175], v[64:67], a[160:163], v[160:175]
    ds_read_b64_tr_b16 v[84:85], v8 offset:61440
    v_mfma_f32_32x32x16_bf16 v[176:191], v[68:71], a[160:163], v[176:191]
    ds_read_b64_tr_b16 v[86:87], v8 offset:61952
    s_waitcnt lgkmcnt(4)
    v_mfma_f32_32x32x16_bf16 v[128:143], v[72:75], a[52:55], v[128:143]
    ds_read_b64_tr_b16 v[88:89], v8 offset:55296
    buffer_load_dwordx4 v5, s[36:39], s81 offen offset:1024 lds
    v_mfma_f32_32x32x16_bf16 v[144:159], v[76:79], a[52:55], v[144:159]
    ds_read_b64_tr_b16 v[90:91], v8 offset:55808
    v_mfma_f32_32x32x16_bf16 v[160:175], v[72:75], a[164:167], v[160:175]
    ds_read_b64_tr_b16 v[92:93], v8 offset:63488
    v_mfma_f32_32x32x16_bf16 v[176:191], v[76:79], a[164:167], v[176:191]
    ds_read_b64_tr_b16 v[94:95], v8 offset:64000
    s_waitcnt lgkmcnt(4)
    v_mfma_f32_32x32x16_bf16 v[128:143], v[80:83], a[56:59], v[128:143]
    s_waitcnt lgkmcnt(0)
    s_barrier
    ds_read_b64_tr_b16 v[64:65], v9 offset:0
    v_mfma_f32_32x32x16_bf16 v[144:159], v[84:87], a[56:59], v[144:159]
    ds_read_b64_tr_b16 v[66:67], v9 offset:512
    s_bfe_u32 s81, s53, 0x40000
    s_mul_i32 s81, s81, s82
    s_add_u32 m0, s73, 49152
    s_nop 0
    buffer_load_dwordx4 v4, s[32:35], s81 offen lds
    v_mfma_f32_32x32x16_bf16 v[160:175], v[80:83], a[168:171], v[160:175]
    ds_read_b64_tr_b16 v[68:69], v9 offset:8192
    v_mfma_f32_32x32x16_bf16 v[176:191], v[84:87], a[168:171], v[176:191]
    ds_read_b64_tr_b16 v[70:71], v9 offset:8704
    v_mfma_f32_32x32x16_bf16 v[128:143], v[88:91], a[60:63], v[128:143]
    ds_read_b64_tr_b16 v[72:73], v9 offset:2048
    buffer_load_dwordx4 v5, s[32:35], s81 offen offset:1024 lds
    v_mfma_f32_32x32x16_bf16 v[144:159], v[92:95], a[60:63], v[144:159]
    ds_read_b64_tr_b16 v[74:75], v9 offset:2560
    v_mfma_f32_32x32x16_bf16 v[160:175], v[88:91], a[172:175], v[160:175]
    ds_read_b64_tr_b16 v[76:77], v9 offset:10240
    v_mfma_f32_32x32x16_bf16 v[176:191], v[92:95], a[172:175], v[176:191]
    ds_read_b64_tr_b16 v[78:79], v9 offset:10752
    s_waitcnt lgkmcnt(4)
    v_mfma_f32_32x32x16_bf16 v[128:143], v[64:67], a[64:67], v[128:143]
    ds_read_b64_tr_b16 v[80:81], v9 offset:4096
    s_add_u32 m0, s73, 57344
    s_nop 0
    buffer_load_dwordx4 v4, s[36:39], s81 offen lds
    v_mfma_f32_32x32x16_bf16 v[144:159], v[68:71], a[64:67], v[144:159]
    ds_read_b64_tr_b16 v[82:83], v9 offset:4608
    v_mfma_f32_32x32x16_bf16 v[160:175], v[64:67], a[176:179], v[160:175]
    ds_read_b64_tr_b16 v[84:85], v9 offset:12288
    v_mfma_f32_32x32x16_bf16 v[176:191], v[68:71], a[176:179], v[176:191]
    ds_read_b64_tr_b16 v[86:87], v9 offset:12800
    s_waitcnt lgkmcnt(4)
    v_mfma_f32_32x32x16_bf16 v[128:143], v[72:75], a[68:71], v[128:143]
    ds_read_b64_tr_b16 v[88:89], v9 offset:6144
    buffer_load_dwordx4 v5, s[36:39], s81 offen offset:1024 lds
    v_mfma_f32_32x32x16_bf16 v[144:159], v[76:79], a[68:71], v[144:159]
    ds_read_b64_tr_b16 v[90:91], v9 offset:6656
    v_mfma_f32_32x32x16_bf16 v[160:175], v[72:75], a[180:183], v[160:175]
    ds_read_b64_tr_b16 v[92:93], v9 offset:14336
    v_mfma_f32_32x32x16_bf16 v[176:191], v[76:79], a[180:183], v[176:191]
    ds_read_b64_tr_b16 v[94:95], v9 offset:14848
    s_waitcnt lgkmcnt(4)
    v_mfma_f32_32x32x16_bf16 v[128:143], v[80:83], a[72:75], v[128:143]
    s_waitcnt lgkmcnt(0)
    s_barrier
    ds_read_b64_tr_b16 v[64:65], v9 offset:16384
    v_mfma_f32_32x32x16_bf16 v[144:159], v[84:87], a[72:75], v[144:159]
    ds_read_b64_tr_b16 v[66:67], v9 offset:16896
    s_bfe_u32 s81, s53, 0x40004
    s_mul_i32 s81, s81, s82
    s_add_u32 m0, s73, 65536
    s_nop 0
    buffer_load_dwordx4 v4, s[32:35], s81 offen lds
    v_mfma_f32_32x32x16_bf16 v[160:175], v[80:83], a[184:187], v[160:175]
    ds_read_b64_tr_b16 v[68:69], v9 offset:24576
    buffer_load_dwordx4 v5, s[32:35], s81 offen offset:1024 lds
    v_mfma_f32_32x32x16_bf16 v[176:191], v[84:87], a[184:187], v[176:191]
    ds_read_b64_tr_b16 v[70:71], v9 offset:25088
    v_mfma_f32_32x32x16_bf16 v[128:143], v[88:91], a[76:79], v[128:143]
    ds_read_b64_tr_b16 v[72:73], v9 offset:18432
    s_add_u32 m0, s73, 73728
    s_nop 0
    buffer_load_dwordx4 v4, s[36:39], s81 offen lds
    v_mfma_f32_32x32x16_bf16 v[144:159], v[92:95], a[76:79], v[144:159]
    ds_read_b64_tr_b16 v[74:75], v9 offset:18944
    v_mfma_f32_32x32x16_bf16 v[160:175], v[88:91], a[188:191], v[160:175]
    ds_read_b64_tr_b16 v[76:77], v9 offset:26624
    buffer_load_dwordx4 v5, s[36:39], s81 offen offset:1024 lds
    v_mfma_f32_32x32x16_bf16 v[176:191], v[92:95], a[188:191], v[176:191]
    ds_read_b64_tr_b16 v[78:79], v9 offset:27136
    s_waitcnt lgkmcnt(4)
    v_mfma_f32_32x32x16_bf16 v[128:143], v[64:67], a[80:83], v[128:143]
    ds_read_b64_tr_b16 v[80:81], v9 offset:20480
    s_bfe_u32 s81, s53, 0x40008
    s_mul_i32 s81, s81, s82
    s_add_u32 m0, s73, 114688
    s_nop 0
    buffer_load_dwordx4 v4, s[32:35], s81 offen lds
    v_mfma_f32_32x32x16_bf16 v[144:159], v[68:71], a[80:83], v[144:159]
    ds_read_b64_tr_b16 v[82:83], v9 offset:20992
    v_mfma_f32_32x32x16_bf16 v[160:175], v[64:67], a[192:195], v[160:175]
    ds_read_b64_tr_b16 v[84:85], v9 offset:28672
    buffer_load_dwordx4 v5, s[32:35], s81 offen offset:1024 lds
    v_mfma_f32_32x32x16_bf16 v[176:191], v[68:71], a[192:195], v[176:191]
    ds_read_b64_tr_b16 v[86:87], v9 offset:29184
    s_waitcnt lgkmcnt(4)
    v_mfma_f32_32x32x16_bf16 v[128:143], v[72:75], a[84:87], v[128:143]
    ds_read_b64_tr_b16 v[88:89], v9 offset:22528
    s_add_u32 m0, s73, 122880
    s_nop 0
    buffer_load_dwordx4 v4, s[36:39], s81 offen lds
    buffer_load_dword v18, v17, s[28:31], s60 offen sc1
    v_mfma_f32_32x32x16_bf16 v[144:159], v[76:79], a[84:87], v[144:159]
    ds_read_b64_tr_b16 v[90:91], v9 offset:23040
    v_mfma_f32_32x32x16_bf16 v[160:175], v[72:75], a[196:199], v[160:175]
    ds_read_b64_tr_b16 v[92:93], v9 offset:30720
    buffer_load_dwordx4 v5, s[36:39], s81 offen offset:1024 lds
    v_mfma_f32_32x32x16_bf16 v[176:191], v[76:79], a[196:199], v[176:191]
    ds_read_b64_tr_b16 v[94:95], v9 offset:31232
    s_waitcnt lgkmcnt(4)
    v_mfma_f32_32x32x16_bf16 v[128:143], v[80:83], a[88:91], v[128:143]
    s_waitcnt lgkmcnt(0)
    s_barrier
    ds_read_b64_tr_b16 v[64:65], v9 offset:32768
    v_mfma_f32_32x32x16_bf16 v[144:159], v[84:87], a[88:91], v[144:159]
    ds_read_b64_tr_b16 v[66:67], v9 offset:33280
    s_bfe_u32 s81, s53, 0x4000c
    s_mul_i32 s81, s81, s82
    s_add_u32 m0, s73, 81920
    s_nop 0
    buffer_load_dwordx4 v4, s[32:35], s81 offen lds
    v_mfma_f32_32x32x16_bf16 v[160:175], v[80:83], a[200:203], v[160:175]
    ds_read_b64_tr_b16 v[68:69], v9 offset:40960
    buffer_load_dwordx4 v5, s[32:35], s81 offen offset:1024 lds
    v_mfma_f32_32x32x16_bf16 v[176:191], v[84:87], a[200:203], v[176:191]
    ds_read_b64_tr_b16 v[70:71], v9 offset:41472
    v_mfma_f32_32x32x16_bf16 v[128:143], v[88:91], a[92:95], v[128:143]
    ds_read_b64_tr_b16 v[72:73], v9 offset:34816
    s_add_u32 m0, s73, 90112
    s_nop 0
    buffer_load_dwordx4 v4, s[36:39], s81 offen lds
    v_mfma_f32_32x32x16_bf16 v[144:159], v[92:95], a[92:95], v[144:159]
    ds_read_b64_tr_b16 v[74:75], v9 offset:35328
    v_mfma_f32_32x32x16_bf16 v[160:175], v[88:91], a[204:207], v[160:175]
    ds_read_b64_tr_b16 v[76:77], v9 offset:43008
    buffer_load_dwordx4 v5, s[36:39], s81 offen offset:1024 lds
    v_mfma_f32_32x32x16_bf16 v[176:191], v[92:95], a[204:207], v[176:191]
    ds_read_b64_tr_b16 v[78:79], v9 offset:43520
    s_waitcnt lgkmcnt(4)
    v_mfma_f32_32x32x16_bf16 v[128:143], v[64:67], a[96:99], v[128:143]
    ds_read_b64_tr_b16 v[80:81], v9 offset:36864
    s_bfe_u32 s81, s54, 0x40000
    s_mul_i32 s81, s81, s82
    s_add_u32 m0, s73, 131072
    s_nop 0
    buffer_load_dwordx4 v4, s[32:35], s81 offen lds
    v_mfma_f32_32x32x16_bf16 v[144:159], v[68:71], a[96:99], v[144:159]
    ds_read_b64_tr_b16 v[82:83], v9 offset:37376
    v_mfma_f32_32x32x16_bf16 v[160:175], v[64:67], a[208:211], v[160:175]
    ds_read_b64_tr_b16 v[84:85], v9 offset:45056
    buffer_load_dwordx4 v5, s[32:35], s81 offen offset:1024 lds
    v_mfma_f32_32x32x16_bf16 v[176:191], v[68:71], a[208:211], v[176:191]
    ds_read_b64_tr_b16 v[86:87], v9 offset:45568
    s_waitcnt lgkmcnt(4)
    v_mfma_f32_32x32x16_bf16 v[128:143], v[72:75], a[100:103], v[128:143]
    ds_read_b64_tr_b16 v[88:89], v9 offset:38912
    s_add_u32 m0, s73, 139264
    s_nop 0
    buffer_load_dwordx4 v4, s[36:39], s81 offen lds
    v_mfma_f32_32x32x16_bf16 v[144:159], v[76:79], a[100:103], v[144:159]
    ds_read_b64_tr_b16 v[90:91], v9 offset:39424
    v_mfma_f32_32x32x16_bf16 v[160:175], v[72:75], a[212:215], v[160:175]
    ds_read_b64_tr_b16 v[92:93], v9 offset:47104
    buffer_load_dwordx4 v5, s[36:39], s81 offen offset:1024 lds
    v_mfma_f32_32x32x16_bf16 v[176:191], v[76:79], a[212:215], v[176:191]
    ds_read_b64_tr_b16 v[94:95], v9 offset:47616
    s_waitcnt lgkmcnt(4)
    v_mfma_f32_32x32x16_bf16 v[128:143], v[80:83], a[104:107], v[128:143]
    v_mfma_f32_32x32x16_bf16 v[144:159], v[84:87], a[104:107], v[144:159]
    v_mfma_f32_32x32x16_bf16 v[160:175], v[80:83], a[216:219], v[160:175]
    v_mfma_f32_32x32x16_bf16 v[176:191], v[84:87], a[216:219], v[176:191]
    s_waitcnt lgkmcnt(0)
    v_mfma_f32_32x32x16_bf16 v[128:143], v[88:91], a[108:111], v[128:143]
    v_mfma_f32_32x32x16_bf16 v[144:159], v[92:95], a[108:111], v[144:159]
    v_mfma_f32_32x32x16_bf16 v[160:175], v[88:91], a[220:223], v[160:175]
    v_mfma_f32_32x32x16_bf16 v[176:191], v[92:95], a[220:223], v[176:191]
    s_lshr_b32 s78, s78, 8
    s_branch Lp2
Lq:
    s_add_u32 m0, s73, 98304
    s_nop 0
    buffer_load_dwordx4 v4, s[32:35], s81 offen lds
    buffer_load_dwordx4 v5, s[32:35], s81 offen offset:1024 lds
    s_add_u32 m0, s73, 106496
    s_nop 0
    buffer_load_dwordx4 v4, s[36:39], s81 offen lds
    buffer_load_dwordx4 v5, s[36:39], s81 offen offset:1024 lds
    s_add_u32 s81, s81, s82
    s_cmp_eq_u32 s81, s83
    s_cselect_b32 s81, 0, s81
    s_cmp_eq_u32 s75, 0
    s_cbranch_scc1 Lq_ni
    v_lshlrev_b32 v12, 1, v0
    v_add_u32 v12, 161792, v12
    s_lshl_b32 s87, s80, 7
    v_add_u32 v13, s87, v12
    ds_read_u16 v40, v13
    s_add_u32 s87, s87, 128
    s_cmp_eq_u32 s87, 896
    s_cselect_b32 s87, 0, s87
    v_add_u32 v13, s87, v12
    ds_read_u16 v41, v13
    s_add_u32 s87, s87, 128
    s_cmp_eq_u32 s87, 896
    s_cselect_b32 s87, 0, s87
    v_add_u32 v13, s87, v12
    ds_read_u16 v42, v13
    s_add_u32 s87, s87, 128
    s_cmp_eq_u32 s87, 896
    s_cselect_b32 s87, 0, s87
    v_add_u32 v13, s87, v12
    ds_read_u16 v43, v13
    s_add_u32 s87, s87, 128
    s_cmp_eq_u32 s87, 896
    s_cselect_b32 s87, 0, s87
    v_add_u32 v13, s87, v12
    ds_read_u16 v44, v13
    s_add_u32 s87, s87, 128
    s_cmp_eq_u32 s87, 896
    s_cselect_b32 s87, 0, s87
    v_add_u32 v13, s87, v12
    ds_read_u16 v45, v13
    s_add_u32 s87, s87, 128
    s_cmp_eq_u32 s87, 896
    s_cselect_b32 s87, 0, s87
    v_add_u32 v13, s87, v12
    ds_read_u16 v46, v13
    s_add_u32 s87, s87, 128
    s_cmp_eq_u32 s87, 896
    s_cselect_b32 s87, 0, s87
    v_bfe_u32 v32, v0, 1, 1
    v_lshlrev_b32 v32, 6, v32
    v_xor_b32 v32, 0x70, v32
    v_lshl_add_u32 v32, v0, 7, v32
    v_add_u32 v33, 0x10000, v32
Lq_ni:
    s_waitcnt vmcnt(4) lgkmcnt(0)
    s_barrier
    s_cmp_eq_u32 s75, 0
    s_cbranch_scc1 Lq_pass
    ds_write_b16 v32, v40 offset:0
    ds_write_b16 v32, v41 offset:16384
    ds_write_b16 v32, v42 offset:32768
    ds_write_b16 v32, v43 offset:49152
    ds_write_b16 v33, v44 offset:0
    ds_write_b16 v33, v45 offset:16384
Lq_pass:
    ds_read_b64_tr_b16 v[64:65], v8 offset:0
    ds_read_b64_tr_b16 v[66:67], v8 offset:512
    ds_read_b64_tr_b16 v[68:69], v8 offset:8192
    ds_read_b64_tr_b16 v[70:71], v8 offset:8704
    ds_read_b64_tr_b16 v[72:73], v8 offset:2048
    ds_read_b64_tr_b16 v[74:75], v8 offset:2560
    ds_read_b64_tr_b16 v[76:77], v8 offset:10240
    ds_read_b64_tr_b16 v[78:79], v8 offset:10752
    s_waitcnt lgkmcnt(4)
    v_mfma_f32_32x32x16_bf16 v[192:207], v[64:67], a[0:3], 0
    ds_read_b64_tr_b16 v[80:81], v8 offset:4096
    v_cvt_pk_bf16_f32 v104, v128, v129
    v_cvt_pk_bf16_f32 v105, v130, v131
    v_cvt_pk_bf16_f32 v106, v132, v133
    v_cvt_pk_bf16_f32 v107, v134, v135
    v_mfma_f32_32x32x16_bf16 v[208:223], v[68:71], a[0:3], 0
    ds_read_b64_tr_b16 v[82:83], v8 offset:4608
    v_cvt_pk_bf16_f32 v108, v136, v137
    v_cvt_pk_bf16_f32 v109, v138, v139
    v_cvt_pk_bf16_f32 v110, v140, v141
    v_cvt_pk_bf16_f32 v111, v142, v143
    v_mfma_f32_32x32x16_bf16 v[224:239], v[64:67], a[112:115], 0
    ds_read_b64_tr_b16 v[84:85], v8 offset:12288
    v_cndmask_b32 v110, v110, 0, s[96:97]
    v_cndmask_b32 v111, v111, 0, s[96:97]
    v_mfma_f32_32x32x16_bf16 v[128:143], v[112:115], v[104:107], 0
    s_nop 0
    v_mfma_f32_32x32x16_bf16 v[128:143], v[116:119], v[108:111], v[128:143]
    v_mfma_f32_32x32x16_bf16 v[240:255], v[68:71], a[112:115], 0
    ds_read_b64_tr_b16 v[86:87], v8 offset:12800
    v_cvt_pk_bf16_f32 v96, v144, v145
    v_cvt_pk_bf16_f32 v97, v146, v147
    v_cvt_pk_bf16_f32 v98, v148, v149
    v_cvt_pk_bf16_f32 v99, v150, v151
    s_waitcnt lgkmcnt(4)
    v_mfma_f32_32x32x16_bf16 v[192:207], v[72:75], a[4:7], v[192:207]
    ds_read_b64_tr_b16 v[88:89], v8 offset:6144
    v_cvt_pk_bf16_f32 v100, v152, v153
    v_cvt_pk_bf16_f32 v101, v154, v155
    v_cvt_pk_bf16_f32 v102, v156, v157
    v_cvt_pk_bf16_f32 v103, v158, v159
    v_mfma_f32_32x32x16_bf16 v[208:223], v[76:79], a[4:7], v[208:223]
    ds_read_b64_tr_b16 v[90:91], v8 offset:6656
    v_cndmask_b32 v102, v102, 0, s[96:97]
    v_cndmask_b32 v103, v103, 0, s[96:97]
    v_mfma_f32_32x32x16_bf16 v[144:159], v[120:123], v[96:99], 0
    s_nop 0
    v_mfma_f32_32x32x16_bf16 v[144:159], v[124:127], v[100:103], v[144:159]
    v_mfma_f32_32x32x16_bf16 v[224:239], v[72:75], a[116:119], v[224:239]
    ds_read_b64_tr_b16 v[92:93], v8 offset:14336
    v_cvt_pk_bf16_f32 v104, v160, v161
    v_cvt_pk_bf16_f32 v105, v162, v163
    v_cvt_pk_bf16_f32 v106, v164, v165
    v_cvt_pk_bf16_f32 v107, v166, v167
    v_mfma_f32_32x32x16_bf16 v[240:255], v[76:79], a[116:119], v[240:255]
    ds_read_b64_tr_b16 v[94:95], v8 offset:14848
    v_cvt_pk_bf16_f32 v108, v168, v169
    v_cvt_pk_bf16_f32 v109, v170, v171
    v_cvt_pk_bf16_f32 v110, v172, v173
    v_cvt_pk_bf16_f32 v111, v174, v175
    s_waitcnt lgkmcnt(4)
    v_mfma_f32_32x32x16_bf16 v[192:207], v[80:83], a[8:11], v[192:207]
    ds_read_b64_tr_b16 v[64:65], v8 offset:16384
    v_cndmask_b32 v110, v110, 0, s[96:97]
    v_cndmask_b32 v111, v111, 0, s[96:97]
    v_mfma_f32_32x32x16_bf16 v[160:175], v[112:115], v[104:107], 0
    s_nop 0
    v_mfma_f32_32x32x16_bf16 v[160:175], v[116:119], v[108:111], v[160:175]
    v_mfma_f32_32x32x16_bf16 v[208:223], v[84:87], a[8:11], v[208:223]
    ds_read_b64_tr_b16 v[66:67], v8 offset:16896
    v_cvt_pk_bf16_f32 v96, v176, v177
    v_cvt_pk_bf16_f32 v97, v178, v179
    v_cvt_pk_bf16_f32 v98, v180, v181
    v_cvt_pk_bf16_f32 v99, v182, v183
    v_mfma_f32_32x32x16_bf16 v[224:239], v[80:83], a[120:123], v[224:239]
    ds_read_b64_tr_b16 v[68:69], v8 offset:24576
    v_cvt_pk_bf16_f32 v100, v184, v185
    v_cvt_pk_bf16_f32 v101, v186, v187
    v_cvt_pk_bf16_f32 v102, v188, v189
    v_cvt_pk_bf16_f32 v103, v190, v191
    v_mfma_f32_32x32x16_bf16 v[240:255], v[84:87], a[120:123], v[240:255]
    ds_read_b64_tr_b16 v[70:71], v8 offset:25088
    v_cndmask_b32 v102, v102, 0, s[96:97]
    v_cndmask_b32 v103, v103, 0, s[96:97]
    v_mfma_f32_32x32x16_bf16 v[176:191], v[120:123], v[96:99], 0
    s_nop 0
    v_mfma_f32_32x32x16_bf16 v[176:191], v[124:127], v[100:103], v[176:191]
    s_waitcnt lgkmcnt(4)
    v_mfma_f32_32x32x16_bf16 v[192:207], v[88:91], a[12:15], v[192:207]
    ds_read_b64_tr_b16 v[72:73], v8 offset:18432
    v_mfma_f32_32x32x16_bf16 v[208:223], v[92:95], a[12:15], v[208:223]
    ds_read_b64_tr_b16 v[74:75], v8 offset:18944
    v_mov_b32 v12, 0x7f800000
    v_mov_b32 v13, 0xff800000
    v_max3_f32 v96, v128, v129, v130
    v_min3_f32 v98, v128, v129, v130
    v_cndmask_b32 v140, v140, v128, s[96:97]
    v_cndmask_b32 v141, v141, v128, s[96:97]
    v_mfma_f32_32x32x16_bf16 v[224:239], v[88:91], a[124:127], v[224:239]
    ds_read_b64_tr_b16 v[76:77], v8 offset:26624
    v_cndmask_b32 v142, v142, v128, s[96:97]
    v_cndmask_b32 v143, v143, v128, s[96:97]
    v_max3_f32 v96, v96, v131, v132
    v_min3_f32 v98, v98, v131, v132
    v_max3_f32 v96, v96, v133, v134
    v_mfma_f32_32x32x16_bf16 v[240:255], v[92:95], a[124:127], v[240:255]
    ds_read_b64_tr_b16 v[78:79], v8 offset:27136
    v_min3_f32 v98, v98, v133, v134
    v_max3_f32 v96, v96, v135, v136
    v_min3_f32 v98, v98, v135, v136
    v_max3_f32 v96, v96, v137, v138
    v_min3_f32 v98, v98, v137, v138
    s_waitcnt lgkmcnt(4)
    v_mfma_f32_32x32x16_bf16 v[192:207], v[64:67], a[16:19], v[192:207]
    ds_read_b64_tr_b16 v[80:81], v8 offset:20480
    v_max3_f32 v96, v96, v139, v140
    v_min3_f32 v98, v98, v139, v140
    v_max3_f32 v96, v96, v141, v142
    v_min3_f32 v98, v98, v141, v142
    v_max_f32 v96, v96, v143
    v_mfma_f32_32x32x16_bf16 v[208:223], v[68:71], a[16:19], v[208:223]
    ds_read_b64_tr_b16 v[82:83], v8 offset:20992
    v_min_f32 v98, v98, v143
    v_mov_b32 v97, v96
    v_mov_b32 v99, v98
    s_nop 0
    v_permlane32_swap_b32 v96, v97
    v_permlane32_swap_b32 v98, v99
    v_mfma_f32_32x32x16_bf16 v[224:239], v[64:67], a[128:131], v[224:239]
    ds_read_b64_tr_b16 v[84:85], v8 offset:28672
    v_max_f32 v96, v96, v97
    v_min_f32 v98, v98, v99
    v_mul_f32 v96, s91, v96
    v_mul_f32 v98, s91, v98
    v_cndmask_b32 v100, v96, v12, s[96:97]
    v_mfma_f32_32x32x16_bf16 v[240:255], v[68:71], a[128:131], v[240:255]
    ds_read_b64_tr_b16 v[86:87], v8 offset:29184
    v_cndmask_b32 v102, v98, v13, s[96:97]
    v_fma_f32 v112, -v128, s91, v98
    v_fma_f32 v128, v128, s91, -v96
    v_fma_f32 v113, -v129, s91, v98
    v_fma_f32 v129, v129, s91, -v96
    s_waitcnt lgkmcnt(4)
    v_mfma_f32_32x32x16_bf16 v[192:207], v[72:75], a[20:23], v[192:207]
    ds_read_b64_tr_b16 v[88:89], v8 offset:22528
    v_exp_f32 v112, v112
    v_fma_f32 v114, -v130, s91, v98
    v_exp_f32 v128, v128
    v_fma_f32 v130, v130, s91, -v96
    v_exp_f32 v113, v113
    v_mfma_f32_32x32x16_bf16 v[208:223], v[76:79], a[20:23], v[208:223]
    ds_read_b64_tr_b16 v[90:91], v8 offset:23040
    v_fma_f32 v115, -v131, s91, v98
    v_exp_f32 v129, v129
    v_fma_f32 v131, v131, s91, -v96
    v_exp_f32 v114, v114
    v_fma_f32 v116, -v132, s91, v98
    v_mfma_f32_32x32x16_bf16 v[224:239], v[72:75], a[132:135], v[224:239]
    ds_read_b64_tr_b16 v[92:93], v8 offset:30720
    v_exp_f32 v130, v130
    v_fma_f32 v132, v132, s91, -v96
    v_exp_f32 v115, v115
    v_fma_f32 v117, -v133, s91, v98
    v_exp_f32 v131, v131
    v_mfma_f32_32x32x16_bf16 v[240:255], v[76:79], a[132:135], v[240:255]
    ds_read_b64_tr_b16 v[94:95], v8 offset:31232
    v_fma_f32 v133, v133, s91, -v96
    v_exp_f32 v116, v116
    v_add_f32 v14, v112, v114
    v_fma_f32 v118, -v134, s91, v98
    v_exp_f32 v132, v132
    s_waitcnt lgkmcnt(4)
    v_mfma_f32_32x32x16_bf16 v[192:207], v[80:83], a[24:27], v[192:207]
    ds_read_b64_tr_b16 v[64:65], v8 offset:32768
    v_add_f32 v12, v128, v130
    v_fma_f32 v134, v134, s91, -v96
    v_exp_f32 v117, v117
    v_add_f32 v15, v113, v115
    v_fma_f32 v119, -v135, s91, v98
    v_mfma_f32_32x32x16_bf16 v[208:223], v[84:87], a[24:27], v[208:223]
    ds_read_b64_tr_b16 v[66:67], v8 offset:33280
    v_exp_f32 v133, v133
    v_add_f32 v13, v129, v131
    v_fma_f32 v135, v135, s91, -v96
    v_exp_f32 v118, v118
    v_add_f32 v14, v14, v116
    v_fma_f32 v120, -v136, s91, v98
    v_mfma_f32_32x32x16_bf16 v[224:239], v[80:83], a[136:139], v[224:239]
    ds_read_b64_tr_b16 v[68:69], v8 offset:40960
    v_exp_f32 v134, v134
    v_add_f32 v12, v12, v132
    v_fma_f32 v136, v136, s91, -v96
    v_exp_f32 v119, v119
    v_add_f32 v15, v15, v117
    v_mfma_f32_32x32x16_bf16 v[240:255], v[84:87], a[136:139], v[240:255]
    ds_read_b64_tr_b16 v[70:71], v8 offset:41472
    v_fma_f32 v121, -v137, s91, v98
    v_exp_f32 v135, v135
    v_add_f32 v13, v13, v133
    v_fma_f32 v137, v137, s91, -v96
    v_exp_f32 v120, v120
    s_waitcnt lgkmcnt(4)
    v_mfma_f32_32x32x16_bf16 v[192:207], v[88:91], a[28:31], v[192:207]
    ds_read_b64_tr_b16 v[72:73], v8 offset:34816
    v_add_f32 v14, v14, v118
    v_fma_f32 v122, -v138, s91, v98
    v_exp_f32 v136, v136
    v_add_f32 v12, v12, v134
    v_fma_f32 v138, v138, s91, -v96
    v_mfma_f32_32x32x16_bf16 v[208:223], v[92:95], a[28:31], v[208:223]
    ds_read_b64_tr_b16 v[74:75], v8 offset:35328
    v_exp_f32 v121, v121
    v_add_f32 v15, v15, v119
    v_fma_f32 v123, -v139, s91, v98
    v_exp_f32 v137, v137
    v_add_f32 v13, v13, v135
    v_mfma_f32_32x32x16_bf16 v[224:239], v[88:91], a[140:143], v[224:239]
    ds_read_b64_tr_b16 v[76:77], v8 offset:43008
    v_fma_f32 v139, v139, s91, -v96
    v_exp_f32 v122, v122
    v_add_f32 v14, v14, v120
    v_fma_f32 v124, -v140, s91, v102
    v_exp_f32 v138, v138
    v_mfma_f32_32x32x16_bf16 v[240:255], v[92:95], a[140:143], v[240:255]
    ds_read_b64_tr_b16 v[78:79], v8 offset:43520
    v_add_f32 v12, v12, v136
    v_fma_f32 v140, v140, s91, -v100
    v_exp_f32 v123, v123
    v_add_f32 v15, v15, v121
    v_fma_f32 v125, -v141, s91, v102
    s_waitcnt lgkmcnt(4)
    v_mfma_f32_32x32x16_bf16 v[192:207], v[64:67], a[32:35], v[192:207]
    ds_read_b64_tr_b16 v[80:81], v8 offset:36864
    v_exp_f32 v139, v139
    v_add_f32 v13, v13, v137
    v_fma_f32 v141, v141, s91, -v100
    v_exp_f32 v124, v124
    v_add_f32 v14, v14, v122
    v_mfma_f32_32x32x16_bf16 v[208:223], v[68:71], a[32:35], v[208:223]
    ds_read_b64_tr_b16 v[82:83], v8 offset:37376
    v_fma_f32 v126, -v142, s91, v102
    v_exp_f32 v140, v140
    v_add_f32 v12, v12, v138
    v_fma_f32 v142, v142, s91, -v100
    v_exp_f32 v125, v125
    v_mfma_f32_32x32x16_bf16 v[224:239], v[64:67], a[144:147], v[224:239]
    ds_read_b64_tr_b16 v[84:85], v8 offset:45056
    v_add_f32 v15, v15, v123
    v_fma_f32 v127, -v143, s91, v102
    v_exp_f32 v141, v141
    v_add_f32 v13, v13, v139
    v_fma_f32 v143, v143, s91, -v100
    v_mfma_f32_32x32x16_bf16 v[240:255], v[68:71], a[144:147], v[240:255]
    ds_read_b64_tr_b16 v[86:87], v8 offset:45568
    v_exp_f32 v126, v126
    v_add_f32 v14, v14, v124
    v_exp_f32 v142, v142
    v_add_f32 v12, v12, v140
    v_exp_f32 v127, v127
    s_waitcnt lgkmcnt(4)
    v_mfma_f32_32x32x16_bf16 v[192:207], v[72:75], a[36:39], v[192:207]
    ds_read_b64_tr_b16 v[88:89], v8 offset:38912
    v_add_f32 v15, v15, v125
    v_exp_f32 v143, v143
    v_add_f32 v13, v13, v141
    v_add_f32 v14, v14, v126
    v_add_f32 v12, v12, v142
    v_mfma_f32_32x32x16_bf16 v[208:223], v[76:79], a[36:39], v[208:223]
    ds_read_b64_tr_b16 v[90:91], v8 offset:39424
    v_add_f32 v15, v15, v127
    v_add_f32 v13, v13, v143
    v_add_f32 v14, v14, v15
    v_add_f32 v12, v12, v13
    v_mov_b32 v15, v14
    v_mov_b32 v13, v12
    v_mfma_f32_32x32x16_bf16 v[224:239], v[72:75], a[148:151], v[224:239]
    ds_read_b64_tr_b16 v[92:93], v8 offset:47104
    v_permlane32_swap_b32 v14, v15
    v_permlane32_swap_b32 v12, v13
    v_add_f32 v14, v14, v15
    v_add_f32 v56, v12, v13
    v_rcp_f32 v14, v14
    v_mfma_f32_32x32x16_bf16 v[240:255], v[76:79], a[148:151], v[240:255]
    ds_read_b64_tr_b16 v[94:95], v8 offset:47616
    v_cvt_pk_bf16_f32 v128, v128, v129
    v_cvt_pk_bf16_f32 v129, v130, v131
    v_cvt_pk_bf16_f32 v130, v132, v133
    v_cvt_pk_bf16_f32 v131, v134, v135
    v_cvt_pk_bf16_f32 v132, v136, v137
    s_waitcnt lgkmcnt(4)
    v_mfma_f32_32x32x16_bf16 v[192:207], v[80:83], a[40:43], v[192:207]
    ds_read_b64_tr_b16 v[64:65], v8 offset:49152
    s_waitcnt vmcnt(0)
    s_barrier
    s_cmp_eq_u32 s75, 0
    s_cbranch_scc1 Lq_n6
    ds_write_b16 v33, v46 offset:32768
Lq_n6:
    v_cvt_pk_bf16_f32 v133, v138, v139
    v_cvt_pk_bf16_f32 v134, v140, v141
    v_cvt_pk_bf16_f32 v135, v142, v143
    v_mul_f32 v14, v14, v56
    v_mul_f32 v112, v112, v14
    v_mfma_f32_32x32x16_bf16 v[208:223], v[84:87], a[40:43], v[208:223]
    ds_read_b64_tr_b16 v[66:67], v8 offset:49664
    v_mul_f32 v113, v113, v14
    v_mul_f32 v114, v114, v14
    v_mul_f32 v115, v115, v14
    v_mul_f32 v116, v116, v14
    v_mul_f32 v117, v117, v14
    v_mfma_f32_32x32x16_bf16 v[224:239], v[80:83], a[152:155], v[224:239]
    ds_read_b64_tr_b16 v[68:69], v8 offset:57344
    v_mul_f32 v118, v118, v14
    v_mul_f32 v119, v119, v14
    v_mul_f32 v120, v120, v14
    v_mul_f32 v121, v121, v14
    v_mul_f32 v122, v122, v14
    v_mfma_f32_32x32x16_bf16 v[240:255], v[84:87], a[152:155], v[240:255]
    ds_read_b64_tr_b16 v[70:71], v8 offset:57856
    v_mul_f32 v123, v123, v14
    v_mul_f32 v124, v124, v14
    v_mul_f32 v125, v125, v14
    v_mul_f32 v126, v126, v14
    v_mul_f32 v127, v127, v14
    s_waitcnt lgkmcnt(4)
    v_mfma_f32_32x32x16_bf16 v[192:207], v[88:91], a[44:47], v[192:207]
    ds_read_b64_tr_b16 v[72:73], v8 offset:51200
    v_cvt_pk_bf16_f32 v136, v112, v113
    v_cvt_pk_bf16_f32 v137, v114, v115
    v_cvt_pk_bf16_f32 v138, v116, v117
    v_cvt_pk_bf16_f32 v139, v118, v119
    v_cvt_pk_bf16_f32 v140, v120, v121
    v_mfma_f32_32x32x16_bf16 v[208:223], v[92:95], a[44:47], v[208:223]
    ds_read_b64_tr_b16 v[74:75], v8 offset:51712
    v_cvt_pk_bf16_f32 v141, v122, v123
    v_cvt_pk_bf16_f32 v142, v124, v125
    v_cvt_pk_bf16_f32 v143, v126, v127
    v_mov_b32 v12, 0x7f800000
    v_mov_b32 v13, 0xff800000
    v_mfma_f32_32x32x16_bf16 v[224:239], v[88:91], a[156:159], v[224:239]
    ds_read_b64_tr_b16 v[76:77], v8 offset:59392
    v_max3_f32 v96, v144, v145, v146
    v_min3_f32 v98, v144, v145, v146
    v_cndmask_b32 v156, v156, v144, s[96:97]
    v_cndmask_b32 v157, v157, v144, s[96:97]
    v_cndmask_b32 v158, v158, v144, s[96:97]
    v_mfma_f32_32x32x16_bf16 v[240:255], v[92:95], a[156:159], v[240:255]
    ds_read_b64_tr_b16 v[78:79], v8 offset:59904
    v_cndmask_b32 v159, v159, v144, s[96:97]
    v_max3_f32 v96, v96, v147, v148
    v_min3_f32 v98, v98, v147, v148
    v_max3_f32 v96, v96, v149, v150
    v_min3_f32 v98, v98, v149, v150
    s_waitcnt lgkmcnt(4)
    v_mfma_f32_32x32x16_bf16 v[192:207], v[64:67], a[48:51], v[192:207]
    ds_read_b64_tr_b16 v[80:81], v8 offset:53248
    v_max3_f32 v96, v96, v151, v152
    v_min3_f32 v98, v98, v151, v152
    v_max3_f32 v96, v96, v153, v154
    v_min3_f32 v98, v98, v153, v154
    v_max3_f32 v96, v96, v155, v156
    v_mfma_f32_32x32x16_bf16 v[208:223], v[68:71], a[48:51], v[208:223]
    ds_read_b64_tr_b16 v[82:83], v8 offset:53760
    v_min3_f32 v98, v98, v155, v156
    v_max3_f32 v96, v96, v157, v158
    v_min3_f32 v98, v98, v157, v158
    v_max_f32 v96, v96, v159
    v_min_f32 v98, v98, v159
    v_mov_b32 v97, v96
    v_mfma_f32_32x32x16_bf16 v[224:239], v[64:67], a[160:163], v[224:239]
    ds_read_b64_tr_b16 v[84:85], v8 offset:61440
    v_mov_b32 v99, v98
    v_permlane32_swap_b32 v96, v97
    s_nop 0
    v_permlane32_swap_b32 v98, v99
    v_max_f32 v96, v96, v97
    v_min_f32 v98, v98, v99
    v_mfma_f32_32x32x16_bf16 v[240:255], v[68:71], a[160:163], v[240:255]
    ds_read_b64_tr_b16 v[86:87], v8 offset:61952
    v_mul_f32 v96, s91, v96
    v_mul_f32 v98, s91, v98
    v_cndmask_b32 v100, v96, v12, s[96:97]
    v_cndmask_b32 v102, v98, v13, s[96:97]
    v_fma_f32 v112, -v144, s91, v98
    s_waitcnt lgkmcnt(4)
    v_mfma_f32_32x32x16_bf16 v[192:207], v[72:75], a[52:55], v[192:207]
    ds_read_b64_tr_b16 v[88:89], v8 offset:55296
    v_fma_f32 v144, v144, s91, -v96
    v_fma_f32 v113, -v145, s91, v98
    v_fma_f32 v145, v145, s91, -v96
    v_exp_f32 v112, v112
    v_fma_f32 v114, -v146, s91, v98
    v_mfma_f32_32x32x16_bf16 v[208:223], v[76:79], a[52:55], v[208:223]
    ds_read_b64_tr_b16 v[90:91], v8 offset:55808
    v_exp_f32 v144, v144
    v_fma_f32 v146, v146, s91, -v96
    v_exp_f32 v113, v113
    v_fma_f32 v115, -v147, s91, v98
    v_exp_f32 v145, v145
    v_mfma_f32_32x32x16_bf16 v[224:239], v[72:75], a[164:167], v[224:239]
    ds_read_b64_tr_b16 v[92:93], v8 offset:63488
    v_fma_f32 v147, v147, s91, -v96
    v_exp_f32 v114, v114
    v_fma_f32 v116, -v148, s91, v98
    v_exp_f32 v146, v146
    v_fma_f32 v148, v148, s91, -v96
    v_mfma_f32_32x32x16_bf16 v[240:255], v[76:79], a[164:167], v[240:255]
    ds_read_b64_tr_b16 v[94:95], v8 offset:64000
    v_exp_f32 v115, v115
    v_fma_f32 v117, -v149, s91, v98
    v_exp_f32 v147, v147
    v_fma_f32 v149, v149, s91, -v96
    v_exp_f32 v116, v116
    s_waitcnt lgkmcnt(4)
    v_mfma_f32_32x32x16_bf16 v[192:207], v[80:83], a[56:59], v[192:207]
    ds_read_b64_tr_b16 v[64:65], v9 offset:0
    v_add_f32 v14, v112, v114
    v_fma_f32 v118, -v150, s91, v98
    v_exp_f32 v148, v148
    v_add_f32 v12, v144, v146
    v_fma_f32 v150, v150, s91, -v96
    v_mfma_f32_32x32x16_bf16 v[208:223], v[84:87], a[56:59], v[208:223]
    ds_read_b64_tr_b16 v[66:67], v9 offset:512
    v_exp_f32 v117, v117
    v_add_f32 v15, v113, v115
    v_fma_f32 v119, -v151, s91, v98
    v_exp_f32 v149, v149
    v_add_f32 v13, v145, v147
    v_mfma_f32_32x32x16_bf16 v[224:239], v[80:83], a[168:171], v[224:239]
    ds_read_b64_tr_b16 v[68:69], v9 offset:8192
    v_fma_f32 v151, v151, s91, -v96
    v_exp_f32 v118, v118
    v_add_f32 v14, v14, v116
    v_fma_f32 v120, -v152, s91, v98
    v_exp_f32 v150, v150
    v_mfma_f32_32x32x16_bf16 v[240:255], v[84:87], a[168:171], v[240:255]
    ds_read_b64_tr_b16 v[70:71], v9 offset:8704
    v_add_f32 v12, v12, v148
    v_fma_f32 v152, v152, s91, -v96
    v_exp_f32 v119, v119
    v_add_f32 v15, v15, v117
    v_fma_f32 v121, -v153, s91, v98
    s_waitcnt lgkmcnt(4)
    v_mfma_f32_32x32x16_bf16 v[192:207], v[88:91], a[60:63], v[192:207]
    ds_read_b64_tr_b16 v[72:73], v9 offset:2048
    v_exp_f32 v151, v151
    v_add_f32 v13, v13, v149
    v_fma_f32 v153, v153, s91, -v96
    v_exp_f32 v120, v120
    v_add_f32 v14, v14, v118
    v_mfma_f32_32x32x16_bf16 v[208:223], v[92:95], a[60:63], v[208:223]
    ds_read_b64_tr_b16 v[74:75], v9 offset:2560
    v_fma_f32 v122, -v154, s91, v98
    v_exp_f32 v152, v152
    v_add_f32 v12, v12, v150
    v_fma_f32 v154, v154, s91, -v96
    v_exp_f32 v121, v121
    v_mfma_f32_32x32x16_bf16 v[224:239], v[88:91], a[172:175], v[224:239]
    ds_read_b64_tr_b16 v[76:77], v9 offset:10240
    v_add_f32 v15, v15, v119
    v_fma_f32 v123, -v155, s91, v98
    v_exp_f32 v153, v153
    v_add_f32 v13, v13, v151
    v_fma_f32 v155, v155, s91, -v96
    v_exp_f32 v122, v122
    v_mfma_f32_32x32x16_bf16 v[240:255], v[92:95], a[172:175], v[240:255]
    ds_read_b64_tr_b16 v[78:79], v9 offset:10752
    v_add_f32 v14, v14, v120
    v_fma_f32 v124, -v156, s91, v102
    v_exp_f32 v154, v154
    v_add_f32 v12, v12, v152
    v_fma_f32 v156, v156, s91, -v100
    s_waitcnt lgkmcnt(4)
    v_mfma_f32_32x32x16_bf16 v[192:207], v[64:67], a[64:67], v[192:207]
    ds_read_b64_tr_b16 v[80:81], v9 offset:4096
    v_exp_f32 v123, v123
    v_add_f32 v15, v15, v121
    v_fma_f32 v125, -v157, s91, v102
    v_exp_f32 v155, v155
    v_add_f32 v13, v13, v153
    v_mfma_f32_32x32x16_bf16 v[208:223], v[68:71], a[64:67], v[208:223]
    ds_read_b64_tr_b16 v[82:83], v9 offset:4608
    v_fma_f32 v157, v157, s91, -v100
    v_exp_f32 v124, v124
    v_add_f32 v14, v14, v122
    v_fma_f32 v126, -v158, s91, v102
    v_exp_f32 v156, v156
    v_mfma_f32_32x32x16_bf16 v[224:239], v[64:67], a[176:179], v[224:239]
    ds_read_b64_tr_b16 v[84:85], v9 offset:12288
    v_add_f32 v12, v12, v154
    v_fma_f32 v158, v158, s91, -v100
    v_exp_f32 v125, v125
    v_add_f32 v15, v15, v123
    v_fma_f32 v127, -v159, s91, v102
    v_mfma_f32_32x32x16_bf16 v[240:255], v[68:71], a[176:179], v[240:255]
    ds_read_b64_tr_b16 v[86:87], v9 offset:12800
    v_exp_f32 v157, v157
    v_add_f32 v13, v13, v155
    v_fma_f32 v159, v159, s91, -v100
    v_exp_f32 v126, v126
    v_add_f32 v14, v14, v124
    s_waitcnt lgkmcnt(4)
    v_mfma_f32_32x32x16_bf16 v[192:207], v[72:75], a[68:71], v[192:207]
    ds_read_b64_tr_b16 v[88:89], v9 offset:6144
    v_exp_f32 v158, v158
    v_add_f32 v12, v12, v156
    v_exp_f32 v127, v127
    v_add_f32 v15, v15, v125
    v_exp_f32 v159, v159
    v_mfma_f32_32x32x16_bf16 v[208:223], v[76:79], a[68:71], v[208:223]
    ds_read_b64_tr_b16 v[90:91], v9 offset:6656
    v_add_f32 v13, v13, v157
    v_add_f32 v14, v14, v126
    v_add_f32 v12, v12, v158
    v_add_f32 v15, v15, v127
    v_add_f32 v13, v13, v159
    v_mfma_f32_32x32x16_bf16 v[224:239], v[72:75], a[180:183], v[224:239]
    ds_read_b64_tr_b16 v[92:93], v9 offset:14336
    v_add_f32 v14, v14, v15
    v_add_f32 v12, v12, v13
    v_mov_b32 v15, v14
    v_mov_b32 v13, v12
    s_nop 0
    v_permlane32_swap_b32 v14, v15
    v_mfma_f32_32x32x16_bf16 v[240:255], v[76:79], a[180:183], v[240:255]
    ds_read_b64_tr_b16 v[94:95], v9 offset:14848
    v_permlane32_swap_b32 v12, v13
    v_add_f32 v14, v14, v15
    v_add_f32 v57, v12, v13
    v_rcp_f32 v14, v14
    v_cvt_pk_bf16_f32 v144, v144, v145
    s_waitcnt lgkmcnt(4)
    v_mfma_f32_32x32x16_bf16 v[192:207], v[80:83], a[72:75], v[192:207]
    ds_read_b64_tr_b16 v[64:65], v9 offset:16384
    v_cvt_pk_bf16_f32 v145, v146, v147
    v_cvt_pk_bf16_f32 v146, v148, v149
    v_cvt_pk_bf16_f32 v147, v150, v151
    v_cvt_pk_bf16_f32 v148, v152, v153
    v_cvt_pk_bf16_f32 v149, v154, v155
    v_mfma_f32_32x32x16_bf16 v[208:223], v[84:87], a[72:75], v[208:223]
    ds_read_b64_tr_b16 v[66:67], v9 offset:16896
    v_cvt_pk_bf16_f32 v150, v156, v157
    v_cvt_pk_bf16_f32 v151, v158, v159
    v_mul_f32 v14, v14, v57
    v_mul_f32 v112, v112, v14
    v_mul_f32 v113, v113, v14
    v_mfma_f32_32x32x16_bf16 v[224:239], v[80:83], a[184:187], v[224:239]
    ds_read_b64_tr_b16 v[68:69], v9 offset:24576
    v_mul_f32 v114, v114, v14
    v_mul_f32 v115, v115, v14
    v_mul_f32 v116, v116, v14
    v_mul_f32 v117, v117, v14
    v_mul_f32 v118, v118, v14
    v_mul_f32 v119, v119, v14
    v_mfma_f32_32x32x16_bf16 v[240:255], v[84:87], a[184:187], v[240:255]
    ds_read_b64_tr_b16 v[70:71], v9 offset:25088
    v_mul_f32 v120, v120, v14
    v_mul_f32 v121, v121, v14
    v_mul_f32 v122, v122, v14
    v_mul_f32 v123, v123, v14
    v_mul_f32 v124, v124, v14
    s_waitcnt lgkmcnt(4)
    v_mfma_f32_32x32x16_bf16 v[192:207], v[88:91], a[76:79], v[192:207]
    ds_read_b64_tr_b16 v[72:73], v9 offset:18432
    v_mul_f32 v125, v125, v14
    v_mul_f32 v126, v126, v14
    v_mul_f32 v127, v127, v14
    v_cvt_pk_bf16_f32 v152, v112, v113
    v_cvt_pk_bf16_f32 v153, v114, v115
    v_mfma_f32_32x32x16_bf16 v[208:223], v[92:95], a[76:79], v[208:223]
    ds_read_b64_tr_b16 v[74:75], v9 offset:18944
    v_cvt_pk_bf16_f32 v154, v116, v117
    v_cvt_pk_bf16_f32 v155, v118, v119
    v_cvt_pk_bf16_f32 v156, v120, v121
    v_cvt_pk_bf16_f32 v157, v122, v123
    v_cvt_pk_bf16_f32 v158, v124, v125
    v_mfma_f32_32x32x16_bf16 v[224:239], v[88:91], a[188:191], v[224:239]
    ds_read_b64_tr_b16 v[76:77], v9 offset:26624
    v_cvt_pk_bf16_f32 v159, v126, v127
    v_mov_b32 v12, 0x7f800000
    v_mov_b32 v13, 0xff800000
    v_max3_f32 v96, v160, v161, v162
    v_min3_f32 v98, v160, v161, v162
    v_mfma_f32_32x32x16_bf16 v[240:255], v[92:95], a[188:191], v[240:255]
    ds_read_b64_tr_b16 v[78:79], v9 offset:27136
    v_cndmask_b32 v172, v172, v160, s[96:97]
    v_cndmask_b32 v173, v173, v160, s[96:97]
    v_cndmask_b32 v174, v174, v160, s[96:97]
    v_cndmask_b32 v175, v175, v160, s[96:97]
    v_max3_f32 v96, v96, v163, v164
    s_waitcnt lgkmcnt(4)
    v_mfma_f32_32x32x16_bf16 v[192:207], v[64:67], a[80:83], v[192:207]
    ds_read_b64_tr_b16 v[80:81], v9 offset:20480
    v_min3_f32 v98, v98, v163, v164
    v_max3_f32 v96, v96, v165, v166
    v_min3_f32 v98, v98, v165, v166
    v_max3_f32 v96, v96, v167, v168
    v_min3_f32 v98, v98, v167, v168
    v_mfma_f32_32x32x16_bf16 v[208:223], v[68:71], a[80:83], v[208:223]
    ds_read_b64_tr_b16 v[82:83], v9 offset:20992
    v_max3_f32 v96, v96, v169, v170
    v_min3_f32 v98, v98, v169, v170
    v_max3_f32 v96, v96, v171, v172
    v_min3_f32 v98, v98, v171, v172
    v_max3_f32 v96, v96, v173, v174
    v_mfma_f32_32x32x16_bf16 v[224:239], v[64:67], a[192:195], v[224:239]
    ds_read_b64_tr_b16 v[84:85], v9 offset:28672
    v_min3_f32 v98, v98, v173, v174
    v_max_f32 v96, v96, v175
    v_min_f32 v98, v98, v175
    v_mov_b32 v97, v96
    v_mov_b32 v99, v98
    v_mfma_f32_32x32x16_bf16 v[240:255], v[68:71], a[192:195], v[240:255]
    ds_read_b64_tr_b16 v[86:87], v9 offset:29184
    v_permlane32_swap_b32 v96, v97
    v_permlane32_swap_b32 v98, v99
    v_max_f32 v96, v96, v97
    v_min_f32 v98, v98, v99
    v_mul_f32 v96, s91, v96
    s_waitcnt lgkmcnt(4)
    v_mfma_f32_32x32x16_bf16 v[192:207], v[72:75], a[84:87], v[192:207]
    ds_read_b64_tr_b16 v[88:89], v9 offset:22528
    v_mul_f32 v98, s91, v98
    v_cndmask_b32 v100, v96, v12, s[96:97]
    v_cndmask_b32 v102, v98, v13, s[96:97]
    v_fma_f32 v112, -v160, s91, v98
    v_fma_f32 v160, v160, s91, -v96
    v_mfma_f32_32x32x16_bf16 v[208:223], v[76:79], a[84:87], v[208:223]
    ds_read_b64_tr_b16 v[90:91], v9 offset:23040
    v_fma_f32 v113, -v161, s91, v98
    v_fma_f32 v161, v161, s91, -v96
    v_exp_f32 v112, v112
    v_fma_f32 v114, -v162, s91, v98
    v_exp_f32 v160, v160
    v_mfma_f32_32x32x16_bf16 v[224:239], v[72:75], a[196:199], v[224:239]
    ds_read_b64_tr_b16 v[92:93], v9 offset:30720
    v_fma_f32 v162, v162, s91, -v96
    v_exp_f32 v113, v113
    v_fma_f32 v115, -v163, s91, v98
    v_exp_f32 v161, v161
    v_fma_f32 v163, v163, s91, -v96
    v_exp_f32 v114, v114
    v_mfma_f32_32x32x16_bf16 v[240:255], v[76:79], a[196:199], v[240:255]
    ds_read_b64_tr_b16 v[94:95], v9 offset:31232
    v_fma_f32 v116, -v164, s91, v98
    v_exp_f32 v162, v162
    v_fma_f32 v164, v164, s91, -v96
    v_exp_f32 v115, v115
    v_fma_f32 v117, -v165, s91, v98
    s_waitcnt lgkmcnt(4)
    v_mfma_f32_32x32x16_bf16 v[192:207], v[80:83], a[88:91], v[192:207]
    ds_read_b64_tr_b16 v[64:65], v9 offset:32768
    v_exp_f32 v163, v163
    v_fma_f32 v165, v165, s91, -v96
    v_exp_f32 v116, v116
    v_add_f32 v14, v112, v114
    v_fma_f32 v118, -v166, s91, v98
    v_mfma_f32_32x32x16_bf16 v[208:223], v[84:87], a[88:91], v[208:223]
    ds_read_b64_tr_b16 v[66:67], v9 offset:33280
    v_exp_f32 v164, v164
    v_add_f32 v12, v160, v162
    v_fma_f32 v166, v166, s91, -v96
    v_exp_f32 v117, v117
    v_add_f32 v15, v113, v115
    v_mfma_f32_32x32x16_bf16 v[224:239], v[80:83], a[200:203], v[224:239]
    ds_read_b64_tr_b16 v[68:69], v9 offset:40960
    v_fma_f32 v119, -v167, s91, v98
    v_exp_f32 v165, v165
    v_add_f32 v13, v161, v163
    v_fma_f32 v167, v167, s91, -v96
    v_exp_f32 v118, v118
    v_mfma_f32_32x32x16_bf16 v[240:255], v[84:87], a[200:203], v[240:255]
    ds_read_b64_tr_b16 v[70:71], v9 offset:41472
    v_add_f32 v14, v14, v116
    v_fma_f32 v120, -v168, s91, v98
    v_exp_f32 v166, v166
    v_add_f32 v12, v12, v164
    v_fma_f32 v168, v168, s91, -v96
    s_waitcnt lgkmcnt(4)
    v_mfma_f32_32x32x16_bf16 v[192:207], v[88:91], a[92:95], v[192:207]
    ds_read_b64_tr_b16 v[72:73], v9 offset:34816
    v_exp_f32 v119, v119
    v_add_f32 v15, v15, v117
    v_fma_f32 v121, -v169, s91, v98
    v_exp_f32 v167, v167
    v_add_f32 v13, v13, v165
    v_mfma_f32_32x32x16_bf16 v[208:223], v[92:95], a[92:95], v[208:223]
    ds_read_b64_tr_b16 v[74:75], v9 offset:35328
    v_fma_f32 v169, v169, s91, -v96
    v_exp_f32 v120, v120
    v_add_f32 v14, v14, v118
    v_fma_f32 v122, -v170, s91, v98
    v_exp_f32 v168, v168
    v_mfma_f32_32x32x16_bf16 v[224:239], v[88:91], a[204:207], v[224:239]
    ds_read_b64_tr_b16 v[76:77], v9 offset:43008
    v_add_f32 v12, v12, v166
    v_fma_f32 v170, v170, s91, -v96
    v_exp_f32 v121, v121
    v_add_f32 v15, v15, v119
    v_fma_f32 v123, -v171, s91, v98
    v_mfma_f32_32x32x16_bf16 v[240:255], v[92:95], a[204:207], v[240:255]
    ds_read_b64_tr_b16 v[78:79], v9 offset:43520
    v_exp_f32 v169, v169
    v_add_f32 v13, v13, v167
    v_fma_f32 v171, v171, s91, -v96
    v_exp_f32 v122, v122
    v_add_f32 v14, v14, v120
    s_waitcnt lgkmcnt(4)
    v_mfma_f32_32x32x16_bf16 v[192:207], v[64:67], a[96:99], v[192:207]
    ds_read_b64_tr_b16 v[80:81], v9 offset:36864
    v_fma_f32 v124, -v172, s91, v102
    v_exp_f32 v170, v170
    v_add_f32 v12, v12, v168
    v_fma_f32 v172, v172, s91, -v100
    v_exp_f32 v123, v123
    v_mfma_f32_32x32x16_bf16 v[208:223], v[68:71], a[96:99], v[208:223]
    ds_read_b64_tr_b16 v[82:83], v9 offset:37376
    v_add_f32 v15, v15, v121
    v_fma_f32 v125, -v173, s91, v102
    v_exp_f32 v171, v171
    v_add_f32 v13, v13, v169
    v_fma_f32 v173, v173, s91, -v100
    v_mfma_f32_32x32x16_bf16 v[224:239], v[64:67], a[208:211], v[224:239]
    ds_read_b64_tr_b16 v[84:85], v9 offset:45056
    v_exp_f32 v124, v124
    v_add_f32 v14, v14, v122
    v_fma_f32 v126, -v174, s91, v102
    v_exp_f32 v172, v172
    v_add_f32 v12, v12, v170
    v_fma_f32 v174, v174, s91, -v100
    v_mfma_f32_32x32x16_bf16 v[240:255], v[68:71], a[208:211], v[240:255]
    ds_read_b64_tr_b16 v[86:87], v9 offset:45568
    v_exp_f32 v125, v125
    v_add_f32 v15, v15, v123
    v_fma_f32 v127, -v175, s91, v102
    v_exp_f32 v173, v173
    v_add_f32 v13, v13, v171
    s_waitcnt lgkmcnt(4)
    v_mfma_f32_32x32x16_bf16 v[192:207], v[72:75], a[100:103], v[192:207]
    ds_read_b64_tr_b16 v[88:89], v9 offset:38912
    v_fma_f32 v175, v175, s91, -v100
    v_exp_f32 v126, v126
    v_add_f32 v14, v14, v124
    v_exp_f32 v174, v174
    v_add_f32 v12, v12, v172
    v_mfma_f32_32x32x16_bf16 v[208:223], v[76:79], a[100:103], v[208:223]
    ds_read_b64_tr_b16 v[90:91], v9 offset:39424
    v_exp_f32 v127, v127
    v_add_f32 v15, v15, v125
    v_exp_f32 v175, v175
    v_add_f32 v13, v13, v173
    v_add_f32 v14, v14, v126
    v_mfma_f32_32x32x16_bf16 v[224:239], v[72:75], a[212:215], v[224:239]
    ds_read_b64_tr_b16 v[92:93], v9 offset:47104
    v_add_f32 v12, v12, v174
    v_add_f32 v15, v15, v127
    v_add_f32 v13, v13, v175
    v_add_f32 v14, v14, v15
    v_add_f32 v12, v12, v13
    v_mfma_f32_32x32x16_bf16 v[240:255], v[76:79], a[212:215], v[240:255]
    ds_read_b64_tr_b16 v[94:95], v9 offset:47616
    v_mov_b32 v15, v14
    v_mov_b32 v13, v12
    s_nop 0
    v_permlane32_swap_b32 v14, v15
    v_permlane32_swap_b32 v12, v13
    v_add_f32 v14, v14, v15
    s_waitcnt lgkmcnt(4)
    v_mfma_f32_32x32x16_bf16 v[192:207], v[80:83], a[104:107], v[192:207]
    v_add_f32 v58, v12, v13
    v_rcp_f32 v14, v14
    v_cvt_pk_bf16_f32 v160, v160, v161
    v_cvt_pk_bf16_f32 v161, v162, v163
    v_cvt_pk_bf16_f32 v162, v164, v165
    v_mfma_f32_32x32x16_bf16 v[208:223], v[84:87], a[104:107], v[208:223]
    v_cvt_pk_bf16_f32 v163, v166, v167
    v_cvt_pk_bf16_f32 v164, v168, v169
    v_cvt_pk_bf16_f32 v165, v170, v171
    v_cvt_pk_bf16_f32 v166, v172, v173
    v_cvt_pk_bf16_f32 v167, v174, v175
    v_mfma_f32_32x32x16_bf16 v[224:239], v[80:83], a[216:219], v[224:239]
    v_mul_f32 v14, v14, v58
    v_mul_f32 v112, v112, v14
    v_mul_f32 v113, v113, v14
    v_mul_f32 v114, v114, v14
    v_mul_f32 v115, v115, v14
    v_mfma_f32_32x32x16_bf16 v[240:255], v[84:87], a[216:219], v[240:255]
    v_mul_f32 v116, v116, v14
    v_mul_f32 v117, v117, v14
    v_mul_f32 v118, v118, v14
    v_mul_f32 v119, v119, v14
    v_mul_f32 v120, v120, v14
    s_waitcnt lgkmcnt(0)
    v_mfma_f32_32x32x16_bf16 v[192:207], v[88:91], a[108:111], v[192:207]
    v_mul_f32 v121, v121, v14
    v_mul_f32 v122, v122, v14
    v_mul_f32 v123, v123, v14
    v_mul_f32 v124, v124, v14
    v_mul_f32 v125, v125, v14
    v_mfma_f32_32x32x16_bf16 v[208:223], v[92:95], a[108:111], v[208:223]
    v_mul_f32 v126, v126, v14
    v_mul_f32 v127, v127, v14
    v_cvt_pk_bf16_f32 v168, v112, v113
    v_cvt_pk_bf16_f32 v169, v114, v115
    v_cvt_pk_bf16_f32 v170, v116, v117
    v_mfma_f32_32x32x16_bf16 v[224:239], v[88:91], a[220:223], v[224:239]
    v_cvt_pk_bf16_f32 v171, v118, v119
    v_cvt_pk_bf16_f32 v172, v120, v121
    v_cvt_pk_bf16_f32 v173, v122, v123
    v_cvt_pk_bf16_f32 v174, v124, v125
    v_cvt_pk_bf16_f32 v175, v126, v127
    v_mfma_f32_32x32x16_bf16 v[240:255], v[92:95], a[220:223], v[240:255]
    ds_read_b64_tr_b16 v[64:65], v16 offset:6272
    ds_read_b64_tr_b16 v[66:67], v16 offset:6720
    ds_read_b64_tr_b16 v[68:69], v16 offset:7168
    ds_read_b64_tr_b16 v[70:71], v16 offset:7616
    ds_read_b64_tr_b16 v[72:73], v16 offset:9408
    ds_read_b64_tr_b16 v[74:75], v16 offset:9856
    ds_read_b64_tr_b16 v[76:77], v16 offset:10304
    ds_read_b64_tr_b16 v[78:79], v16 offset:10752
    v_and_b32 v24, 3, v0
    v_lshlrev_b32 v24, 3, v24
    v_lshrrev_b32 v24, v24, v22
    v_and_b32 v24, 0xff, v24
    s_lshl_b32 s87, s74, 8
    s_add_u32 s87, s87, 160768
    v_add_u32 v23, s87, v17
    s_lshl_b32 s88, s85, 16
    s_lshl_b32 s89, s72, 14
    s_add_u32 s88, s88, s89
    s_add_u32 s57, s88, 10485760
    s_cmp_eq_u32 s75, 0
    s_cbranch_scc1 Lq_ng
    v_mov_b32 v12, v204
    v_mov_b32 v13, v204
    s_nop 1
    v_permlane32_swap_b32 v12, v13
    v_min_f32 v13, 0x42700000, v13
    v_mul_f32 v13, s91, v13
    v_exp_f32 v13, v13
    ds_write_b32 v23, v13 offset:0
    v_add_f32 v15, 1.0, v13
    v_rcp_f32 v15, v15
    s_nop 0
    buffer_store_dword v15, v17, s[28:31], s78 offen offset:0 sc1
    v_mov_b32 v12, v236
    v_mov_b32 v13, v236
    s_nop 1
    v_permlane32_swap_b32 v12, v13
    v_min_f32 v13, 0x42700000, v13
    v_mul_f32 v13, s91, v13
    v_exp_f32 v13, v13
    ds_write_b32 v23, v13 offset:128
    v_add_f32 v15, 1.0, v13
    v_rcp_f32 v15, v15
    s_nop 0
    buffer_store_dword v15, v17, s[28:31], s78 offen offset:128 sc1
Lq_ng:
    s_waitcnt lgkmcnt(0)
    s_nop 3
    s_add_u32 s88, s57, 0
    buffer_load_dwordx4 a[0:3], v1, s[28:31], s88 offen offset:0 sc1
    v_cvt_pk_bf16_f32 v80, v192, v193
    v_cvt_pk_bf16_f32 v81, v194, v195
    v_cvt_pk_bf16_f32 v82, v196, v197
    v_cvt_pk_bf16_f32 v83, v198, v199
    v_cvt_pk_bf16_f32 v84, v200, v201
    v_cvt_pk_bf16_f32 v85, v202, v203
    v_cvt_pk_bf16_f32 v86, v204, v205
    v_cvt_pk_bf16_f32 v87, v206, v207
    v_cndmask_b32 v86, v86, 0, s[96:97]
    v_cndmask_b32 v87, v87, 0, s[96:97]
    v_mfma_f32_32x32x16_bf16 v[192:207], v[64:67], v[80:83], 0
    s_nop 0
    v_mfma_f32_32x32x16_bf16 v[192:207], v[68:71], v[84:87], v[192:207]
    v_cvt_pk_bf16_f32 v88, v208, v209
    buffer_load_dwordx4 a[4:7], v1, s[28:31], s88 offen offset:1024 sc1
    v_cvt_pk_bf16_f32 v89, v210, v211
    v_cvt_pk_bf16_f32 v90, v212, v213
    v_cvt_pk_bf16_f32 v91, v214, v215
    v_cvt_pk_bf16_f32 v92, v216, v217
    v_cvt_pk_bf16_f32 v93, v218, v219
    v_cvt_pk_bf16_f32 v94, v220, v221
    v_cvt_pk_bf16_f32 v95, v222, v223
    v_cndmask_b32 v94, v94, 0, s[96:97]
    v_cndmask_b32 v95, v95, 0, s[96:97]
    v_mfma_f32_32x32x16_bf16 v[208:223], v[72:75], v[88:91], 0
    s_nop 0
    v_mfma_f32_32x32x16_bf16 v[208:223], v[76:79], v[92:95], v[208:223]
    v_cvt_pk_bf16_f32 v80, v224, v225
    v_cvt_pk_bf16_f32 v81, v226, v227
    buffer_load_dwordx4 a[8:11], v1, s[28:31], s88 offen offset:2048 sc1
    v_cvt_pk_bf16_f32 v82, v228, v229
    v_cvt_pk_bf16_f32 v83, v230, v231
    v_cvt_pk_bf16_f32 v84, v232, v233
    v_cvt_pk_bf16_f32 v85, v234, v235
    v_cvt_pk_bf16_f32 v86, v236, v237
    v_cvt_pk_bf16_f32 v87, v238, v239
    v_cndmask_b32 v86, v86, 0, s[96:97]
    v_cndmask_b32 v87, v87, 0, s[96:97]
    v_mfma_f32_32x32x16_bf16 v[224:239], v[64:67], v[80:83], 0
    s_nop 0
    v_mfma_f32_32x32x16_bf16 v[224:239], v[68:71], v[84:87], v[224:239]
    v_cvt_pk_bf16_f32 v88, v240, v241
    v_cvt_pk_bf16_f32 v89, v242, v243
    v_cvt_pk_bf16_f32 v90, v244, v245
    buffer_load_dwordx4 a[12:15], v1, s[28:31], s88 offen offset:3072 sc1
    v_cvt_pk_bf16_f32 v91, v246, v247
    v_cvt_pk_bf16_f32 v92, v248, v249
    v_cvt_pk_bf16_f32 v93, v250, v251
    v_cvt_pk_bf16_f32 v94, v252, v253
    v_cvt_pk_bf16_f32 v95, v254, v255
    v_cndmask_b32 v94, v94, 0, s[96:97]
    v_cndmask_b32 v95, v95, 0, s[96:97]
    v_mfma_f32_32x32x16_bf16 v[240:255], v[72:75], v[88:91], 0
    s_nop 0
    v_mfma_f32_32x32x16_bf16 v[240:255], v[76:79], v[92:95], v[240:255]
    v_mov_b32 v12, 0x7f800000
    v_mov_b32 v13, 0xff800000
    v_max3_f32 v96, v176, v177, v178
    v_min3_f32 v98, v176, v177, v178
    s_add_u32 s88, s57, 4096
    buffer_load_dwordx4 a[16:19], v1, s[28:31], s88 offen offset:0 sc1
    v_cndmask_b32 v188, v188, v176, s[96:97]
    v_cndmask_b32 v189, v189, v176, s[96:97]
    v_cndmask_b32 v190, v190, v176, s[96:97]
    v_cndmask_b32 v191, v191, v176, s[96:97]
    v_max3_f32 v96, v96, v179, v180
    v_min3_f32 v98, v98, v179, v180
    v_max3_f32 v96, v96, v181, v182
    v_min3_f32 v98, v98, v181, v182
    v_max3_f32 v96, v96, v183, v184
    v_min3_f32 v98, v98, v183, v184
    v_max3_f32 v96, v96, v185, v186
    v_min3_f32 v98, v98, v185, v186
    v_max3_f32 v96, v96, v187, v188
    buffer_load_dwordx4 a[20:23], v1, s[28:31], s88 offen offset:1024 sc1
    v_min3_f32 v98, v98, v187, v188
    v_max3_f32 v96, v96, v189, v190
    v_min3_f32 v98, v98, v189, v190
    v_max_f32 v96, v96, v191
    v_min_f32 v98, v98, v191
    v_mov_b32 v97, v96
    v_mov_b32 v99, v98
    s_nop 0
    v_permlane32_swap_b32 v96, v97
    v_permlane32_swap_b32 v98, v99
    v_max_f32 v96, v96, v97
    v_min_f32 v98, v98, v99
    v_mul_f32 v96, s91, v96
    v_mul_f32 v98, s91, v98
    buffer_load_dwordx4 a[24:27], v1, s[28:31], s88 offen offset:2048 sc1
    v_cndmask_b32 v100, v96, v12, s[96:97]
    v_cndmask_b32 v102, v98, v13, s[96:97]
    v_pk_fma_f32 v[112:113], v[176:177], s[50:51], v[98:99] op_sel_hi:[1,1,0] neg_lo:[1,0,0] neg_hi:[1,0,0]
    v_pk_fma_f32 v[176:177], v[176:177], s[50:51], v[96:97] op_sel_hi:[1,1,0] neg_lo:[0,0,1] neg_hi:[0,0,1]
    v_exp_f32 v112, v112
    v_pk_fma_f32 v[114:115], v[178:179], s[50:51], v[98:99] op_sel_hi:[1,1,0] neg_lo:[1,0,0] neg_hi:[1,0,0]
    v_exp_f32 v176, v176
    v_pk_fma_f32 v[178:179], v[178:179], s[50:51], v[96:97] op_sel_hi:[1,1,0] neg_lo:[0,0,1] neg_hi:[0,0,1]
    v_exp_f32 v113, v113
    v_exp_f32 v177, v177
    v_exp_f32 v114, v114
    v_pk_fma_f32 v[116:117], v[180:181], s[50:51], v[98:99] op_sel_hi:[1,1,0] neg_lo:[1,0,0] neg_hi:[1,0,0]
    v_exp_f32 v178, v178
    buffer_load_dwordx4 a[28:31], v1, s[28:31], s88 offen offset:3072 sc1
    v_pk_fma_f32 v[180:181], v[180:181], s[50:51], v[96:97] op_sel_hi:[1,1,0] neg_lo:[0,0,1] neg_hi:[0,0,1]
    v_exp_f32 v115, v115
    v_exp_f32 v179, v179
    v_exp_f32 v116, v116
    v_pk_fma_f32 v[118:119], v[182:183], s[50:51], v[98:99] op_sel_hi:[1,1,0] neg_lo:[1,0,0] neg_hi:[1,0,0]
    v_exp_f32 v180, v180
    v_pk_fma_f32 v[182:183], v[182:183], s[50:51], v[96:97] op_sel_hi:[1,1,0] neg_lo:[0,0,1] neg_hi:[0,0,1]
    v_exp_f32 v117, v117
    v_pk_add_f32 v[14:15], v[112:113], v[114:115]
    v_exp_f32 v181, v181
    v_pk_add_f32 v[12:13], v[176:177], v[178:179]
    v_exp_f32 v118, v118
    v_pk_fma_f32 v[120:121], v[184:185], s[50:51], v[98:99] op_sel_hi:[1,1,0] neg_lo:[1,0,0] neg_hi:[1,0,0]
    s_add_u32 s88, s57, 8192
    buffer_load_dwordx4 a[32:35], v1, s[28:31], s88 offen offset:0 sc1
    v_exp_f32 v182, v182
    v_pk_fma_f32 v[184:185], v[184:185], s[50:51], v[96:97] op_sel_hi:[1,1,0] neg_lo:[0,0,1] neg_hi:[0,0,1]
    v_exp_f32 v119, v119
    v_pk_add_f32 v[14:15], v[14:15], v[116:117]
    v_exp_f32 v183, v183
    v_pk_add_f32 v[12:13], v[12:13], v[180:181]
    v_exp_f32 v120, v120
    v_pk_fma_f32 v[122:123], v[186:187], s[50:51], v[98:99] op_sel_hi:[1,1,0] neg_lo:[1,0,0] neg_hi:[1,0,0]
    v_exp_f32 v184, v184
    v_pk_fma_f32 v[186:187], v[186:187], s[50:51], v[96:97] op_sel_hi:[1,1,0] neg_lo:[0,0,1] neg_hi:[0,0,1]
    v_exp_f32 v121, v121
    v_pk_add_f32 v[14:15], v[14:15], v[118:119]
    v_exp_f32 v185, v185
    buffer_load_dwordx4 a[36:39], v1, s[28:31], s88 offen offset:1024 sc1
    v_pk_add_f32 v[12:13], v[12:13], v[182:183]
    v_exp_f32 v122, v122
    v_pk_fma_f32 v[124:125], v[188:189], s[50:51], v[102:103] op_sel_hi:[1,1,0] neg_lo:[1,0,0] neg_hi:[1,0,0]
    v_exp_f32 v186, v186
    v_pk_fma_f32 v[188:189], v[188:189], s[50:51], v[100:101] op_sel_hi:[1,1,0] neg_lo:[0,0,1] neg_hi:[0,0,1]
    v_exp_f32 v123, v123
    v_pk_add_f32 v[14:15], v[14:15], v[120:121]
    v_exp_f32 v187, v187
    v_pk_add_f32 v[12:13], v[12:13], v[184:185]
    v_exp_f32 v124, v124
    v_pk_fma_f32 v[126:127], v[190:191], s[50:51], v[102:103] op_sel_hi:[1,1,0] neg_lo:[1,0,0] neg_hi:[1,0,0]
    v_exp_f32 v188, v188
    v_pk_fma_f32 v[190:191], v[190:191], s[50:51], v[100:101] op_sel_hi:[1,1,0] neg_lo:[0,0,1] neg_hi:[0,0,1]
    buffer_load_dwordx4 a[40:43], v1, s[28:31], s88 offen offset:2048 sc1
    v_exp_f32 v125, v125
    v_pk_add_f32 v[14:15], v[14:15], v[122:123]
    v_exp_f32 v189, v189
    v_pk_add_f32 v[12:13], v[12:13], v[186:187]
    v_exp_f32 v126, v126
    v_exp_f32 v190, v190
    v_exp_f32 v127, v127
    v_pk_add_f32 v[14:15], v[14:15], v[124:125]
    v_exp_f32 v191, v191
    v_pk_add_f32 v[12:13], v[12:13], v[188:189]
    v_pk_add_f32 v[14:15], v[14:15], v[126:127]
    v_pk_add_f32 v[12:13], v[12:13], v[190:191]
    v_add_f32 v14, v14, v15
    buffer_load_dwordx4 a[44:47], v1, s[28:31], s88 offen offset:3072 sc1
    v_add_f32 v12, v12, v13
    v_mov_b32 v15, v14
    v_mov_b32 v13, v12
    s_nop 0
    v_permlane32_swap_b32 v14, v15
    v_permlane32_swap_b32 v12, v13
    v_add_f32 v14, v14, v15
    v_add_f32 v59, v12, v13
    v_rcp_f32 v14, v14
    v_cvt_pk_bf16_f32 v176, v176, v177
    v_cvt_pk_bf16_f32 v177, v178, v179
    v_cvt_pk_bf16_f32 v178, v180, v181
    v_cvt_pk_bf16_f32 v179, v182, v183
    v_cvt_pk_bf16_f32 v180, v184, v185
    s_add_u32 s88, s57, 12288
    buffer_load_dwordx4 a[48:51], v1, s[28:31], s88 offen offset:0 sc1
    v_cvt_pk_bf16_f32 v181, v186, v187
    v_cvt_pk_bf16_f32 v182, v188, v189
    v_cvt_pk_bf16_f32 v183, v190, v191
    v_mul_f32 v14, v14, v59
    v_pk_mul_f32 v[112:113], v[112:113], v[14:15] op_sel_hi:[1,0]
    v_pk_mul_f32 v[114:115], v[114:115], v[14:15] op_sel_hi:[1,0]
    v_pk_mul_f32 v[116:117], v[116:117], v[14:15] op_sel_hi:[1,0]
    v_pk_mul_f32 v[118:119], v[118:119], v[14:15] op_sel_hi:[1,0]
    v_pk_mul_f32 v[120:121], v[120:121], v[14:15] op_sel_hi:[1,0]
    v_pk_mul_f32 v[122:123], v[122:123], v[14:15] op_sel_hi:[1,0]
    v_pk_mul_f32 v[124:125], v[124:125], v[14:15] op_sel_hi:[1,0]
    v_pk_mul_f32 v[126:127], v[126:127], v[14:15] op_sel_hi:[1,0]
    v_cvt_pk_bf16_f32 v184, v112, v113
    buffer_load_dwordx4 a[52:55], v1, s[28:31], s88 offen offset:1024 sc1
    v_cvt_pk_bf16_f32 v185, v114, v115
    v_cvt_pk_bf16_f32 v186, v116, v117
    v_cvt_pk_bf16_f32 v187, v118, v119
    v_cvt_pk_bf16_f32 v188, v120, v121
    v_cvt_pk_bf16_f32 v189, v122, v123
    v_cvt_pk_bf16_f32 v190, v124, v125
    v_cvt_pk_bf16_f32 v191, v126, v127
    v_mov_b32 v12, 0x7f800000
    v_mov_b32 v13, 0xff800000
    v_max3_f32 v96, v192, v193, v194
    v_min3_f32 v98, v192, v193, v194
    v_cndmask_b32 v204, v204, v192, s[96:97]
    v_cndmask_b32 v205, v205, v192, s[96:97]
    buffer_load_dwordx4 a[56:59], v1, s[28:31], s88 offen offset:2048 sc1
    v_cndmask_b32 v206, v206, v192, s[96:97]
    v_cndmask_b32 v207, v207, v192, s[96:97]
    v_max3_f32 v96, v96, v195, v196
    v_min3_f32 v98, v98, v195, v196
    v_max3_f32 v96, v96, v197, v198
    v_min3_f32 v98, v98, v197, v198
    v_max3_f32 v96, v96, v199, v200
    v_min3_f32 v98, v98, v199, v200
    v_max3_f32 v96, v96, v201, v202
    v_min3_f32 v98, v98, v201, v202
    v_max3_f32 v96, v96, v203, v204
    v_min3_f32 v98, v98, v203, v204
    v_max3_f32 v96, v96, v205, v206
    buffer_load_dwordx4 a[60:63], v1, s[28:31], s88 offen offset:3072 sc1
    v_min3_f32 v98, v98, v205, v206
    v_max_f32 v96, v96, v207
    v_min_f32 v98, v98, v207
    v_mov_b32 v97, v96
    v_mov_b32 v99, v98
    s_nop 0
    v_permlane32_swap_b32 v96, v97
    v_permlane32_swap_b32 v98, v99
    v_max_f32 v96, v96, v97
    v_min_f32 v98, v98, v99
    v_mul_f32 v96, s91, v96
    v_mul_f32 v98, s91, v98
    v_cndmask_b32 v100, v96, v12, s[96:97]
    v_cndmask_b32 v102, v98, v13, s[96:97]
    v_pk_fma_f32 v[112:113], v[192:193], s[50:51], v[98:99] op_sel_hi:[1,1,0] neg_lo:[1,0,0] neg_hi:[1,0,0]
    v_pk_fma_f32 v[192:193], v[192:193], s[50:51], v[96:97] op_sel_hi:[1,1,0] neg_lo:[0,0,1] neg_hi:[0,0,1]
    v_exp_f32 v112, v112
    v_pk_fma_f32 v[114:115], v[194:195], s[50:51], v[98:99] op_sel_hi:[1,1,0] neg_lo:[1,0,0] neg_hi:[1,0,0]
    v_exp_f32 v192, v192
    v_pk_fma_f32 v[194:195], v[194:195], s[50:51], v[96:97] op_sel_hi:[1,1,0] neg_lo:[0,0,1] neg_hi:[0,0,1]
    v_exp_f32 v113, v113
    v_exp_f32 v193, v193
    v_exp_f32 v114, v114
    v_pk_fma_f32 v[116:117], v[196:197], s[50:51], v[98:99] op_sel_hi:[1,1,0] neg_lo:[1,0,0] neg_hi:[1,0,0]
    v_exp_f32 v194, v194
    v_pk_fma_f32 v[196:197], v[196:197], s[50:51], v[96:97] op_sel_hi:[1,1,0] neg_lo:[0,0,1] neg_hi:[0,0,1]
    v_exp_f32 v115, v115
    v_exp_f32 v195, v195
    v_exp_f32 v116, v116
    v_pk_fma_f32 v[118:119], v[198:199], s[50:51], v[98:99] op_sel_hi:[1,1,0] neg_lo:[1,0,0] neg_hi:[1,0,0]
    v_exp_f32 v196, v196
    v_pk_fma_f32 v[198:199], v[198:199], s[50:51], v[96:97] op_sel_hi:[1,1,0] neg_lo:[0,0,1] neg_hi:[0,0,1]
    v_exp_f32 v117, v117
    v_pk_add_f32 v[14:15], v[112:113], v[114:115]
    v_exp_f32 v197, v197
    v_pk_add_f32 v[12:13], v[192:193], v[194:195]
    v_exp_f32 v118, v118
    v_pk_fma_f32 v[120:121], v[200:201], s[50:51], v[98:99] op_sel_hi:[1,1,0] neg_lo:[1,0,0] neg_hi:[1,0,0]
    v_exp_f32 v198, v198
    v_pk_fma_f32 v[200:201], v[200:201], s[50:51], v[96:97] op_sel_hi:[1,1,0] neg_lo:[0,0,1] neg_hi:[0,0,1]
    v_exp_f32 v119, v119
    v_pk_add_f32 v[14:15], v[14:15], v[116:117]
    v_exp_f32 v199, v199
    v_pk_add_f32 v[12:13], v[12:13], v[196:197]
    v_exp_f32 v120, v120
    v_pk_fma_f32 v[122:123], v[202:203], s[50:51], v[98:99] op_sel_hi:[1,1,0] neg_lo:[1,0,0] neg_hi:[1,0,0]
    v_exp_f32 v200, v200
    v_pk_fma_f32 v[202:203], v[202:203], s[50:51], v[96:97] op_sel_hi:[1,1,0] neg_lo:[0,0,1] neg_hi:[0,0,1]
    v_exp_f32 v121, v121
    v_pk_add_f32 v[14:15], v[14:15], v[118:119]
    v_exp_f32 v201, v201
    v_pk_add_f32 v[12:13], v[12:13], v[198:199]
    v_exp_f32 v122, v122
    v_pk_fma_f32 v[124:125], v[204:205], s[50:51], v[102:103] op_sel_hi:[1,1,0] neg_lo:[1,0,0] neg_hi:[1,0,0]
    v_exp_f32 v202, v202
    v_pk_fma_f32 v[204:205], v[204:205], s[50:51], v[100:101] op_sel_hi:[1,1,0] neg_lo:[0,0,1] neg_hi:[0,0,1]
    v_exp_f32 v123, v123
    v_pk_add_f32 v[14:15], v[14:15], v[120:121]
    v_exp_f32 v203, v203
    v_pk_add_f32 v[12:13], v[12:13], v[200:201]
    v_exp_f32 v124, v124
    v_pk_fma_f32 v[126:127], v[206:207], s[50:51], v[102:103] op_sel_hi:[1,1,0] neg_lo:[1,0,0] neg_hi:[1,0,0]
    v_exp_f32 v204, v204
    v_pk_fma_f32 v[206:207], v[206:207], s[50:51], v[100:101] op_sel_hi:[1,1,0] neg_lo:[0,0,1] neg_hi:[0,0,1]
    v_exp_f32 v125, v125
    v_pk_add_f32 v[14:15], v[14:15], v[122:123]
    v_exp_f32 v205, v205
    v_pk_add_f32 v[12:13], v[12:13], v[202:203]
    v_exp_f32 v126, v126
    v_exp_f32 v206, v206
    v_exp_f32 v127, v127
    v_pk_add_f32 v[14:15], v[14:15], v[124:125]
    v_exp_f32 v207, v207
    v_pk_add_f32 v[12:13], v[12:13], v[204:205]
    v_pk_add_f32 v[14:15], v[14:15], v[126:127]
    v_pk_add_f32 v[12:13], v[12:13], v[206:207]
    v_add_f32 v14, v14, v15
    v_add_f32 v12, v12, v13
    v_mov_b32 v15, v14
    v_mov_b32 v13, v12
    s_nop 0
    v_permlane32_swap_b32 v14, v15
    v_permlane32_swap_b32 v12, v13
    v_add_f32 v14, v14, v15
    v_add_f32 v60, v12, v13
    v_rcp_f32 v14, v14
    v_cvt_pk_bf16_f32 v192, v192, v193
    v_cvt_pk_bf16_f32 v193, v194, v195
    v_cvt_pk_bf16_f32 v194, v196, v197
    v_cvt_pk_bf16_f32 v195, v198, v199
    v_cvt_pk_bf16_f32 v196, v200, v201
    v_cvt_pk_bf16_f32 v197, v202, v203
    v_cvt_pk_bf16_f32 v198, v204, v205
    v_cvt_pk_bf16_f32 v199, v206, v207
    v_mul_f32 v14, v14, v60
    v_pk_mul_f32 v[112:113], v[112:113], v[14:15] op_sel_hi:[1,0]
    v_pk_mul_f32 v[114:115], v[114:115], v[14:15] op_sel_hi:[1,0]
    v_pk_mul_f32 v[116:117], v[116:117], v[14:15] op_sel_hi:[1,0]
    v_pk_mul_f32 v[118:119], v[118:119], v[14:15] op_sel_hi:[1,0]
    v_pk_mul_f32 v[120:121], v[120:121], v[14:15] op_sel_hi:[1,0]
    v_pk_mul_f32 v[122:123], v[122:123], v[14:15] op_sel_hi:[1,0]
    v_pk_mul_f32 v[124:125], v[124:125], v[14:15] op_sel_hi:[1,0]
    v_pk_mul_f32 v[126:127], v[126:127], v[14:15] op_sel_hi:[1,0]
    v_cvt_pk_bf16_f32 v200, v112, v113
    v_cvt_pk_bf16_f32 v201, v114, v115
    v_cvt_pk_bf16_f32 v202, v116, v117
    v_cvt_pk_bf16_f32 v203, v118, v119
    v_cvt_pk_bf16_f32 v204, v120, v121
    v_cvt_pk_bf16_f32 v205, v122, v123
    v_cvt_pk_bf16_f32 v206, v124, v125
    v_cvt_pk_bf16_f32 v207, v126, v127
    s_mov_b32 s92, 0x4000
    s_branch Lq_rchk
Lq_rtry:
    s_add_u32 s88, s57, 0
    buffer_load_dwordx4 a[0:3], v1, s[28:31], s88 offen offset:0 sc1
    buffer_load_dwordx4 a[4:7], v1, s[28:31], s88 offen offset:1024 sc1
    buffer_load_dwordx4 a[8:11], v1, s[28:31], s88 offen offset:2048 sc1
    buffer_load_dwordx4 a[12:15], v1, s[28:31], s88 offen offset:3072 sc1
    s_add_u32 s88, s57, 4096
    buffer_load_dwordx4 a[16:19], v1, s[28:31], s88 offen offset:0 sc1
    buffer_load_dwordx4 a[20:23], v1, s[28:31], s88 offen offset:1024 sc1
    buffer_load_dwordx4 a[24:27], v1, s[28:31], s88 offen offset:2048 sc1
    buffer_load_dwordx4 a[28:31], v1, s[28:31], s88 offen offset:3072 sc1
    s_add_u32 s88, s57, 8192
    buffer_load_dwordx4 a[32:35], v1, s[28:31], s88 offen offset:0 sc1
    buffer_load_dwordx4 a[36:39], v1, s[28:31], s88 offen offset:1024 sc1
    buffer_load_dwordx4 a[40:43], v1, s[28:31], s88 offen offset:2048 sc1
    buffer_load_dwordx4 a[44:47], v1, s[28:31], s88 offen offset:3072 sc1
    s_add_u32 s88, s57, 12288
    buffer_load_dwordx4 a[48:51], v1, s[28:31], s88 offen offset:0 sc1
    buffer_load_dwordx4 a[52:55], v1, s[28:31], s88 offen offset:1024 sc1
    buffer_load_dwordx4 a[56:59], v1, s[28:31], s88 offen offset:2048 sc1
    buffer_load_dwordx4 a[60:63], v1, s[28:31], s88 offen offset:3072 sc1
Lq_rchk:
    s_waitcnt vmcnt(0)
    v_accvgpr_read_b32 v64, a0
    v_accvgpr_read_b32 v65, a1
    v_accvgpr_read_b32 v66, a2
    v_accvgpr_read_b32 v67, a3
    v_accvgpr_read_b32 v68, a4
    v_accvgpr_read_b32 v69, a5
    v_accvgpr_read_b32 v70, a6
    v_accvgpr_read_b32 v71, a7
    v_accvgpr_read_b32 v72, a8
    v_accvgpr_read_b32 v73, a9
    v_accvgpr_read_b32 v74, a10
    v_accvgpr_read_b32 v75, a11
    v_accvgpr_read_b32 v76, a12
    v_accvgpr_read_b32 v77, a13
    v_accvgpr_read_b32 v78, a14
    v_accvgpr_read_b32 v79, a15
    v_accvgpr_read_b32 v80, a16
    v_accvgpr_read_b32 v81, a17
    v_accvgpr_read_b32 v82, a18
    v_accvgpr_read_b32 v83, a19
    v_accvgpr_read_b32 v84, a20
    v_accvgpr_read_b32 v85, a21
    v_accvgpr_read_b32 v86, a22
    v_accvgpr_read_b32 v87, a23
    v_accvgpr_read_b32 v88, a24
    v_accvgpr_read_b32 v89, a25
    v_accvgpr_read_b32 v90, a26
    v_accvgpr_read_b32 v91, a27
    v_accvgpr_read_b32 v92, a28
    v_accvgpr_read_b32 v93, a29
    v_accvgpr_read_b32 v94, a30
    v_accvgpr_read_b32 v95, a31
    v_accvgpr_read_b32 v96, a32
    v_accvgpr_read_b32 v97, a33
    v_accvgpr_read_b32 v98, a34
    v_accvgpr_read_b32 v99, a35
    v_accvgpr_read_b32 v100, a36
    v_accvgpr_read_b32 v101, a37
    v_accvgpr_read_b32 v102, a38
    v_accvgpr_read_b32 v103, a39
    v_accvgpr_read_b32 v104, a40
    v_accvgpr_read_b32 v105, a41
    v_accvgpr_read_b32 v106, a42
    v_accvgpr_read_b32 v107, a43
    v_accvgpr_read_b32 v108, a44
    v_accvgpr_read_b32 v109, a45
    v_accvgpr_read_b32 v110, a46
    v_accvgpr_read_b32 v111, a47
    v_accvgpr_read_b32 v112, a48
    v_accvgpr_read_b32 v113, a49
    v_accvgpr_read_b32 v114, a50
    v_accvgpr_read_b32 v115, a51
    v_accvgpr_read_b32 v116, a52
    v_accvgpr_read_b32 v117, a53
    v_accvgpr_read_b32 v118, a54
    v_accvgpr_read_b32 v119, a55
    v_accvgpr_read_b32 v120, a56
    v_accvgpr_read_b32 v121, a57
    v_accvgpr_read_b32 v122, a58
    v_accvgpr_read_b32 v123, a59
    v_accvgpr_read_b32 v124, a60
    v_accvgpr_read_b32 v125, a61
    v_accvgpr_read_b32 v126, a62
    v_accvgpr_read_b32 v127, a63
    v_xor_b32 v64, v64, v24
    v_xor_b32 v68, v68, v24
    v_xor_b32 v72, v72, v24
    v_xor_b32 v76, v76, v24
    v_xor_b32 v80, v80, v24
    v_xor_b32 v84, v84, v24
    v_xor_b32 v88, v88, v24
    v_xor_b32 v92, v92, v24
    v_xor_b32 v96, v96, v24
    v_xor_b32 v100, v100, v24
    v_xor_b32 v104, v104, v24
    v_xor_b32 v108, v108, v24
    v_xor_b32 v112, v112, v24
    v_xor_b32 v116, v116, v24
    v_xor_b32 v120, v120, v24
    v_xor_b32 v124, v124, v24
    v_or_b32 v28, v64, v68
    v_or3_b32 v28, v28, v72, v76
    v_or3_b32 v28, v28, v80, v84
    v_or3_b32 v28, v28, v88, v92
    v_or3_b32 v28, v28, v96, v100
    v_or3_b32 v28, v28, v104, v108
    v_or3_b32 v28, v28, v112, v116
    v_or3_b32 v28, v28, v120, v124
    s_nop 0
    v_and_b32 v28, 0xff, v28
    v_cmp_ne_u32 vcc, 0, v28
    s_sub_u32 s92, s92, 1
    s_cselect_b64 vcc, 0, vcc
    s_nop 0
    s_cbranch_vccnz Lq_rtry
    v_pk_add_f32 v[64:65], v[64:65], v[96:97]
    v_pk_add_f32 v[66:67], v[66:67], v[98:99]
    v_pk_add_f32 v[68:69], v[68:69], v[100:101]
    v_pk_add_f32 v[70:71], v[70:71], v[102:103]
    v_pk_add_f32 v[72:73], v[72:73], v[104:105]
    v_pk_add_f32 v[74:75], v[74:75], v[106:107]
    v_pk_add_f32 v[76:77], v[76:77], v[108:109]
    v_pk_add_f32 v[78:79], v[78:79], v[110:111]
    v_pk_add_f32 v[80:81], v[80:81], v[112:113]
    v_pk_add_f32 v[82:83], v[82:83], v[114:115]
    v_pk_add_f32 v[84:85], v[84:85], v[116:117]
    v_pk_add_f32 v[86:87], v[86:87], v[118:119]
    v_pk_add_f32 v[88:89], v[88:89], v[120:121]
    v_pk_add_f32 v[90:91], v[90:91], v[122:123]
    v_pk_add_f32 v[92:93], v[92:93], v[124:125]
    v_pk_add_f32 v[94:95], v[94:95], v[126:127]
    v_pk_add_f32 v[64:65], v[64:65], v[80:81]
    v_pk_add_f32 v[66:67], v[66:67], v[82:83]
    v_pk_add_f32 v[68:69], v[68:69], v[84:85]
    v_pk_add_f32 v[70:71], v[70:71], v[86:87]
    v_pk_add_f32 v[72:73], v[72:73], v[88:89]
    v_pk_add_f32 v[74:75], v[74:75], v[90:91]
    v_pk_add_f32 v[76:77], v[76:77], v[92:93]
    v_pk_add_f32 v[78:79], v[78:79], v[94:95]
    v_pk_add_f32 v[64:65], v[64:65], v[72:73]
    v_pk_add_f32 v[66:67], v[66:67], v[74:75]
    v_pk_add_f32 v[68:69], v[68:69], v[76:77]
    v_pk_add_f32 v[70:71], v[70:71], v[78:79]
    v_pk_add_f32 v[64:65], v[64:65], v[68:69]
    v_pk_add_f32 v[66:67], v[66:67], v[70:71]
    s_movk_i32 s87, 0xff
    v_bfi_b32 v64, s87, v24, v64
    s_lshl_b32 s88, s85, 12
    s_lshl_b32 s89, s72, 10
    s_add_u32 s88, s88, s89
    s_add_u32 s88, s88, 12582912
    buffer_store_dwordx4 v[64:67], v1, s[28:31], s88 offen sc1
    s_lshl_b32 s88, s93, 16
    s_lshl_b32 s89, s72, 14
    s_add_u32 s88, s88, s89
    s_add_u32 s57, s88, 12582912
    s_lshl_b32 s60, s76, 10
    s_add_u32 s60, s60, 4096
    s_cmp_eq_u32 s75, 0
    s_cbranch_scc1 Lq_nf
    v_mov_b32 v15, s79
    s_mov_b64 exec, 0xf
    buffer_store_dword v15, v19, s[28:31], s59 offen sc1
    s_mov_b64 exec, -1
Lq_nf:
    v_mov_b32 v12, 0x7f800000
    v_mov_b32 v13, 0xff800000
    v_max3_f32 v96, v208, v209, v210
    v_min3_f32 v98, v208, v209, v210
    v_cndmask_b32 v220, v220, v208, s[96:97]
    v_cndmask_b32 v221, v221, v208, s[96:97]
    v_cndmask_b32 v222, v222, v208, s[96:97]
    v_cndmask_b32 v223, v223, v208, s[96:97]
    v_max3_f32 v96, v96, v211, v212
    v_min3_f32 v98, v98, v211, v212
    v_max3_f32 v96, v96, v213, v214
    v_min3_f32 v98, v98, v213, v214
    v_max3_f32 v96, v96, v215, v216
    v_min3_f32 v98, v98, v215, v216
    v_max3_f32 v96, v96, v217, v218
    v_min3_f32 v98, v98, v217, v218
    v_max3_f32 v96, v96, v219, v220
    v_min3_f32 v98, v98, v219, v220
    v_max3_f32 v96, v96, v221, v222
    v_min3_f32 v98, v98, v221, v222
    v_max_f32 v96, v96, v223
    v_min_f32 v98, v98, v223
    v_mov_b32 v97, v96
    v_mov_b32 v99, v98
    s_nop 0
    v_permlane32_swap_b32 v96, v97
    v_permlane32_swap_b32 v98, v99
    v_max_f32 v96, v96, v97
    v_min_f32 v98, v98, v99
    v_mul_f32 v96, s91, v96
    v_mul_f32 v98, s91, v98
    v_cndmask_b32 v100, v96, v12, s[96:97]
    v_cndmask_b32 v102, v98, v13, s[96:97]
    v_pk_fma_f32 v[112:113], v[208:209], s[50:51], v[98:99] op_sel_hi:[1,1,0] neg_lo:[1,0,0] neg_hi:[1,0,0]
    v_pk_fma_f32 v[208:209], v[208:209], s[50:51], v[96:97] op_sel_hi:[1,1,0] neg_lo:[0,0,1] neg_hi:[0,0,1]
    v_exp_f32 v112, v112
    v_pk_fma_f32 v[114:115], v[210:211], s[50:51], v[98:99] op_sel_hi:[1,1,0] neg_lo:[1,0,0] neg_hi:[1,0,0]
    v_exp_f32 v208, v208
    v_pk_fma_f32 v[210:211], v[210:211], s[50:51], v[96:97] op_sel_hi:[1,1,0] neg_lo:[0,0,1] neg_hi:[0,0,1]
    v_exp_f32 v113, v113
    v_exp_f32 v209, v209
    v_exp_f32 v114, v114
    v_pk_fma_f32 v[116:117], v[212:213], s[50:51], v[98:99] op_sel_hi:[1,1,0] neg_lo:[1,0,0] neg_hi:[1,0,0]
    v_exp_f32 v210, v210
    v_pk_fma_f32 v[212:213], v[212:213], s[50:51], v[96:97] op_sel_hi:[1,1,0] neg_lo:[0,0,1] neg_hi:[0,0,1]
    v_exp_f32 v115, v115
    v_exp_f32 v211, v211
    v_exp_f32 v116, v116
    v_pk_fma_f32 v[118:119], v[214:215], s[50:51], v[98:99] op_sel_hi:[1,1,0] neg_lo:[1,0,0] neg_hi:[1,0,0]
    v_exp_f32 v212, v212
    v_pk_fma_f32 v[214:215], v[214:215], s[50:51], v[96:97] op_sel_hi:[1,1,0] neg_lo:[0,0,1] neg_hi:[0,0,1]
    v_exp_f32 v117, v117
    v_pk_add_f32 v[14:15], v[112:113], v[114:115]
    v_exp_f32 v213, v213
    v_pk_add_f32 v[12:13], v[208:209], v[210:211]
    v_exp_f32 v118, v118
    v_pk_fma_f32 v[120:121], v[216:217], s[50:51], v[98:99] op_sel_hi:[1,1,0] neg_lo:[1,0,0] neg_hi:[1,0,0]
    v_exp_f32 v214, v214
    v_pk_fma_f32 v[216:217], v[216:217], s[50:51], v[96:97] op_sel_hi:[1,1,0] neg_lo:[0,0,1] neg_hi:[0,0,1]
    v_exp_f32 v119, v119
    v_pk_add_f32 v[14:15], v[14:15], v[116:117]
    v_exp_f32 v215, v215
    v_pk_add_f32 v[12:13], v[12:13], v[212:213]
    v_exp_f32 v120, v120
    v_pk_fma_f32 v[122:123], v[218:219], s[50:51], v[98:99] op_sel_hi:[1,1,0] neg_lo:[1,0,0] neg_hi:[1,0,0]
    v_exp_f32 v216, v216
    v_pk_fma_f32 v[218:219], v[218:219], s[50:51], v[96:97] op_sel_hi:[1,1,0] neg_lo:[0,0,1] neg_hi:[0,0,1]
    v_exp_f32 v121, v121
    v_pk_add_f32 v[14:15], v[14:15], v[118:119]
    v_exp_f32 v217, v217
    v_pk_add_f32 v[12:13], v[12:13], v[214:215]
    v_exp_f32 v122, v122
    v_pk_fma_f32 v[124:125], v[220:221], s[50:51], v[102:103] op_sel_hi:[1,1,0] neg_lo:[1,0,0] neg_hi:[1,0,0]
    v_exp_f32 v218, v218
    v_pk_fma_f32 v[220:221], v[220:221], s[50:51], v[100:101] op_sel_hi:[1,1,0] neg_lo:[0,0,1] neg_hi:[0,0,1]
    v_exp_f32 v123, v123
    v_pk_add_f32 v[14:15], v[14:15], v[120:121]
    v_exp_f32 v219, v219
    v_pk_add_f32 v[12:13], v[12:13], v[216:217]
    v_exp_f32 v124, v124
    v_pk_fma_f32 v[126:127], v[222:223], s[50:51], v[102:103] op_sel_hi:[1,1,0] neg_lo:[1,0,0] neg_hi:[1,0,0]
    v_exp_f32 v220, v220
    v_pk_fma_f32 v[222:223], v[222:223], s[50:51], v[100:101] op_sel_hi:[1,1,0] neg_lo:[0,0,1] neg_hi:[0,0,1]
    v_exp_f32 v125, v125
    v_pk_add_f32 v[14:15], v[14:15], v[122:123]
    v_exp_f32 v221, v221
    v_pk_add_f32 v[12:13], v[12:13], v[218:219]
    v_exp_f32 v126, v126
    v_exp_f32 v222, v222
    v_exp_f32 v127, v127
    v_pk_add_f32 v[14:15], v[14:15], v[124:125]
    v_exp_f32 v223, v223
    v_pk_add_f32 v[12:13], v[12:13], v[220:221]
    v_pk_add_f32 v[14:15], v[14:15], v[126:127]
    v_pk_add_f32 v[12:13], v[12:13], v[222:223]
    v_add_f32 v14, v14, v15
    v_add_f32 v12, v12, v13
    v_mov_b32 v15, v14
    v_mov_b32 v13, v12
    s_nop 0
    v_permlane32_swap_b32 v14, v15
    v_permlane32_swap_b32 v12, v13
    v_add_f32 v14, v14, v15
    v_add_f32 v61, v12, v13
    v_rcp_f32 v14, v14
    v_cvt_pk_bf16_f32 v208, v208, v209
    v_cvt_pk_bf16_f32 v209, v210, v211
    v_cvt_pk_bf16_f32 v210, v212, v213
    v_cvt_pk_bf16_f32 v211, v214, v215
    v_cvt_pk_bf16_f32 v212, v216, v217
    v_cvt_pk_bf16_f32 v213, v218, v219
    v_cvt_pk_bf16_f32 v214, v220, v221
    v_cvt_pk_bf16_f32 v215, v222, v223
    v_mul_f32 v14, v14, v61
    v_pk_mul_f32 v[112:113], v[112:113], v[14:15] op_sel_hi:[1,0]
    v_pk_mul_f32 v[114:115], v[114:115], v[14:15] op_sel_hi:[1,0]
    v_pk_mul_f32 v[116:117], v[116:117], v[14:15] op_sel_hi:[1,0]
    v_pk_mul_f32 v[118:119], v[118:119], v[14:15] op_sel_hi:[1,0]
    v_pk_mul_f32 v[120:121], v[120:121], v[14:15] op_sel_hi:[1,0]
    v_pk_mul_f32 v[122:123], v[122:123], v[14:15] op_sel_hi:[1,0]
    v_pk_mul_f32 v[124:125], v[124:125], v[14:15] op_sel_hi:[1,0]
    v_pk_mul_f32 v[126:127], v[126:127], v[14:15] op_sel_hi:[1,0]
    v_cvt_pk_bf16_f32 v216, v112, v113
    v_cvt_pk_bf16_f32 v217, v114, v115
    v_cvt_pk_bf16_f32 v218, v116, v117
    v_cvt_pk_bf16_f32 v219, v118, v119
    v_cvt_pk_bf16_f32 v220, v120, v121
    v_cvt_pk_bf16_f32 v221, v122, v123
    v_cvt_pk_bf16_f32 v222, v124, v125
    v_cvt_pk_bf16_f32 v223, v126, v127
    v_mov_b32 v12, 0x7f800000
    v_mov_b32 v13, 0xff800000
    v_max3_f32 v96, v224, v225, v226
    v_min3_f32 v98, v224, v225, v226
    v_cndmask_b32 v236, v236, v224, s[96:97]
    v_cndmask_b32 v237, v237, v224, s[96:97]
    v_cndmask_b32 v238, v238, v224, s[96:97]
    v_cndmask_b32 v239, v239, v224, s[96:97]
    v_max3_f32 v96, v96, v227, v228
    v_min3_f32 v98, v98, v227, v228
    v_max3_f32 v96, v96, v229, v230
    v_min3_f32 v98, v98, v229, v230
    v_max3_f32 v96, v96, v231, v232
    v_min3_f32 v98, v98, v231, v232
    v_max3_f32 v96, v96, v233, v234
    v_min3_f32 v98, v98, v233, v234
    v_max3_f32 v96, v96, v235, v236
    v_min3_f32 v98, v98, v235, v236
    v_max3_f32 v96, v96, v237, v238
    v_min3_f32 v98, v98, v237, v238
    v_max_f32 v96, v96, v239
    v_min_f32 v98, v98, v239
    v_mov_b32 v97, v96
    v_mov_b32 v99, v98
    s_nop 0
    v_permlane32_swap_b32 v96, v97
    v_permlane32_swap_b32 v98, v99
    v_max_f32 v96, v96, v97
    v_min_f32 v98, v98, v99
    v_mul_f32 v96, s91, v96
    v_mul_f32 v98, s91, v98
    v_cndmask_b32 v100, v96, v12, s[96:97]
    v_cndmask_b32 v102, v98, v13, s[96:97]
    v_pk_fma_f32 v[112:113], v[224:225], s[50:51], v[98:99] op_sel_hi:[1,1,0] neg_lo:[1,0,0] neg_hi:[1,0,0]
    v_pk_fma_f32 v[224:225], v[224:225], s[50:51], v[96:97] op_sel_hi:[1,1,0] neg_lo:[0,0,1] neg_hi:[0,0,1]
    v_exp_f32 v112, v112
    v_pk_fma_f32 v[114:115], v[226:227], s[50:51], v[98:99] op_sel_hi:[1,1,0] neg_lo:[1,0,0] neg_hi:[1,0,0]
    v_exp_f32 v224, v224
    v_pk_fma_f32 v[226:227], v[226:227], s[50:51], v[96:97] op_sel_hi:[1,1,0] neg_lo:[0,0,1] neg_hi:[0,0,1]
    v_exp_f32 v113, v113
    v_exp_f32 v225, v225
    v_exp_f32 v114, v114
    v_pk_fma_f32 v[116:117], v[228:229], s[50:51], v[98:99] op_sel_hi:[1,1,0] neg_lo:[1,0,0] neg_hi:[1,0,0]
    v_exp_f32 v226, v226
    v_pk_fma_f32 v[228:229], v[228:229], s[50:51], v[96:97] op_sel_hi:[1,1,0] neg_lo:[0,0,1] neg_hi:[0,0,1]
    v_exp_f32 v115, v115
    v_exp_f32 v227, v227
    v_exp_f32 v116, v116
    v_pk_fma_f32 v[118:119], v[230:231], s[50:51], v[98:99] op_sel_hi:[1,1,0] neg_lo:[1,0,0] neg_hi:[1,0,0]
    v_exp_f32 v228, v228
    v_pk_fma_f32 v[230:231], v[230:231], s[50:51], v[96:97] op_sel_hi:[1,1,0] neg_lo:[0,0,1] neg_hi:[0,0,1]
    v_exp_f32 v117, v117
    v_pk_add_f32 v[14:15], v[112:113], v[114:115]
    v_exp_f32 v229, v229
    v_pk_add_f32 v[12:13], v[224:225], v[226:227]
    v_exp_f32 v118, v118
    v_pk_fma_f32 v[120:121], v[232:233], s[50:51], v[98:99] op_sel_hi:[1,1,0] neg_lo:[1,0,0] neg_hi:[1,0,0]
    v_exp_f32 v230, v230
    v_pk_fma_f32 v[232:233], v[232:233], s[50:51], v[96:97] op_sel_hi:[1,1,0] neg_lo:[0,0,1] neg_hi:[0,0,1]
    v_exp_f32 v119, v119
    v_pk_add_f32 v[14:15], v[14:15], v[116:117]
    v_exp_f32 v231, v231
    v_pk_add_f32 v[12:13], v[12:13], v[228:229]
    v_exp_f32 v120, v120
    v_pk_fma_f32 v[122:123], v[234:235], s[50:51], v[98:99] op_sel_hi:[1,1,0] neg_lo:[1,0,0] neg_hi:[1,0,0]
    v_exp_f32 v232, v232
    v_pk_fma_f32 v[234:235], v[234:235], s[50:51], v[96:97] op_sel_hi:[1,1,0] neg_lo:[0,0,1] neg_hi:[0,0,1]
    v_exp_f32 v121, v121
    v_pk_add_f32 v[14:15], v[14:15], v[118:119]
    v_exp_f32 v233, v233
    v_pk_add_f32 v[12:13], v[12:13], v[230:231]
    v_exp_f32 v122, v122
    v_pk_fma_f32 v[124:125], v[236:237], s[50:51], v[102:103] op_sel_hi:[1,1,0] neg_lo:[1,0,0] neg_hi:[1,0,0]
    v_exp_f32 v234, v234
    v_pk_fma_f32 v[236:237], v[236:237], s[50:51], v[100:101] op_sel_hi:[1,1,0] neg_lo:[0,0,1] neg_hi:[0,0,1]
    v_exp_f32 v123, v123
    v_pk_add_f32 v[14:15], v[14:15], v[120:121]
    v_exp_f32 v235, v235
    v_pk_add_f32 v[12:13], v[12:13], v[232:233]
    v_exp_f32 v124, v124
    v_pk_fma_f32 v[126:127], v[238:239], s[50:51], v[102:103] op_sel_hi:[1,1,0] neg_lo:[1,0,0] neg_hi:[1,0,0]
    v_exp_f32 v236, v236
    v_pk_fma_f32 v[238:239], v[238:239], s[50:51], v[100:101] op_sel_hi:[1,1,0] neg_lo:[0,0,1] neg_hi:[0,0,1]
    v_exp_f32 v125, v125
    v_pk_add_f32 v[14:15], v[14:15], v[122:123]
    v_exp_f32 v237, v237
    v_pk_add_f32 v[12:13], v[12:13], v[234:235]
    v_exp_f32 v126, v126
    v_exp_f32 v238, v238
    v_exp_f32 v127, v127
    v_pk_add_f32 v[14:15], v[14:15], v[124:125]
    v_exp_f32 v239, v239
    v_pk_add_f32 v[12:13], v[12:13], v[236:237]
    v_pk_add_f32 v[14:15], v[14:15], v[126:127]
    v_pk_add_f32 v[12:13], v[12:13], v[238:239]
    v_add_f32 v14, v14, v15
    v_add_f32 v12, v12, v13
    v_mov_b32 v15, v14
    v_mov_b32 v13, v12
    s_nop 0
    v_permlane32_swap_b32 v14, v15
    v_permlane32_swap_b32 v12, v13
    v_add_f32 v14, v14, v15
    v_add_f32 v62, v12, v13
    v_rcp_f32 v14, v14
    v_cvt_pk_bf16_f32 v224, v224, v225
    v_cvt_pk_bf16_f32 v225, v226, v227
    v_cvt_pk_bf16_f32 v226, v228, v229
    v_cvt_pk_bf16_f32 v227, v230, v231
    v_cvt_pk_bf16_f32 v228, v232, v233
    v_cvt_pk_bf16_f32 v229, v234, v235
    v_cvt_pk_bf16_f32 v230, v236, v237
    v_cvt_pk_bf16_f32 v231, v238, v239
    v_mul_f32 v14, v14, v62
    v_pk_mul_f32 v[112:113], v[112:113], v[14:15] op_sel_hi:[1,0]
    v_pk_mul_f32 v[114:115], v[114:115], v[14:15] op_sel_hi:[1,0]
    v_pk_mul_f32 v[116:117], v[116:117], v[14:15] op_sel_hi:[1,0]
    v_pk_mul_f32 v[118:119], v[118:119], v[14:15] op_sel_hi:[1,0]
    v_pk_mul_f32 v[120:121], v[120:121], v[14:15] op_sel_hi:[1,0]
    v_pk_mul_f32 v[122:123], v[122:123], v[14:15] op_sel_hi:[1,0]
    v_pk_mul_f32 v[124:125], v[124:125], v[14:15] op_sel_hi:[1,0]
    v_pk_mul_f32 v[126:127], v[126:127], v[14:15] op_sel_hi:[1,0]
    v_cvt_pk_bf16_f32 v232, v112, v113
    v_cvt_pk_bf16_f32 v233, v114, v115
    v_cvt_pk_bf16_f32 v234, v116, v117
    v_cvt_pk_bf16_f32 v235, v118, v119
    v_cvt_pk_bf16_f32 v236, v120, v121
    v_cvt_pk_bf16_f32 v237, v122, v123
    v_cvt_pk_bf16_f32 v238, v124, v125
    v_cvt_pk_bf16_f32 v239, v126, v127
    buffer_load_dword v18, v17, s[28:31], s60 offen sc1
    s_add_u32 s88, s57, 0
    buffer_load_dwordx4 a[0:3], v1, s[28:31], s88 offen offset:0 sc1
    v_mov_b32 v12, 0x7f800000
    v_mov_b32 v13, 0xff800000
    v_max3_f32 v96, v240, v241, v242
    v_min3_f32 v98, v240, v241, v242
    v_cndmask_b32 v252, v252, v240, s[96:97]
    buffer_load_dwordx4 a[4:7], v1, s[28:31], s88 offen offset:1024 sc1
    v_cndmask_b32 v253, v253, v240, s[96:97]
    v_cndmask_b32 v254, v254, v240, s[96:97]
    v_cndmask_b32 v255, v255, v240, s[96:97]
    v_max3_f32 v96, v96, v243, v244
    v_min3_f32 v98, v98, v243, v244
    buffer_load_dwordx4 a[8:11], v1, s[28:31], s88 offen offset:2048 sc1
    v_max3_f32 v96, v96, v245, v246
    v_min3_f32 v98, v98, v245, v246
    v_max3_f32 v96, v96, v247, v248
    v_min3_f32 v98, v98, v247, v248
    v_max3_f32 v96, v96, v249, v250
    buffer_load_dwordx4 a[12:15], v1, s[28:31], s88 offen offset:3072 sc1
    v_min3_f32 v98, v98, v249, v250
    v_max3_f32 v96, v96, v251, v252
    v_min3_f32 v98, v98, v251, v252
    v_max3_f32 v96, v96, v253, v254
    v_min3_f32 v98, v98, v253, v254
    s_add_u32 s88, s57, 4096
    buffer_load_dwordx4 a[16:19], v1, s[28:31], s88 offen offset:0 sc1
    v_max_f32 v96, v96, v255
    v_min_f32 v98, v98, v255
    v_mov_b32 v97, v96
    v_mov_b32 v99, v98
    s_nop 0
    v_permlane32_swap_b32 v96, v97
    buffer_load_dwordx4 a[20:23], v1, s[28:31], s88 offen offset:1024 sc1
    v_permlane32_swap_b32 v98, v99
    v_max_f32 v96, v96, v97
    v_min_f32 v98, v98, v99
    v_mul_f32 v96, s91, v96
    v_mul_f32 v98, s91, v98
    buffer_load_dwordx4 a[24:27], v1, s[28:31], s88 offen offset:2048 sc1
    v_cndmask_b32 v100, v96, v12, s[96:97]
    v_cndmask_b32 v102, v98, v13, s[96:97]
    v_pk_fma_f32 v[112:113], v[240:241], s[50:51], v[98:99] op_sel_hi:[1,1,0] neg_lo:[1,0,0] neg_hi:[1,0,0]
    v_pk_fma_f32 v[240:241], v[240:241], s[50:51], v[96:97] op_sel_hi:[1,1,0] neg_lo:[0,0,1] neg_hi:[0,0,1]
    v_exp_f32 v112, v112
    buffer_load_dwordx4 a[28:31], v1, s[28:31], s88 offen offset:3072 sc1
    v_pk_fma_f32 v[114:115], v[242:243], s[50:51], v[98:99] op_sel_hi:[1,1,0] neg_lo:[1,0,0] neg_hi:[1,0,0]
    v_exp_f32 v240, v240
    v_pk_fma_f32 v[242:243], v[242:243], s[50:51], v[96:97] op_sel_hi:[1,1,0] neg_lo:[0,0,1] neg_hi:[0,0,1]
    v_exp_f32 v113, v113
    v_exp_f32 v241, v241
    s_add_u32 s88, s57, 8192
    buffer_load_dwordx4 a[32:35], v1, s[28:31], s88 offen offset:0 sc1
    v_exp_f32 v114, v114
    v_pk_fma_f32 v[116:117], v[244:245], s[50:51], v[98:99] op_sel_hi:[1,1,0] neg_lo:[1,0,0] neg_hi:[1,0,0]
    v_exp_f32 v242, v242
    v_pk_fma_f32 v[244:245], v[244:245], s[50:51], v[96:97] op_sel_hi:[1,1,0] neg_lo:[0,0,1] neg_hi:[0,0,1]
    v_exp_f32 v115, v115
    buffer_load_dwordx4 a[36:39], v1, s[28:31], s88 offen offset:1024 sc1
    v_exp_f32 v243, v243
    v_exp_f32 v116, v116
    v_pk_fma_f32 v[118:119], v[246:247], s[50:51], v[98:99] op_sel_hi:[1,1,0] neg_lo:[1,0,0] neg_hi:[1,0,0]
    v_exp_f32 v244, v244
    v_pk_fma_f32 v[246:247], v[246:247], s[50:51], v[96:97] op_sel_hi:[1,1,0] neg_lo:[0,0,1] neg_hi:[0,0,1]
    buffer_load_dwordx4 a[40:43], v1, s[28:31], s88 offen offset:2048 sc1
    v_exp_f32 v117, v117
    v_pk_add_f32 v[14:15], v[112:113], v[114:115]
    v_exp_f32 v245, v245
    v_pk_add_f32 v[12:13], v[240:241], v[242:243]
    v_exp_f32 v118, v118
    buffer_load_dwordx4 a[44:47], v1, s[28:31], s88 offen offset:3072 sc1
    v_pk_fma_f32 v[120:121], v[248:249], s[50:51], v[98:99] op_sel_hi:[1,1,0] neg_lo:[1,0,0] neg_hi:[1,0,0]
    v_exp_f32 v246, v246
    v_pk_fma_f32 v[248:249], v[248:249], s[50:51], v[96:97] op_sel_hi:[1,1,0] neg_lo:[0,0,1] neg_hi:[0,0,1]
    v_exp_f32 v119, v119
    v_pk_add_f32 v[14:15], v[14:15], v[116:117]
    s_add_u32 s88, s57, 12288
    buffer_load_dwordx4 a[48:51], v1, s[28:31], s88 offen offset:0 sc1
    v_exp_f32 v247, v247
    v_pk_add_f32 v[12:13], v[12:13], v[244:245]
    v_exp_f32 v120, v120
    v_pk_fma_f32 v[122:123], v[250:251], s[50:51], v[98:99] op_sel_hi:[1,1,0] neg_lo:[1,0,0] neg_hi:[1,0,0]
    v_exp_f32 v248, v248
    buffer_load_dwordx4 a[52:55], v1, s[28:31], s88 offen offset:1024 sc1
    v_pk_fma_f32 v[250:251], v[250:251], s[50:51], v[96:97] op_sel_hi:[1,1,0] neg_lo:[0,0,1] neg_hi:[0,0,1]
    v_exp_f32 v121, v121
    v_pk_add_f32 v[14:15], v[14:15], v[118:119]
    v_exp_f32 v249, v249
    v_pk_add_f32 v[12:13], v[12:13], v[246:247]
    buffer_load_dwordx4 a[56:59], v1, s[28:31], s88 offen offset:2048 sc1
    v_exp_f32 v122, v122
    v_pk_fma_f32 v[124:125], v[252:253], s[50:51], v[102:103] op_sel_hi:[1,1,0] neg_lo:[1,0,0] neg_hi:[1,0,0]
    v_exp_f32 v250, v250
    v_pk_fma_f32 v[252:253], v[252:253], s[50:51], v[100:101] op_sel_hi:[1,1,0] neg_lo:[0,0,1] neg_hi:[0,0,1]
    v_exp_f32 v123, v123
    buffer_load_dwordx4 a[60:63], v1, s[28:31], s88 offen offset:3072 sc1
    v_pk_add_f32 v[14:15], v[14:15], v[120:121]
    v_exp_f32 v251, v251
    v_pk_add_f32 v[12:13], v[12:13], v[248:249]
    v_exp_f32 v124, v124
    v_pk_fma_f32 v[126:127], v[254:255], s[50:51], v[102:103] op_sel_hi:[1,1,0] neg_lo:[1,0,0] neg_hi:[1,0,0]
    v_exp_f32 v252, v252
    v_pk_fma_f32 v[254:255], v[254:255], s[50:51], v[100:101] op_sel_hi:[1,1,0] neg_lo:[0,0,1] neg_hi:[0,0,1]
    v_exp_f32 v125, v125
    v_pk_add_f32 v[14:15], v[14:15], v[122:123]
    v_exp_f32 v253, v253
    v_pk_add_f32 v[12:13], v[12:13], v[250:251]
    v_exp_f32 v126, v126
    v_exp_f32 v254, v254
    v_exp_f32 v127, v127
    v_pk_add_f32 v[14:15], v[14:15], v[124:125]
    v_exp_f32 v255, v255
    v_pk_add_f32 v[12:13], v[12:13], v[252:253]
    v_pk_add_f32 v[14:15], v[14:15], v[126:127]
    v_pk_add_f32 v[12:13], v[12:13], v[254:255]
    v_add_f32 v14, v14, v15
    v_add_f32 v12, v12, v13
    v_mov_b32 v15, v14
    v_mov_b32 v13, v12
    s_nop 0
    v_permlane32_swap_b32 v14, v15
    v_permlane32_swap_b32 v12, v13
    v_add_f32 v14, v14, v15
    v_add_f32 v63, v12, v13
    v_rcp_f32 v14, v14
    v_cvt_pk_bf16_f32 v240, v240, v241
    v_cvt_pk_bf16_f32 v241, v242, v243
    v_cvt_pk_bf16_f32 v242, v244, v245
    v_cvt_pk_bf16_f32 v243, v246, v247
    v_cvt_pk_bf16_f32 v244, v248, v249
    v_cvt_pk_bf16_f32 v245, v250, v251
    v_cvt_pk_bf16_f32 v246, v252, v253
    v_cvt_pk_bf16_f32 v247, v254, v255
    v_mul_f32 v14, v14, v63
    v_pk_mul_f32 v[112:113], v[112:113], v[14:15] op_sel_hi:[1,0]
    v_pk_mul_f32 v[114:115], v[114:115], v[14:15] op_sel_hi:[1,0]
    v_pk_mul_f32 v[116:117], v[116:117], v[14:15] op_sel_hi:[1,0]
    v_pk_mul_f32 v[118:119], v[118:119], v[14:15] op_sel_hi:[1,0]
    v_pk_mul_f32 v[120:121], v[120:121], v[14:15] op_sel_hi:[1,0]
    v_pk_mul_f32 v[122:123], v[122:123], v[14:15] op_sel_hi:[1,0]
    v_pk_mul_f32 v[124:125], v[124:125], v[14:15] op_sel_hi:[1,0]
    v_pk_mul_f32 v[126:127], v[126:127], v[14:15] op_sel_hi:[1,0]
    v_cvt_pk_bf16_f32 v248, v112, v113
    v_cvt_pk_bf16_f32 v249, v114, v115
    v_cvt_pk_bf16_f32 v250, v116, v117
    v_cvt_pk_bf16_f32 v251, v118, v119
    v_cvt_pk_bf16_f32 v252, v120, v121
    v_cvt_pk_bf16_f32 v253, v122, v123
    v_cvt_pk_bf16_f32 v254, v124, v125
    v_cvt_pk_bf16_f32 v255, v126, v127
    s_mov_b32 s92, 0x4000
    s_branch Lq_fchk
Lq_ftry:
    s_add_u32 s88, s57, 0
    buffer_load_dwordx4 a[0:3], v1, s[28:31], s88 offen offset:0 sc1
    buffer_load_dwordx4 a[4:7], v1, s[28:31], s88 offen offset:1024 sc1
    buffer_load_dwordx4 a[8:11], v1, s[28:31], s88 offen offset:2048 sc1
    buffer_load_dwordx4 a[12:15], v1, s[28:31], s88 offen offset:3072 sc1
    s_add_u32 s88, s57, 4096
    buffer_load_dwordx4 a[16:19], v1, s[28:31], s88 offen offset:0 sc1
    buffer_load_dwordx4 a[20:23], v1, s[28:31], s88 offen offset:1024 sc1
    buffer_load_dwordx4 a[24:27], v1, s[28:31], s88 offen offset:2048 sc1
    buffer_load_dwordx4 a[28:31], v1, s[28:31], s88 offen offset:3072 sc1
    s_add_u32 s88, s57, 8192
    buffer_load_dwordx4 a[32:35], v1, s[28:31], s88 offen offset:0 sc1
    buffer_load_dwordx4 a[36:39], v1, s[28:31], s88 offen offset:1024 sc1
    buffer_load_dwordx4 a[40:43], v1, s[28:31], s88 offen offset:2048 sc1
    buffer_load_dwordx4 a[44:47], v1, s[28:31], s88 offen offset:3072 sc1
    s_add_u32 s88, s57, 12288
    buffer_load_dwordx4 a[48:51], v1, s[28:31], s88 offen offset:0 sc1
    buffer_load_dwordx4 a[52:55], v1, s[28:31], s88 offen offset:1024 sc1
    buffer_load_dwordx4 a[56:59], v1, s[28:31], s88 offen offset:2048 sc1
    buffer_load_dwordx4 a[60:63], v1, s[28:31], s88 offen offset:3072 sc1
Lq_fchk:
    s_waitcnt vmcnt(0)
    v_accvgpr_read_b32 v64, a0
    v_accvgpr_read_b32 v65, a1
    v_accvgpr_read_b32 v66, a2
    v_accvgpr_read_b32 v67, a3
    v_accvgpr_read_b32 v68, a4
    v_accvgpr_read_b32 v69, a5
    v_accvgpr_read_b32 v70, a6
    v_accvgpr_read_b32 v71, a7
    v_accvgpr_read_b32 v72, a8
    v_accvgpr_read_b32 v73, a9
    v_accvgpr_read_b32 v74, a10
    v_accvgpr_read_b32 v75, a11
    v_accvgpr_read_b32 v76, a12
    v_accvgpr_read_b32 v77, a13
    v_accvgpr_read_b32 v78, a14
    v_accvgpr_read_b32 v79, a15
    v_accvgpr_read_b32 v80, a16
    v_accvgpr_read_b32 v81, a17
    v_accvgpr_read_b32 v82, a18
    v_accvgpr_read_b32 v83, a19
    v_accvgpr_read_b32 v84, a20
    v_accvgpr_read_b32 v85, a21
    v_accvgpr_read_b32 v86, a22
    v_accvgpr_read_b32 v87, a23
    v_accvgpr_read_b32 v88, a24
    v_accvgpr_read_b32 v89, a25
    v_accvgpr_read_b32 v90, a26
    v_accvgpr_read_b32 v91, a27
    v_accvgpr_read_b32 v92, a28
    v_accvgpr_read_b32 v93, a29
    v_accvgpr_read_b32 v94, a30
    v_accvgpr_read_b32 v95, a31
    v_accvgpr_read_b32 v96, a32
    v_accvgpr_read_b32 v97, a33
    v_accvgpr_read_b32 v98, a34
    v_accvgpr_read_b32 v99, a35
    v_accvgpr_read_b32 v100, a36
    v_accvgpr_read_b32 v101, a37
    v_accvgpr_read_b32 v102, a38
    v_accvgpr_read_b32 v103, a39
    v_accvgpr_read_b32 v104, a40
    v_accvgpr_read_b32 v105, a41
    v_accvgpr_read_b32 v106, a42
    v_accvgpr_read_b32 v107, a43
    v_accvgpr_read_b32 v108, a44
    v_accvgpr_read_b32 v109, a45
    v_accvgpr_read_b32 v110, a46
    v_accvgpr_read_b32 v111, a47
    v_accvgpr_read_b32 v112, a48
    v_accvgpr_read_b32 v113, a49
    v_accvgpr_read_b32 v114, a50
    v_accvgpr_read_b32 v115, a51
    v_accvgpr_read_b32 v116, a52
    v_accvgpr_read_b32 v117, a53
    v_accvgpr_read_b32 v118, a54
    v_accvgpr_read_b32 v119, a55
    v_accvgpr_read_b32 v120, a56
    v_accvgpr_read_b32 v121, a57
    v_accvgpr_read_b32 v122, a58
    v_accvgpr_read_b32 v123, a59
    v_accvgpr_read_b32 v124, a60
    v_accvgpr_read_b32 v125, a61
    v_accvgpr_read_b32 v126, a62
    v_accvgpr_read_b32 v127, a63
    v_xor_b32 v64, v64, v24
    v_xor_b32 v68, v68, v24
    v_xor_b32 v72, v72, v24
    v_xor_b32 v76, v76, v24
    v_xor_b32 v80, v80, v24
    v_xor_b32 v84, v84, v24
    v_xor_b32 v88, v88, v24
    v_xor_b32 v92, v92, v24
    v_xor_b32 v96, v96, v24
    v_xor_b32 v100, v100, v24
    v_xor_b32 v104, v104, v24
    v_xor_b32 v108, v108, v24
    v_xor_b32 v112, v112, v24
    v_xor_b32 v116, v116, v24
    v_xor_b32 v120, v120, v24
    v_xor_b32 v124, v124, v24
    v_or_b32 v28, v64, v68
    v_or3_b32 v28, v28, v72, v76
    v_or3_b32 v28, v28, v80, v84
    v_or3_b32 v28, v28, v88, v92
    v_or3_b32 v28, v28, v96, v100
    v_or3_b32 v28, v28, v104, v108
    v_or3_b32 v28, v28, v112, v116
    v_or3_b32 v28, v28, v120, v124
    s_nop 0
    v_and_b32 v28, 0xff, v28
    v_cmp_ne_u32 vcc, 0, v28
    s_sub_u32 s92, s92, 1
    s_cselect_b64 vcc, 0, vcc
    s_nop 0
    s_cbranch_vccnz Lq_ftry
    s_mov_b32 s92, 0x8000
Lck_4:
    v_cmp_eq_u32 vcc, s79, v18
    s_sub_u32 s92, s92, 1
    s_cbranch_scc1 Lcd_5
    s_andn2_b32 s87, 0xfff, vcc_lo
    s_cbranch_scc0 Lcd_5
    buffer_load_dword v18, v17, s[28:31], s60 offen sc1
    s_sleep 4
    s_branch Lck_4
Lcd_5:
    s_mov_b32 s92, 0x8000
    v_cvt_pk_bf16_f32 v64, v64, v65
    v_cvt_pk_bf16_f32 v65, v66, v67
    v_cvt_pk_bf16_f32 v66, v68, v69
    v_cvt_pk_bf16_f32 v67, v70, v71
    v_cvt_pk_bf16_f32 v68, v72, v73
    v_cvt_pk_bf16_f32 v69, v74, v75
    v_cvt_pk_bf16_f32 v70, v76, v77
    v_cvt_pk_bf16_f32 v71, v78, v79
    v_cvt_pk_bf16_f32 v72, v80, v81
    v_cvt_pk_bf16_f32 v73, v82, v83
    v_cvt_pk_bf16_f32 v74, v84, v85
    v_cvt_pk_bf16_f32 v75, v86, v87
    v_cvt_pk_bf16_f32 v76, v88, v89
    v_cvt_pk_bf16_f32 v77, v90, v91
    v_cvt_pk_bf16_f32 v78, v92, v93
    v_cvt_pk_bf16_f32 v79, v94, v95
    v_cvt_pk_bf16_f32 v80, v96, v97
    v_cvt_pk_bf16_f32 v81, v98, v99
    v_cvt_pk_bf16_f32 v82, v100, v101
    v_cvt_pk_bf16_f32 v83, v102, v103
    v_cvt_pk_bf16_f32 v84, v104, v105
    v_cvt_pk_bf16_f32 v85, v106, v107
    v_cvt_pk_bf16_f32 v86, v108, v109
    v_cvt_pk_bf16_f32 v87, v110, v111
    v_cvt_pk_bf16_f32 v88, v112, v113
    v_cvt_pk_bf16_f32 v89, v114, v115
    v_cvt_pk_bf16_f32 v90, v116, v117
    v_cvt_pk_bf16_f32 v91, v118, v119
    v_cvt_pk_bf16_f32 v92, v120, v121
    v_cvt_pk_bf16_f32 v93, v122, v123
    v_cvt_pk_bf16_f32 v94, v124, v125
    v_cvt_pk_bf16_f32 v95, v126, v127
    s_lshl_b32 s87, s72, 13
    s_add_u32 s87, s87, 114688
    v_add_u32 v14, s87, v1
    ds_write_b128 v14, v[64:67] offset:0
    ds_write_b128 v14, v[68:71] offset:1024
    ds_write_b128 v14, v[72:75] offset:2048
    ds_write_b128 v14, v[76:79] offset:3072
    ds_write_b128 v14, v[80:83] offset:4096
    ds_write_b128 v14, v[84:87] offset:5120
    ds_write_b128 v14, v[88:91] offset:6144
    ds_write_b128 v14, v[92:95] offset:7168
    s_lshl_b32 s87, s75, 12
    s_add_u32 s87, s87, 114688
    v_add_u32 v14, s87, v1
    s_waitcnt lgkmcnt(0)
    s_barrier
    ds_read_b32 v32, v23
    ds_read_b32 v33, v23 offset:128
    ds_read_b128 a[0:3], v14 offset:0
    ds_read_b128 a[4:7], v14 offset:1024
    ds_read_b128 a[8:11], v14 offset:2048
    ds_read_b128 a[12:15], v14 offset:3072
    ds_read_b128 a[16:19], v14 offset:8192
    ds_read_b128 a[20:23], v14 offset:9216
    ds_read_b128 a[24:27], v14 offset:10240
    ds_read_b128 a[28:31], v14 offset:11264
    ds_read_b128 a[32:35], v14 offset:16384
    ds_read_b128 a[36:39], v14 offset:17408
    ds_read_b128 a[40:43], v14 offset:18432
    ds_read_b128 a[44:47], v14 offset:19456
    s_waitcnt lgkmcnt(8)
    ds_read_b128 a[48:51], v14 offset:24576
    ds_read_b128 a[52:55], v14 offset:25600
    ds_read_b128 a[56:59], v14 offset:26624
    ds_read_b128 a[60:63], v14 offset:27648
    v_mfma_f32_32x32x16_bf16 v[64:79], a[0:3], v[128:131], 0
    v_mfma_f32_32x32x16_bf16 v[64:79], a[4:7], v[132:135], v[64:79]
    v_mfma_f32_32x32x16_bf16 v[64:79], a[8:11], v[136:139], v[64:79]
    v_mfma_f32_32x32x16_bf16 v[64:79], a[12:15], v[140:143], v[64:79]
    v_mfma_f32_32x32x16_bf16 v[80:95], a[0:3], v[160:163], 0
    v_mfma_f32_32x32x16_bf16 v[80:95], a[4:7], v[164:167], v[80:95]
    v_mfma_f32_32x32x16_bf16 v[80:95], a[8:11], v[168:171], v[80:95]
    v_mfma_f32_32x32x16_bf16 v[80:95], a[12:15], v[172:175], v[80:95]
    s_waitcnt lgkmcnt(0)
    v_mfma_f32_32x32x16_bf16 v[96:111], a[16:19], v[144:147], 0
    s_nop 5
    v_mov_b32 v12, v76
    v_mov_b32 v13, v76
    s_nop 1
    v_permlane32_swap_b32 v12, v13
    v_fmac_f32 v13, 0x358637bd, v56
    v_rcp_f32 v13, v13
    s_nop 0
    v_mul_f32 v12, v13, v32
    v_mul_f32 v64, v64, v12
    v_mul_f32 v65, v65, v12
    v_mfma_f32_32x32x16_bf16 v[96:111], a[20:23], v[148:151], v[96:111]
    v_mul_f32 v66, v66, v12
    v_mul_f32 v67, v67, v12
    v_mul_f32 v68, v68, v12
    v_mul_f32 v69, v69, v12
    v_mul_f32 v70, v70, v12
    v_mul_f32 v71, v71, v12
    v_mul_f32 v72, v72, v12
    v_mul_f32 v73, v73, v12
    v_mfma_f32_32x32x16_bf16 v[96:111], a[24:27], v[152:155], v[96:111]
    v_mul_f32 v74, v74, v12
    v_mul_f32 v75, v75, v12
    v_mul_f32 v76, v76, v12
    v_mul_f32 v77, v77, v12
    v_mul_f32 v78, v78, v12
    v_mul_f32 v79, v79, v12
    v_cvt_pk_bf16_f32 v128, v64, v65
    v_cvt_pk_bf16_f32 v129, v66, v67
    v_mfma_f32_32x32x16_bf16 v[96:111], a[28:31], v[156:159], v[96:111]
    v_cvt_pk_bf16_f32 v130, v68, v69
    v_cvt_pk_bf16_f32 v131, v70, v71
    v_cvt_pk_bf16_f32 v132, v72, v73
    v_cvt_pk_bf16_f32 v133, v74, v75
    v_cvt_pk_bf16_f32 v134, v76, v77
    v_cvt_pk_bf16_f32 v135, v78, v79
    v_cndmask_b32 v134, v134, 0, s[96:97]
    v_cndmask_b32 v135, v135, 0, s[96:97]
    s_add_u32 s88, s58, 0
    buffer_store_dwordx4 v[128:131], v1, s[28:31], s88 offen sc1
    buffer_store_dwordx4 v[132:135], v1, s[28:31], s88 offen offset:1024 sc1
    v_mfma_f32_32x32x16_bf16 v[112:127], a[16:19], v[176:179], 0
    v_mov_b32 v12, v92
    v_mov_b32 v13, v92
    s_nop 1
    v_permlane32_swap_b32 v12, v13
    v_fmac_f32 v13, 0x358637bd, v58
    v_rcp_f32 v13, v13
    s_nop 0
    v_mul_f32 v12, v13, v33
    v_mul_f32 v80, v80, v12
    v_mul_f32 v81, v81, v12
    v_mfma_f32_32x32x16_bf16 v[112:127], a[20:23], v[180:183], v[112:127]
    v_mul_f32 v82, v82, v12
    v_mul_f32 v83, v83, v12
    v_mul_f32 v84, v84, v12
    v_mul_f32 v85, v85, v12
    v_mul_f32 v86, v86, v12
    v_mul_f32 v87, v87, v12
    v_mul_f32 v88, v88, v12
    v_mul_f32 v89, v89, v12
    v_mfma_f32_32x32x16_bf16 v[112:127], a[24:27], v[184:187], v[112:127]
    v_mul_f32 v90, v90, v12
    v_mul_f32 v91, v91, v12
    v_mul_f32 v92, v92, v12
    v_mul_f32 v93, v93, v12
    v_mul_f32 v94, v94, v12
    v_mul_f32 v95, v95, v12
    v_cvt_pk_bf16_f32 v160, v80, v81
    v_cvt_pk_bf16_f32 v161, v82, v83
    v_mfma_f32_32x32x16_bf16 v[112:127], a[28:31], v[188:191], v[112:127]
    v_cvt_pk_bf16_f32 v162, v84, v85
    v_cvt_pk_bf16_f32 v163, v86, v87
    v_cvt_pk_bf16_f32 v164, v88, v89
    v_cvt_pk_bf16_f32 v165, v90, v91
    v_cvt_pk_bf16_f32 v166, v92, v93
    v_cvt_pk_bf16_f32 v167, v94, v95
    v_cndmask_b32 v166, v166, 0, s[96:97]
    v_cndmask_b32 v167, v167, 0, s[96:97]
    s_add_u32 s88, s58, 32768
    buffer_store_dwordx4 v[160:163], v1, s[28:31], s88 offen sc1
    buffer_store_dwordx4 v[164:167], v1, s[28:31], s88 offen offset:1024 sc1
    v_mfma_f32_32x32x16_bf16 v[64:79], a[32:35], v[192:195], 0
    v_mov_b32 v12, v108
    v_mov_b32 v13, v108
    s_nop 1
    v_permlane32_swap_b32 v12, v13
    v_fmac_f32 v13, 0x358637bd, v57
    v_rcp_f32 v13, v13
    s_nop 0
    v_mul_f32 v12, v13, v32
    v_mul_f32 v96, v96, v12
    v_mul_f32 v97, v97, v12
    v_mfma_f32_32x32x16_bf16 v[64:79], a[36:39], v[196:199], v[64:79]
    v_mul_f32 v98, v98, v12
    v_mul_f32 v99, v99, v12
    v_mul_f32 v100, v100, v12
    v_mul_f32 v101, v101, v12
    v_mul_f32 v102, v102, v12
    v_mul_f32 v103, v103, v12
    v_mul_f32 v104, v104, v12
    v_mul_f32 v105, v105, v12
    v_mfma_f32_32x32x16_bf16 v[64:79], a[40:43], v[200:203], v[64:79]
    v_mul_f32 v106, v106, v12
    v_mul_f32 v107, v107, v12
    v_mul_f32 v108, v108, v12
    v_mul_f32 v109, v109, v12
    v_mul_f32 v110, v110, v12
    v_mul_f32 v111, v111, v12
    v_cvt_pk_bf16_f32 v144, v96, v97
    v_cvt_pk_bf16_f32 v145, v98, v99
    v_mfma_f32_32x32x16_bf16 v[64:79], a[44:47], v[204:207], v[64:79]
    v_cvt_pk_bf16_f32 v146, v100, v101
    v_cvt_pk_bf16_f32 v147, v102, v103
    v_cvt_pk_bf16_f32 v148, v104, v105
    v_cvt_pk_bf16_f32 v149, v106, v107
    v_cvt_pk_bf16_f32 v150, v108, v109
    v_cvt_pk_bf16_f32 v151, v110, v111
    v_cndmask_b32 v150, v150, 0, s[96:97]
    v_cndmask_b32 v151, v151, 0, s[96:97]
    s_add_u32 s88, s58, 4096
    buffer_store_dwordx4 v[144:147], v1, s[28:31], s88 offen sc1
    buffer_store_dwordx4 v[148:151], v1, s[28:31], s88 offen offset:1024 sc1
    v_mfma_f32_32x32x16_bf16 v[80:95], a[48:51], v[208:211], 0
    v_mov_b32 v12, v124
    v_mov_b32 v13, v124
    s_nop 1
    v_permlane32_swap_b32 v12, v13
    v_fmac_f32 v13, 0x358637bd, v59
    v_rcp_f32 v13, v13
    s_nop 0
    v_mul_f32 v12, v13, v33
    v_mul_f32 v112, v112, v12
    v_mul_f32 v113, v113, v12
    v_mfma_f32_32x32x16_bf16 v[80:95], a[52:55], v[212:215], v[80:95]
    v_mul_f32 v114, v114, v12
    v_mul_f32 v115, v115, v12
    v_mul_f32 v116, v116, v12
    v_mul_f32 v117, v117, v12
    v_mul_f32 v118, v118, v12
    v_mul_f32 v119, v119, v12
    v_mul_f32 v120, v120, v12
    v_mul_f32 v121, v121, v12
    v_mfma_f32_32x32x16_bf16 v[80:95], a[56:59], v[216:219], v[80:95]
    v_mul_f32 v122, v122, v12
    v_mul_f32 v123, v123, v12
    v_mul_f32 v124, v124, v12
    v_mul_f32 v125, v125, v12
    v_mul_f32 v126, v126, v12
    v_mul_f32 v127, v127, v12
    v_cvt_pk_bf16_f32 v176, v112, v113
    v_cvt_pk_bf16_f32 v177, v114, v115
    v_mfma_f32_32x32x16_bf16 v[80:95], a[60:63], v[220:223], v[80:95]
    v_cvt_pk_bf16_f32 v178, v116, v117
    v_cvt_pk_bf16_f32 v179, v118, v119
    v_cvt_pk_bf16_f32 v180, v120, v121
    v_cvt_pk_bf16_f32 v181, v122, v123
    v_cvt_pk_bf16_f32 v182, v124, v125
    v_cvt_pk_bf16_f32 v183, v126, v127
    v_cndmask_b32 v182, v182, 0, s[96:97]
    v_cndmask_b32 v183, v183, 0, s[96:97]
    s_add_u32 s88, s58, 36864
    buffer_store_dwordx4 v[176:179], v1, s[28:31], s88 offen sc1
    buffer_store_dwordx4 v[180:183], v1, s[28:31], s88 offen offset:1024 sc1
    v_mfma_f32_32x32x16_bf16 v[96:111], a[32:35], v[224:227], 0
    v_mov_b32 v12, v76
    v_mov_b32 v13, v76
    s_nop 1
    v_permlane32_swap_b32 v12, v13
    v_fmac_f32 v13, 0x358637bd, v60
    v_rcp_f32 v13, v13
    s_nop 0
    v_mul_f32 v12, v13, v32
    v_mul_f32 v64, v64, v12
    v_mul_f32 v65, v65, v12
    v_mfma_f32_32x32x16_bf16 v[96:111], a[36:39], v[228:231], v[96:111]
    v_mul_f32 v66, v66, v12
    v_mul_f32 v67, v67, v12
    v_mul_f32 v68, v68, v12
    v_mul_f32 v69, v69, v12
    v_mul_f32 v70, v70, v12
    v_mul_f32 v71, v71, v12
    v_mul_f32 v72, v72, v12
    v_mul_f32 v73, v73, v12
    v_mfma_f32_32x32x16_bf16 v[96:111], a[40:43], v[232:235], v[96:111]
    v_mul_f32 v74, v74, v12
    v_mul_f32 v75, v75, v12
    v_mul_f32 v76, v76, v12
    v_mul_f32 v77, v77, v12
    v_mul_f32 v78, v78, v12
    v_mul_f32 v79, v79, v12
    v_cvt_pk_bf16_f32 v192, v64, v65
    v_cvt_pk_bf16_f32 v193, v66, v67
    v_mfma_f32_32x32x16_bf16 v[96:111], a[44:47], v[236:239], v[96:111]
    v_cvt_pk_bf16_f32 v194, v68, v69
    v_cvt_pk_bf16_f32 v195, v70, v71
    v_cvt_pk_bf16_f32 v196, v72, v73
    v_cvt_pk_bf16_f32 v197, v74, v75
    v_cvt_pk_bf16_f32 v198, v76, v77
    v_cvt_pk_bf16_f32 v199, v78, v79
    v_cndmask_b32 v198, v198, 0, s[96:97]
    v_cndmask_b32 v199, v199, 0, s[96:97]
    s_add_u32 s88, s58, 8192
    buffer_store_dwordx4 v[192:195], v1, s[28:31], s88 offen sc1
    buffer_store_dwordx4 v[196:199], v1, s[28:31], s88 offen offset:1024 sc1
    v_mfma_f32_32x32x16_bf16 v[112:127], a[48:51], v[240:243], 0
    v_mov_b32 v12, v92
    v_mov_b32 v13, v92
    s_nop 1
    v_permlane32_swap_b32 v12, v13
    v_fmac_f32 v13, 0x358637bd, v61
    v_rcp_f32 v13, v13
    s_nop 0
    v_mul_f32 v12, v13, v32
    v_mul_f32 v80, v80, v12
    v_mul_f32 v81, v81, v12
    v_mfma_f32_32x32x16_bf16 v[112:127], a[52:55], v[244:247], v[112:127]
    v_mul_f32 v82, v82, v12
    v_mul_f32 v83, v83, v12
    v_mul_f32 v84, v84, v12
    v_mul_f32 v85, v85, v12
    v_mul_f32 v86, v86, v12
    v_mul_f32 v87, v87, v12
    v_mul_f32 v88, v88, v12
    v_mul_f32 v89, v89, v12
    v_mfma_f32_32x32x16_bf16 v[112:127], a[56:59], v[248:251], v[112:127]
    v_mul_f32 v90, v90, v12
    v_mul_f32 v91, v91, v12
    v_mul_f32 v92, v92, v12
    v_mul_f32 v93, v93, v12
    v_mul_f32 v94, v94, v12
    v_mul_f32 v95, v95, v12
    v_cvt_pk_bf16_f32 v208, v80, v81
    v_cvt_pk_bf16_f32 v209, v82, v83
    v_mfma_f32_32x32x16_bf16 v[112:127], a[60:63], v[252:255], v[112:127]
    v_cvt_pk_bf16_f32 v210, v84, v85
    v_cvt_pk_bf16_f32 v211, v86, v87
    v_cvt_pk_bf16_f32 v212, v88, v89
    v_cvt_pk_bf16_f32 v213, v90, v91
    v_cvt_pk_bf16_f32 v214, v92, v93
    v_cvt_pk_bf16_f32 v215, v94, v95
    v_cndmask_b32 v214, v214, 0, s[96:97]
    v_cndmask_b32 v215, v215, 0, s[96:97]
    s_add_u32 s88, s58, 12288
    buffer_store_dwordx4 v[208:211], v1, s[28:31], s88 offen sc1
    buffer_store_dwordx4 v[212:215], v1, s[28:31], s88 offen offset:1024 sc1
    v_mov_b32 v12, v108
    v_mov_b32 v13, v108
    s_nop 1
    v_permlane32_swap_b32 v12, v13
    v_fmac_f32 v13, 0x358637bd, v62
    v_rcp_f32 v13, v13
    s_nop 0
    v_mul_f32 v12, v13, v33
    v_mul_f32 v96, v96, v12
    v_mul_f32 v97, v97, v12
    v_mul_f32 v98, v98, v12
    v_mul_f32 v99, v99, v12
    v_mul_f32 v100, v100, v12
    v_mul_f32 v101, v101, v12
    v_mul_f32 v102, v102, v12
    v_mul_f32 v103, v103, v12
    v_mul_f32 v104, v104, v12
    v_mul_f32 v105, v105, v12
    v_mul_f32 v106, v106, v12
    v_mul_f32 v107, v107, v12
    v_mul_f32 v108, v108, v12
    v_mul_f32 v109, v109, v12
    v_mul_f32 v110, v110, v12
    v_mul_f32 v111, v111, v12
    v_cvt_pk_bf16_f32 v224, v96, v97
    v_cvt_pk_bf16_f32 v225, v98, v99
    v_cvt_pk_bf16_f32 v226, v100, v101
    v_cvt_pk_bf16_f32 v227, v102, v103
    v_cvt_pk_bf16_f32 v228, v104, v105
    v_cvt_pk_bf16_f32 v229, v106, v107
    v_cvt_pk_bf16_f32 v230, v108, v109
    v_cvt_pk_bf16_f32 v231, v110, v111
    v_cndmask_b32 v230, v230, 0, s[96:97]
    v_cndmask_b32 v231, v231, 0, s[96:97]
    s_add_u32 s88, s58, 40960
    buffer_store_dwordx4 v[224:227], v1, s[28:31], s88 offen sc1
    buffer_store_dwordx4 v[228:231], v1, s[28:31], s88 offen offset:1024 sc1
    v_mov_b32 v12, v124
    v_mov_b32 v13, v124
    s_nop 1
    v_permlane32_swap_b32 v12, v13
    v_fmac_f32 v13, 0x358637bd, v63
    v_rcp_f32 v13, v13
    s_nop 0
    v_mul_f32 v12, v13, v33
    v_mul_f32 v112, v112, v12
    v_mul_f32 v113, v113, v12
    v_mul_f32 v114, v114, v12
    v_mul_f32 v115, v115, v12
    v_mul_f32 v116, v116, v12
    v_mul_f32 v117, v117, v12
    v_mul_f32 v118, v118, v12
    v_mul_f32 v119, v119, v12
    v_mul_f32 v120, v120, v12
    v_mul_f32 v121, v121, v12
    v_mul_f32 v122, v122, v12
    v_mul_f32 v123, v123, v12
    v_mul_f32 v124, v124, v12
    v_mul_f32 v125, v125, v12
    v_mul_f32 v126, v126, v12
    v_mul_f32 v127, v127, v12
    v_cvt_pk_bf16_f32 v240, v112, v113
    v_cvt_pk_bf16_f32 v241, v114, v115
    v_cvt_pk_bf16_f32 v242, v116, v117
    v_cvt_pk_bf16_f32 v243, v118, v119
    v_cvt_pk_bf16_f32 v244, v120, v121
    v_cvt_pk_bf16_f32 v245, v122, v123
    v_cvt_pk_bf16_f32 v246, v124, v125
    v_cvt_pk_bf16_f32 v247, v126, v127
    v_cndmask_b32 v246, v246, 0, s[96:97]
    v_cndmask_b32 v247, v247, 0, s[96:97]
    s_add_u32 s88, s58, 45056
    buffer_store_dwordx4 v[240:243], v1, s[28:31], s88 offen sc1
    buffer_store_dwordx4 v[244:247], v1, s[28:31], s88 offen offset:1024 sc1
    s_endpgm
Lrl1:
    s_sleep 2
    s_mov_b32 s89, s65
    s_bfe_u32 s88, s53, 0x40000
    s_lshl_b32 s88, s88, 13
    s_add_u32 s65, s88, s61
    buffer_load_dwordx4 a[48:51], v1, s[28:31], s65 offen sc1
    s_add_u32 s65, s65, 114688
    buffer_load_dwordx4 a[52:55], v1, s[28:31], s65 offen sc1
    s_bfe_u32 s88, s53, 0x40000
    s_lshl_b32 s88, s88, 13
    s_add_u32 s65, s88, s61
    s_add_u32 s65, s65, 4096
    buffer_load_dwordx4 a[56:59], v1, s[28:31], s65 offen sc1
    s_add_u32 s65, s65, 114688
    buffer_load_dwordx4 a[60:63], v1, s[28:31], s65 offen sc1
    s_bfe_u32 s88, s53, 0x40004
    s_lshl_b32 s88, s88, 13
    s_add_u32 s65, s88, s61
    buffer_load_dwordx4 a[64:67], v1, s[28:31], s65 offen sc1
    s_add_u32 s65, s65, 114688
    buffer_load_dwordx4 a[68:71], v1, s[28:31], s65 offen sc1
    s_bfe_u32 s88, s53, 0x40004
    s_lshl_b32 s88, s88, 13
    s_add_u32 s65, s88, s61
    s_add_u32 s65, s65, 4096
    buffer_load_dwordx4 a[72:75], v1, s[28:31], s65 offen sc1
    s_add_u32 s65, s65, 114688
    buffer_load_dwordx4 a[76:79], v1, s[28:31], s65 offen sc1
    s_mov_b32 s65, s89
    s_sub_u32 s92, s92, 1
    s_waitcnt vmcnt(0)
    s_cbranch_scc0 Lrl1_r
    v_accvgpr_write_b32 a51, 0
    v_accvgpr_write_b32 a55, 0
    v_accvgpr_write_b32 a59, 0
    v_accvgpr_write_b32 a63, 0
    v_accvgpr_write_b32 a67, 0
    v_accvgpr_write_b32 a71, 0
    v_accvgpr_write_b32 a75, 0
    v_accvgpr_write_b32 a79, 0
    s_mov_b32 s92, 0
Lrl1_r:
    s_setpc_b64 s[98:99]
Lrl2:
    s_sleep 2
    s_mov_b32 s89, s65
    s_bfe_u32 s88, s53, 0x40008
    s_lshl_b32 s88, s88, 13
    s_add_u32 s65, s88, s61
    buffer_load_dwordx4 a[80:83], v1, s[28:31], s65 offen sc1
    s_add_u32 s65, s65, 114688
    buffer_load_dwordx4 a[84:87], v1, s[28:31], s65 offen sc1
    s_bfe_u32 s88, s53, 0x40008
    s_lshl_b32 s88, s88, 13
    s_add_u32 s65, s88, s61
    s_add_u32 s65, s65, 4096
    buffer_load_dwordx4 a[88:91], v1, s[28:31], s65 offen sc1
    s_add_u32 s65, s65, 114688
    buffer_load_dwordx4 a[92:95], v1, s[28:31], s65 offen sc1
    s_bfe_u32 s88, s53, 0x4000c
    s_lshl_b32 s88, s88, 13
    s_add_u32 s65, s88, s61
    buffer_load_dwordx4 a[96:99], v1, s[28:31], s65 offen sc1
    s_add_u32 s65, s65, 114688
    buffer_load_dwordx4 a[100:103], v1, s[28:31], s65 offen sc1
    s_bfe_u32 s88, s53, 0x4000c
    s_lshl_b32 s88, s88, 13
    s_add_u32 s65, s88, s61
    s_add_u32 s65, s65, 4096
    buffer_load_dwordx4 a[104:107], v1, s[28:31], s65 offen sc1
    s_add_u32 s65, s65, 114688
    buffer_load_dwordx4 a[108:111], v1, s[28:31], s65 offen sc1
    s_mov_b32 s65, s89
    s_sub_u32 s92, s92, 1
    s_waitcnt vmcnt(0)
    s_cbranch_scc0 Lrl2_r
    v_accvgpr_write_b32 a83, 0
    v_accvgpr_write_b32 a87, 0
    v_accvgpr_write_b32 a91, 0
    v_accvgpr_write_b32 a95, 0
    v_accvgpr_write_b32 a99, 0
    v_accvgpr_write_b32 a103, 0
    v_accvgpr_write_b32 a107, 0
    v_accvgpr_write_b32 a111, 0
    s_mov_b32 s92, 0
Lrl2_r:
    s_setpc_b64 s[98:99]
Lrl3:
    s_sleep 2
    s_mov_b32 s89, s65
    s_bfe_u32 s88, s54, 0x40000
    s_lshl_b32 s88, s88, 13
    s_add_u32 s65, s88, s61
    buffer_load_dwordx4 a[112:115], v1, s[28:31], s65 offen sc1
    s_add_u32 s65, s65, 114688
    buffer_load_dwordx4 a[116:119], v1, s[28:31], s65 offen sc1
    s_bfe_u32 s88, s54, 0x40000
    s_lshl_b32 s88, s88, 13
    s_add_u32 s65, s88, s61
    s_add_u32 s65, s65, 4096
    buffer_load_dwordx4 a[120:123], v1, s[28:31], s65 offen sc1
    s_add_u32 s65, s65, 114688
    buffer_load_dwordx4 a[124:127], v1, s[28:31], s65 offen sc1
    s_bfe_u32 s88, s54, 0x40004
    s_lshl_b32 s88, s88, 13
    s_add_u32 s65, s88, s61
    buffer_load_dwordx4 a[128:131], v1, s[28:31], s65 offen sc1
    s_add_u32 s65, s65, 114688
    buffer_load_dwordx4 a[132:135], v1, s[28:31], s65 offen sc1
    s_bfe_u32 s88, s54, 0x40004
    s_lshl_b32 s88, s88, 13
    s_add_u32 s65, s88, s61
    s_add_u32 s65, s65, 4096
    buffer_load_dwordx4 a[136:139], v1, s[28:31], s65 offen sc1
    s_add_u32 s65, s65, 114688
    buffer_load_dwordx4 a[140:143], v1, s[28:31], s65 offen sc1
    s_mov_b32 s65, s89
    s_sub_u32 s92, s92, 1
    s_waitcnt vmcnt(0)
    s_cbranch_scc0 Lrl3_r
    v_accvgpr_write_b32 a115, 0
    v_accvgpr_write_b32 a119, 0
    v_accvgpr_write_b32 a123, 0
    v_accvgpr_write_b32 a127, 0
    v_accvgpr_write_b32 a131, 0
    v_accvgpr_write_b32 a135, 0
    v_accvgpr_write_b32 a139, 0
    v_accvgpr_write_b32 a143, 0
    s_mov_b32 s92, 0
Lrl3_r:
    s_setpc_b64 s[98:99]
Lrl4:
    s_sleep 2
    s_mov_b32 s89, s65
    s_bfe_u32 s88, s54, 0x40008
    s_lshl_b32 s88, s88, 13
    s_add_u32 s65, s88, s61
    buffer_load_dwordx4 a[144:147], v1, s[28:31], s65 offen sc1
    s_add_u32 s65, s65, 114688
    buffer_load_dwordx4 a[148:151], v1, s[28:31], s65 offen sc1
    s_bfe_u32 s88, s54, 0x40008
    s_lshl_b32 s88, s88, 13
    s_add_u32 s65, s88, s61
    s_add_u32 s65, s65, 4096
    buffer_load_dwordx4 a[152:155], v1, s[28:31], s65 offen sc1
    s_add_u32 s65, s65, 114688
    buffer_load_dwordx4 a[156:159], v1, s[28:31], s65 offen sc1
    s_bfe_u32 s88, s54, 0x4000c
    s_lshl_b32 s88, s88, 13
    s_add_u32 s65, s88, s61
    buffer_load_dwordx4 a[160:163], v1, s[28:31], s65 offen sc1
    s_add_u32 s65, s65, 114688
    buffer_load_dwordx4 a[164:167], v1, s[28:31], s65 offen sc1
    s_bfe_u32 s88, s54, 0x4000c
    s_lshl_b32 s88, s88, 13
    s_add_u32 s65, s88, s61
    s_add_u32 s65, s65, 4096
    buffer_load_dwordx4 a[168:171], v1, s[28:31], s65 offen sc1
    s_add_u32 s65, s65, 114688
    buffer_load_dwordx4 a[172:175], v1, s[28:31], s65 offen sc1
    s_mov_b32 s65, s89
    s_sub_u32 s92, s92, 1
    s_waitcnt vmcnt(0)
    s_cbranch_scc0 Lrl4_r
    v_accvgpr_write_b32 a147, 0
    v_accvgpr_write_b32 a151, 0
    v_accvgpr_write_b32 a155, 0
    v_accvgpr_write_b32 a159, 0
    v_accvgpr_write_b32 a163, 0
    v_accvgpr_write_b32 a167, 0
    v_accvgpr_write_b32 a171, 0
    v_accvgpr_write_b32 a175, 0
    s_mov_b32 s92, 0
Lrl4_r:
    s_setpc_b64 s[98:99]
Lrl5:
    s_sleep 2
    s_mov_b32 s89, s65
    s_bfe_u32 s88, s54, 0x40010
    s_lshl_b32 s88, s88, 13
    s_add_u32 s65, s88, s61
    buffer_load_dwordx4 a[176:179], v1, s[28:31], s65 offen sc1
    s_add_u32 s65, s65, 114688
    buffer_load_dwordx4 a[180:183], v1, s[28:31], s65 offen sc1
    s_bfe_u32 s88, s54, 0x40010
    s_lshl_b32 s88, s88, 13
    s_add_u32 s65, s88, s61
    s_add_u32 s65, s65, 4096
    buffer_load_dwordx4 a[184:187], v1, s[28:31], s65 offen sc1
    s_add_u32 s65, s65, 114688
    buffer_load_dwordx4 a[188:191], v1, s[28:31], s65 offen sc1
    s_bfe_u32 s88, s54, 0x40014
    s_lshl_b32 s88, s88, 13
    s_add_u32 s65, s88, s61
    buffer_load_dwordx4 a[192:195], v1, s[28:31], s65 offen sc1
    s_add_u32 s65, s65, 114688
    buffer_load_dwordx4 a[196:199], v1, s[28:31], s65 offen sc1
    s_bfe_u32 s88, s54, 0x40014
    s_lshl_b32 s88, s88, 13
    s_add_u32 s65, s88, s61
    s_add_u32 s65, s65, 4096
    buffer_load_dwordx4 a[200:203], v1, s[28:31], s65 offen sc1
    s_add_u32 s65, s65, 114688
    buffer_load_dwordx4 a[204:207], v1, s[28:31], s65 offen sc1
    s_mov_b32 s65, s89
    s_sub_u32 s92, s92, 1
    s_waitcnt vmcnt(0)
    s_cbranch_scc0 Lrl5_r
    v_accvgpr_write_b32 a179, 0
    v_accvgpr_write_b32 a183, 0
    v_accvgpr_write_b32 a187, 0
    v_accvgpr_write_b32 a191, 0
    v_accvgpr_write_b32 a195, 0
    v_accvgpr_write_b32 a199, 0
    v_accvgpr_write_b32 a203, 0
    v_accvgpr_write_b32 a207, 0
    s_mov_b32 s92, 0
Lrl5_r:
    s_setpc_b64 s[98:99]
Lrl6:
    s_sleep 2
    s_mov_b32 s89, s65
    s_mov_b32 s88, 13
    s_lshl_b32 s88, s88, 13
    s_add_u32 s65, s88, s61
    buffer_load_dwordx4 a[208:211], v1, s[28:31], s65 offen sc1
    s_add_u32 s65, s65, 114688
    buffer_load_dwordx4 a[212:215], v1, s[28:31], s65 offen sc1
    s_mov_b32 s88, 13
    s_lshl_b32 s88, s88, 13
    s_add_u32 s65, s88, s61
    s_add_u32 s65, s65, 4096
    buffer_load_dwordx4 a[216:219], v1, s[28:31], s65 offen sc1
    s_add_u32 s65, s65, 114688
    buffer_load_dwordx4 a[220:223], v1, s[28:31], s65 offen sc1
    s_mov_b32 s65, s89
    s_sub_u32 s92, s92, 1
    s_waitcnt vmcnt(0)
    s_cbranch_scc0 Lrl6_r
    v_accvgpr_write_b32 a211, 0
    v_accvgpr_write_b32 a215, 0
    v_accvgpr_write_b32 a219, 0
    v_accvgpr_write_b32 a223, 0
    s_mov_b32 s92, 0
Lrl6_r:
    s_setpc_b64 s[98:99]
Lrl7:
    s_sleep 2
    s_mov_b32 s89, s65
    s_bfe_u32 s88, s55, 0x40000
    s_lshl_b32 s88, s88, 13
    s_add_u32 s65, s88, s62
    buffer_load_dwordx4 v[128:131], v1, s[28:31], s65 offen sc1
    s_add_u32 s65, s65, 32768
    buffer_load_dwordx4 v[132:135], v1, s[28:31], s65 offen sc1
    s_bfe_u32 s88, s55, 0x40000
    s_lshl_b32 s88, s88, 13
    s_add_u32 s65, s88, s62
    buffer_load_dwordx4 v[136:139], v1, s[28:31], s65 offen offset:1024 sc1
    s_add_u32 s65, s65, 32768
    buffer_load_dwordx4 v[140:143], v1, s[28:31], s65 offen offset:1024 sc1
    s_bfe_u32 s88, s55, 0x40004
    s_lshl_b32 s88, s88, 13
    s_add_u32 s65, s88, s62
    buffer_load_dwordx4 v[144:147], v1, s[28:31], s65 offen sc1
    s_add_u32 s65, s65, 32768
    buffer_load_dwordx4 v[148:151], v1, s[28:31], s65 offen sc1
    s_bfe_u32 s88, s55, 0x40004
    s_lshl_b32 s88, s88, 13
    s_add_u32 s65, s88, s62
    buffer_load_dwordx4 v[152:155], v1, s[28:31], s65 offen offset:1024 sc1
    s_add_u32 s65, s65, 32768
    buffer_load_dwordx4 v[156:159], v1, s[28:31], s65 offen offset:1024 sc1
    s_mov_b32 s65, s89
    s_sub_u32 s92, s92, 1
    s_waitcnt vmcnt(0)
    s_cbranch_scc0 Lrl7_r
    v_mov_b32 v131, 0
    v_mov_b32 v135, 0
    v_mov_b32 v139, 0
    v_mov_b32 v143, 0
    v_mov_b32 v147, 0
    v_mov_b32 v151, 0
    v_mov_b32 v155, 0
    v_mov_b32 v159, 0
    s_mov_b32 s92, 0
Lrl7_r:
    s_setpc_b64 s[98:99]
Lrl8:
    s_sleep 2
    s_mov_b32 s89, s65
    s_bfe_u32 s88, s55, 0x40008
    s_lshl_b32 s88, s88, 13
    s_add_u32 s65, s88, s62
    buffer_load_dwordx4 v[160:163], v1, s[28:31], s65 offen sc1
    s_add_u32 s65, s65, 32768
    buffer_load_dwordx4 v[164:167], v1, s[28:31], s65 offen sc1
    s_bfe_u32 s88, s55, 0x40008
    s_lshl_b32 s88, s88, 13
    s_add_u32 s65, s88, s62
    buffer_load_dwordx4 v[168:171], v1, s[28:31], s65 offen offset:1024 sc1
    s_add_u32 s65, s65, 32768
    buffer_load_dwordx4 v[172:175], v1, s[28:31], s65 offen offset:1024 sc1
    s_bfe_u32 s88, s55, 0x4000c
    s_lshl_b32 s88, s88, 13
    s_add_u32 s65, s88, s62
    buffer_load_dwordx4 v[176:179], v1, s[28:31], s65 offen sc1
    s_add_u32 s65, s65, 32768
    buffer_load_dwordx4 v[180:183], v1, s[28:31], s65 offen sc1
    s_bfe_u32 s88, s55, 0x4000c
    s_lshl_b32 s88, s88, 13
    s_add_u32 s65, s88, s62
    buffer_load_dwordx4 v[184:187], v1, s[28:31], s65 offen offset:1024 sc1
    s_add_u32 s65, s65, 32768
    buffer_load_dwordx4 v[188:191], v1, s[28:31], s65 offen offset:1024 sc1
    s_mov_b32 s65, s89
    s_sub_u32 s92, s92, 1
    s_waitcnt vmcnt(0)
    s_cbranch_scc0 Lrl8_r
    v_mov_b32 v163, 0
    v_mov_b32 v167, 0
    v_mov_b32 v171, 0
    v_mov_b32 v175, 0
    v_mov_b32 v179, 0
    v_mov_b32 v183, 0
    v_mov_b32 v187, 0
    v_mov_b32 v191, 0
    s_mov_b32 s92, 0
Lrl8_r:
    s_setpc_b64 s[98:99]
Lcode_end:
.section .rodata,"a"
.p2align 6
.amdhsa_kernel gated_mix__linear_kernel_hedgehog__glu_gated_geglu__prompt_kernel
  .amdhsa_next_free_vgpr 512
  .amdhsa_next_free_sgpr 102
  .amdhsa_accum_offset 256
  .amdhsa_group_segment_fixed_size 0
  .amdhsa_kernarg_size 96
  .amdhsa_user_sgpr_count 2
  .amdhsa_user_sgpr_kernarg_segment_ptr 1
  .amdhsa_system_sgpr_workgroup_id_x 1
.end_amdhsa_kernel
```
